```python
import torch

def _softmax(x, axis=-1):
    return torch.softmax(x, dim=axis)

def _gelu(x):
    return torch.nn.functional.gelu(x, approximate='tanh')

def _silu(x):
    return torch.nn.functional.silu(x)

def _sigmoid(x):
    return torch.sigmoid(x)

def _layernorm(x, axis=-1, eps=1e-05):
    m = x.mean(dim=axis, keepdim=True)
    v = x.var(dim=axis, keepdim=True, unbiased=False)
    return (x - m) / torch.sqrt(v + eps)

def _scatter_add(tgt, idx, src, axis=0):
    return tgt.clone().index_add_(axis, idx, src)

def _segment_sum(src, seg, n):
    out = torch.zeros((n,) + src.shape[1:], dtype=src.dtype)
    return out.index_add_(0, seg, src)

def _pad(x, pw):
    flat = tuple((v for pair in reversed(pw) for v in pair))
    return torch.nn.functional.pad(x, flat)
kernel_name = 'gated_mix__memory_aug_recurrent_mem_tr__glu_gated_bilinear__prompt'

def setup_inputs():

    _w = lambda a: (lambda t: t.to(torch.bfloat16) if t.is_floating_point() else t)(torch.as_tensor(a))

    def _A_setup():
        B, S, Dm = (1, 2048, 512)
        H, Dh = (32, 128)
        M, seg = (8, 32)
        seg = min(seg, S)
        S = S // seg * seg
        return {'x': _w((lambda *s: torch.randn(*s, dtype=torch.bfloat16) * 0.05)(B, S, Dm)), 'mem0': _w((lambda *s: torch.randn(*s, dtype=torch.bfloat16) * 0.4)(B, M, Dm)), 'Wq': _w((lambda *s: torch.randn(*s, dtype=torch.bfloat16) * 6.4)(Dm, H, Dh) * Dm ** (-0.5)), 'Wk': _w((lambda *s: torch.randn(*s, dtype=torch.bfloat16) * 6.4)(Dm, H, Dh) * Dm ** (-0.5)), 'Wv': _w((lambda *s: torch.randn(*s, dtype=torch.bfloat16) * 0.4)(Dm, H, Dh) * Dm ** (-0.5)), 'Wo': _w((lambda *s: torch.randn(*s, dtype=torch.bfloat16) * 0.4)(H, Dh, Dm) * (H * Dh) ** (-0.5)), 'seg_len': seg}
    _A_in = _A_setup()

    def _B_setup():
        B, S, D, F = (1, 2048, 512, 1376)
        return {'x': _w((lambda *s: torch.randn(*s, dtype=torch.bfloat16) * 0.05)(B, S, D)), 'w_gate': _w((lambda *s: torch.randn(*s, dtype=torch.bfloat16) * 1.6)(D, F) * D ** (-0.5)), 'w_up': _w((lambda *s: torch.randn(*s, dtype=torch.bfloat16) * 1.6)(D, F) * D ** (-0.5)), 'w_down': _w((lambda *s: torch.randn(*s, dtype=torch.bfloat16) * 1.6)(F, D) * F ** (-0.5))}
    _B_in = _B_setup()
    return {'A_x': _A_in['x'], 'A_mem0': _A_in['mem0'], 'A_Wq': _A_in['Wq'], 'A_Wk': _A_in['Wk'], 'A_Wv': _A_in['Wv'], 'A_Wo': _A_in['Wo'], 'A_seg_len': _A_in['seg_len'], 'B_x': _B_in['x'], 'B_w_gate': _B_in['w_gate'], 'B_w_up': _B_in['w_up'], 'B_w_down': _B_in['w_down'], 'gate_w': _w((lambda *s: torch.randn(*s, dtype=torch.bfloat16) * 0.05)(512) * 16.0)}

def reference(A_x, A_mem0, A_Wq, A_Wk, A_Wv, A_Wo, A_seg_len, B_x, B_w_gate, B_w_up, B_w_down, gate_w):

    def _A_ref(x, mem0, Wq, Wk, Wv, Wo, seg_len):
        B, S, Dm = x.shape
        H, Dh = (Wq.shape[1], Wq.shape[2])
        M = mem0.shape[1]
        scale = Dh ** (-0.5)
        n_seg = S // seg_len
        L = M + seg_len
        idx = torch.arange(L)
        mask = (idx[:, None] < M) | (idx[:, None] >= idx[None, :])
        mem = mem0
        outs = []
        for s in range(n_seg):
            xs = x[:, s * seg_len:(s + 1) * seg_len, :].clone()
            h = torch.concatenate([mem, xs], axis=1)
            q = torch.einsum('btd,dhe->bhte', h, Wq)
            k = torch.einsum('btd,dhe->bhte', h, Wk)
            v = torch.einsum('btd,dhe->bhte', h, Wv)
            scores = torch.einsum('bhqe,bhke->bhqk', q, k) * scale
            scores = torch.where(mask[None, None], scores, -1000000000.0)
            p = _softmax(scores, axis=-1)
            o = torch.einsum('bhqk,bhke->bhqe', p, v)
            o = torch.einsum('bhte,hed->btd', o, Wo)
            mem = o[:, :M, :].clone()
            outs.append(o[:, M:, :])
        return torch.concatenate(outs, axis=1)

    def _B_ref(x, w_gate, w_up, w_down):
        g = torch.einsum('bsd,df->bsf', x, w_gate)
        u = torch.einsum('bsd,df->bsf', x, w_up)
        h = g * u
        return torch.einsum('bsf,fd->bsd', h, w_down)
    x = A_x
    g = _sigmoid((x * gate_w).sum(-1, keepdims=True))
    a = _A_ref(x, A_mem0, A_Wq, A_Wk, A_Wv, A_Wo, A_seg_len)
    b = _B_ref(x, B_w_gate, B_w_up, B_w_down)
    return g * a + (1 - g) * b
```

```asm
; @launch grid=(256,1,1) block=(256,1,1) lds=163840
.amdgcn_target "amdgcn-amd-amdhsa--gfx950"
.text
.globl gated_mix__memory_aug_recurrent_mem_tr__glu_gated_bilinear__prompt_kernel
.p2align 8
.type gated_mix__memory_aug_recurrent_mem_tr__glu_gated_bilinear__prompt_kernel,@function
gated_mix__memory_aug_recurrent_mem_tr__glu_gated_bilinear__prompt_kernel:
    s_cmp_ge_u32 s2, 256
    s_cbranch_scc1 L_done
    s_load_dwordx2 s[14:15], s[0:1], 104
    s_load_dwordx2 s[4:5], s[0:1], 8
    s_load_dwordx4 s[8:11], s[0:1], 24
    s_load_dwordx2 s[6:7], s[0:1], 16
    s_load_dwordx2 s[12:13], s[0:1], 40
    s_load_dwordx2 s[16:17], s[0:1], 112
    s_load_dwordx2 s[30:31], s[0:1], 0
    s_load_dwordx8 s[32:39], s[0:1], 64
    s_load_dwordx2 s[40:41], s[0:1], 96
    s_getreg_b32 s3, hwreg(HW_REG_XCC_ID)
    s_and_b32 s3, s3, 15
    v_lshrrev_b32 v4, 6, v0
    s_lshr_b32 s18, s2, 3
    s_add_u32 s20, s2, 7
    s_and_b32 s20, s20, 7
    v_readfirstlane_b32 s19, v4
    s_waitcnt lgkmcnt(0)
    s_cmp_lg_u32 s20, 0
    s_cbranch_scc1 L_work
    v_and_b32 v96, 63, v0
    v_and_b32 v97, 15, v0
    v_lshrrev_b32 v98, 4, v96
    v_lshlrev_b32 v113, 4, v96
    s_lshl_b32 s24, s19, 15
    s_mul_i32 s25, s19, 2304
    s_add_u32 s68, s25, 139264
    v_add_u32 v120, s24, v113
    v_and_b32 v99, 1, v98
    v_lshrrev_b32 v101, 1, v98
    v_lshlrev_b32 v100, 1, v98
    v_xor_b32 v100, v100, v97
    v_lshlrev_b32 v100, 4, v100
    v_lshl_add_u32 v100, v99, 13, v100
    v_lshl_add_u32 v100, v101, 14, v100
    s_and_b32 s25, s19, 1
    s_lshl_b32 s25, s25, 15
    s_lshr_b32 s26, s19, 1
    s_lshl_b32 s26, s26, 18
    s_add_u32 s25, s25, s26
    s_lshl_b32 s26, s18, 8
    s_add_u32 s25, s25, s26
    v_add_u32 v52, s25, v100
    v_xor_b32 v100, 128, v52
    v_add_u32 v53, 64512, v100
    v_add_u32 v54, 129024, v52
    v_add_u32 v55, 193536, v100
    v_lshlrev_b32 v105, 4, v99
    v_lshl_add_u32 v105, v101, 2, v105
    v_bfe_u32 v56, v96, 3, 1
    v_add_u32 v105, v105, v56
    v_lshlrev_b32 v56, 2, v99
    v_xor_b32 v56, v56, v96
    v_and_b32 v56, 7, v56
    v_lshlrev_b32 v56, 4, v56
    v_lshl_add_u32 v105, v105, 10, v56
    s_lshl_b32 s25, s18, 17
    s_lshl_b32 s26, s19, 8
    s_add_u32 s25, s25, s26
    v_add_u32 v105, s25, v105
    s_lshl_b32 s25, s3, 1
    s_add_u32 s25, s25, 1
    s_mul_i32 s3, s25, 0x01010101
    v_mov_b32 v64, s18
    v_mov_b32 v65, s25
    s_cmp_eq_u32 s19, 0
    s_cselect_b32 s100, 1, 0
    s_mov_b32 s101, 0
    s_mov_b64 exec, s[100:101]
    global_store_byte v64, v65, s[14:15] sc1
    s_mov_b64 exec, -1
    v_lshlrev_b32 v66, 4, v97
    v_lshl_add_u32 v66, v98, 10, v66
    s_lshl_b32 s25, s19, 8
    v_add_u32 v66, s25, v66
    v_add_u32 v67, 3072, v66
    s_lshl_b32 s25, s19, 11
    s_add_u32 m0, s25, 131072
    s_nop 0
    global_load_lds_dwordx4 v66, s[4:5]
    global_load_lds_dwordx4 v67, s[4:5] offset:1024
    s_add_u32 s22, s8, 0
    s_addc_u32 s23, s9, 0
    s_add_u32 m0, s24, 0
    s_nop 0
    global_load_lds_dwordx4 v52, s[22:23] offset:0
    global_load_lds_dwordx4 v53, s[22:23] offset:1024
    global_load_lds_dwordx4 v54, s[22:23] offset:2048
    global_load_lds_dwordx4 v55, s[22:23] offset:3072
    s_add_u32 s22, s8, 524288
    s_addc_u32 s23, s9, 0
    s_add_u32 m0, s24, 4096
    s_nop 0
    global_load_lds_dwordx4 v52, s[22:23] offset:0
    global_load_lds_dwordx4 v53, s[22:23] offset:1024
    global_load_lds_dwordx4 v54, s[22:23] offset:2048
    global_load_lds_dwordx4 v55, s[22:23] offset:3072
    s_add_u32 s22, s8, 1048576
    s_addc_u32 s23, s9, 0
    s_add_u32 m0, s24, 8192
    s_nop 0
    global_load_lds_dwordx4 v52, s[22:23] offset:0
    global_load_lds_dwordx4 v53, s[22:23] offset:1024
    global_load_lds_dwordx4 v54, s[22:23] offset:2048
    global_load_lds_dwordx4 v55, s[22:23] offset:3072
    s_add_u32 s22, s8, 1572864
    s_addc_u32 s23, s9, 0
    s_add_u32 m0, s24, 12288
    s_nop 0
    global_load_lds_dwordx4 v52, s[22:23] offset:0
    global_load_lds_dwordx4 v53, s[22:23] offset:1024
    global_load_lds_dwordx4 v54, s[22:23] offset:2048
    global_load_lds_dwordx4 v55, s[22:23] offset:3072
    s_add_u32 s22, s8, 2097152
    s_addc_u32 s23, s9, 0
    s_add_u32 m0, s24, 16384
    s_nop 0
    global_load_lds_dwordx4 v52, s[22:23] offset:0
    global_load_lds_dwordx4 v53, s[22:23] offset:1024
    global_load_lds_dwordx4 v54, s[22:23] offset:2048
    global_load_lds_dwordx4 v55, s[22:23] offset:3072
    s_add_u32 s22, s8, 2621440
    s_addc_u32 s23, s9, 0
    s_add_u32 m0, s24, 20480
    s_nop 0
    global_load_lds_dwordx4 v52, s[22:23] offset:0
    global_load_lds_dwordx4 v53, s[22:23] offset:1024
    global_load_lds_dwordx4 v54, s[22:23] offset:2048
    global_load_lds_dwordx4 v55, s[22:23] offset:3072
    s_add_u32 s22, s8, 3145728
    s_addc_u32 s23, s9, 0
    s_add_u32 m0, s24, 24576
    s_nop 0
    global_load_lds_dwordx4 v52, s[22:23] offset:0
    global_load_lds_dwordx4 v53, s[22:23] offset:1024
    global_load_lds_dwordx4 v54, s[22:23] offset:2048
    global_load_lds_dwordx4 v55, s[22:23] offset:3072
    s_add_u32 s22, s8, 3670016
    s_addc_u32 s23, s9, 0
    s_add_u32 m0, s24, 28672
    s_nop 0
    global_load_lds_dwordx4 v52, s[22:23] offset:0
    global_load_lds_dwordx4 v53, s[22:23] offset:1024
    global_load_lds_dwordx4 v54, s[22:23] offset:2048
    global_load_lds_dwordx4 v55, s[22:23] offset:3072
    v_lshrrev_b32 v100, 2, v97
    v_and_b32 v101, 3, v96
    s_lshl_b32 s25, s19, 6
    v_lshl_add_u32 v56, v101, 3, s25
    v_lshlrev_b32 v57, 5, v100
    v_lshl_add_u32 v57, v99, 7, v57
    v_xor_b32 v56, v56, v57
    v_lshl_add_u32 v56, v100, 8, v56
    v_lshl_add_u32 v56, v98, 10, v56
    v_xor_b32 v57, 32, v56
    v_add_u32 v58, 0x10000, v56
    v_add_u32 v59, 0x10000, v57
    v_lshlrev_b32 v50, 8, v98
    v_lshl_add_u32 v50, v99, 6, v50
    v_lshl_add_u32 v50, v101, 3, v50
    v_and_b32 v51, 4, v96
    v_lshl_add_u32 v50, v51, 5, v50
    v_and_b32 v51, 8, v96
    v_lshl_add_u32 v50, v51, 2, v50
    v_add_u32 v50, s24, v50
    v_xor_b32 v51, 64, v50
    v_xor_b32 v116, v98, v100
    v_lshlrev_b32 v116, 3, v116
    v_lshl_add_u32 v116, v97, 5, v116
    s_lshl_b32 s25, s19, 10
    s_add_u32 s25, s25, 159744
    v_add_u32 v116, s25, v116
    v_xor_b32 v117, v101, v98
    v_lshlrev_b32 v117, 3, v117
    v_lshl_add_u32 v117, v100, 5, v117
    v_lshl_add_u32 v117, v98, 7, v117
    v_add_u32 v117, 159744, v117
    v_lshl_add_u32 v118, v100, 2, v98
    v_lshlrev_b32 v118, 11, v118
    v_lshl_add_u32 v118, v101, 4, v118
    s_lshl_b32 s25, s19, 16
    s_lshl_b32 s26, s18, 6
    s_add_u32 s25, s25, s26
    v_add_u32 v118, s25, v118
    v_lshrrev_b32 v118, 4, v97
    v_lshl_add_u32 v118, v118, 2, v98
    v_mul_u32_u24 v119, 0, v118
    v_add_u32 v119, s26, v119
    v_and_b32 v119, 0x7ff, v119
    v_lshl_add_u32 v118, v118, 13, v119
    v_and_b32 v119, 15, v96
    v_lshl_add_u32 v118, v119, 2, v118
    s_lshl_b32 s25, s19, 16
    s_add_u32 s25, s25, 4096
    v_add_u32 v118, s25, v118
    v_mov_b32 v119, 0
    v_bfe_u32 v100, v96, 5, 1
    v_lshl_add_u32 v119, v100, 5, v119
    v_bfe_u32 v100, v96, 4, 1
    v_lshl_add_u32 v119, v100, 4, v119
    v_bfe_u32 v100, v96, 1, 1
    v_lshl_add_u32 v119, v100, 3, v119
    v_bfe_u32 v100, v96, 0, 1
    v_lshl_add_u32 v119, v100, 2, v119
    v_lshlrev_b32 v121, 7, v98
    v_and_b32 v100, 12, v96
    v_lshl_add_u32 v121, v100, 3, v121
    v_and_b32 v100, 1, v96
    v_lshl_add_u32 v121, v100, 4, v121
    v_and_b32 v100, 2, v96
    v_lshl_add_u32 v121, v100, 2, v121
    s_lshl_b32 s25, s19, 9
    s_add_u32 s25, s25, 157696
    v_add_u32 v121, s25, v121
    s_mov_b32 s54, 0xcccccccc
    s_mov_b32 s55, 0xcccccccc
    s_mov_b32 s64, 4042322160
    s_mov_b32 s65, 4042322160
    s_mov_b32 s66, 983055
    s_mov_b32 s67, 983055
    s_mov_b32 s69, 1040356334
    v_mov_b32 v100, 0x4444
    v_mov_b32 v101, 0xeeee
    v_cndmask_b32 v112, v100, v101, s[54:55]
    v_cndmask_b32 v122, -1, 0, s[54:55]
    v_cndmask_b32 v123, 0, -1, s[54:55]
    s_mov_b32 s56, 5570645
    s_mov_b32 s57, 5570645
    s_mov_b32 s58, 11141290
    s_mov_b32 s59, 11141290
    s_mov_b32 s60, 1426085120
    s_mov_b32 s61, 1426085120
    s_mov_b32 s62, 2852170240
    s_mov_b32 s63, 2852170240
    s_lshl_b32 s25, s18, 2
    s_add_u32 s25, s25, s19
    s_add_u32 s46, s16, 62914560
    s_addc_u32 s47, s17, 0
    s_mov_b32 s27, s25
    s_lshl_b32 s26, s27, 11
    s_add_u32 s48, s46, s26
    s_addc_u32 s49, s47, 0
    s_and_b32 s27, s18, 24
    s_lshl_b32 s27, s27, 2
    s_and_b32 s26, s18, 7
    s_add_u32 s27, s27, s26
    s_lshl_b32 s26, s19, 3
    s_add_u32 s27, s27, s26
    s_lshl_b32 s26, s27, 6
    s_add_u32 s26, s26, 63963136
    s_add_u32 s52, s16, s26
    s_addc_u32 s53, s17, 0
    s_lshl_b32 s26, s19, 11
    s_add_u32 s26, s26, 63963136
    s_add_u32 s50, s16, s26
    s_addc_u32 s51, s17, 0
    s_lshl_b32 s26, s25, 11
    s_add_u32 s30, s16, s26
    s_addc_u32 s31, s17, 0
    s_lshl_b32 s26, s25, 10
    s_add_u32 s26, s26, 50069504
    s_add_u32 s32, s16, s26
    s_addc_u32 s33, s17, 0
    s_lshl_b32 s26, s18, 7
    s_add_u32 s26, s26, 66080768
    s_add_u32 s28, s16, s26
    s_addc_u32 s29, s17, 0
    s_lshl_b32 s26, s18, 8
    s_add_u32 s26, s26, 66068480
    s_add_u32 s84, s16, s26
    s_addc_u32 s85, s17, 0
    s_sub_u32 s26, s26, 2304
    v_lshl_add_u32 v115, v96, 3, s26
    s_lshl_b32 s26, s25, 11
    s_add_u32 s26, s26, 16775168
    v_lshl_add_u32 v100, v96, 6, s26
    v_cmp_gt_u32 vcc, 32, v96
    s_nop 1
    v_cndmask_b32 v115, v115, v100, vcc
    s_mov_b32 s86, 0
    v_lshlrev_b32 v102, 2, v96
    v_mov_b64 v[124:125], 0
    v_mov_b64 v[126:127], 0
    v_lshrrev_b32 v100, 2, v97
    v_lshlrev_b32 v100, 9, v100
    v_and_b32 v101, 1, v96
    v_lshl_add_u32 v100, v101, 8, v100
    v_lshl_add_u32 v100, v98, 5, v100
    v_and_b32 v101, 2, v96
    v_lshl_add_u32 v100, v101, 1, v100
    s_lshl_b32 s25, s19, 11
    s_add_u32 s25, s25, 131072
    v_add_u32 v100, s25, v100
    s_cmp_eq_u32 s19, 1
    s_cbranch_scc1 Lc_pw1
    s_cmp_eq_u32 s19, 2
    s_cbranch_scc1 Lc_pw2
    s_cmp_eq_u32 s19, 3
    s_cbranch_scc1 Lc_pw3
Lc_pw0:
    s_waitcnt vmcnt(28)
    s_barrier
    ds_read_b64_tr_b16 v[224:225], v56 offset:0
    ds_read_b64_tr_b16 v[226:227], v56 offset:32768
    ds_read_b64_tr_b16 v[228:229], v58 offset:0
    ds_read_b64_tr_b16 v[230:231], v58 offset:32768
    ds_read_b64_tr_b16 v[232:233], v57 offset:0
    ds_read_b64_tr_b16 v[234:235], v57 offset:32768
    ds_read_b64_tr_b16 v[236:237], v59 offset:0
    ds_read_b64_tr_b16 v[238:239], v59 offset:32768
    ds_read_u16 v64, v100 offset:0
    ds_read_u16 v65, v100 offset:2
    ds_read_u16 v66, v100 offset:8
    ds_read_u16 v67, v100 offset:10
    ds_read_u16 v68, v100 offset:16
    ds_read_u16 v69, v100 offset:18
    ds_read_u16 v70, v100 offset:24
    ds_read_u16 v71, v100 offset:26
    ds_read_u16 v72, v100 offset:128
    ds_read_u16 v73, v100 offset:130
    ds_read_u16 v74, v100 offset:136
    ds_read_u16 v75, v100 offset:138
    ds_read_u16 v76, v100 offset:144
    ds_read_u16 v77, v100 offset:146
    ds_read_u16 v78, v100 offset:152
    ds_read_u16 v79, v100 offset:154
    s_waitcnt lgkmcnt(0)
    s_waitcnt vmcnt(24)
    s_barrier
    s_add_u32 s22, s10, 0
    s_addc_u32 s23, s11, 0
    s_add_u32 m0, s24, 0
    s_bitcmp0_b32 0xa2222222, s18
    s_cbranch_scc1 Lc_nta1
    global_load_lds_dwordx4 v52, s[22:23] offset:0
    global_load_lds_dwordx4 v53, s[22:23] offset:1024
    global_load_lds_dwordx4 v54, s[22:23] offset:2048
    global_load_lds_dwordx4 v55, s[22:23] offset:3072
    s_branch Lc_ntb1
Lc_nta1:
    s_waitcnt vmcnt(5)
    global_load_lds_dwordx4 v52, s[22:23] offset:0
    s_waitcnt vmcnt(5)
    global_load_lds_dwordx4 v53, s[22:23] offset:1024
    s_waitcnt vmcnt(5)
    global_load_lds_dwordx4 v54, s[22:23] offset:2048
    s_waitcnt vmcnt(5)
    global_load_lds_dwordx4 v55, s[22:23] offset:3072
Lc_ntb1:
    ds_read_b64_tr_b16 a[96:97], v56 offset:4096
    ds_read_b64_tr_b16 a[98:99], v56 offset:36864
    ds_read_b64_tr_b16 a[100:101], v58 offset:4096
    ds_read_b64_tr_b16 a[102:103], v58 offset:36864
    ds_read_b64_tr_b16 a[104:105], v57 offset:4096
    ds_read_b64_tr_b16 a[106:107], v57 offset:36864
    ds_read_b64_tr_b16 a[108:109], v59 offset:4096
    ds_read_b64_tr_b16 a[110:111], v59 offset:36864
    v_lshl_or_b32 v0, v65, 16, v64
    v_lshl_or_b32 v1, v67, 16, v66
    v_lshl_or_b32 v2, v69, 16, v68
    v_lshl_or_b32 v3, v71, 16, v70
    v_lshl_or_b32 v4, v73, 16, v72
    v_lshl_or_b32 v5, v75, 16, v74
    v_lshl_or_b32 v6, v77, 16, v76
    v_lshl_or_b32 v7, v79, 16, v78
    s_waitcnt lgkmcnt(0)
    s_waitcnt vmcnt(24)
    s_barrier
    s_add_u32 s22, s10, 524288
    s_addc_u32 s23, s11, 0
    s_add_u32 m0, s24, 4096
    s_bitcmp0_b32 0xa2222222, s18
    s_cbranch_scc1 Lc_nta2
    global_load_lds_dwordx4 v52, s[22:23] offset:0
    global_load_lds_dwordx4 v53, s[22:23] offset:1024
    global_load_lds_dwordx4 v54, s[22:23] offset:2048
    global_load_lds_dwordx4 v55, s[22:23] offset:3072
    s_branch Lc_ntb2
Lc_nta2:
    s_waitcnt vmcnt(5)
    global_load_lds_dwordx4 v52, s[22:23] offset:0
    s_waitcnt vmcnt(5)
    global_load_lds_dwordx4 v53, s[22:23] offset:1024
    s_waitcnt vmcnt(5)
    global_load_lds_dwordx4 v54, s[22:23] offset:2048
    s_waitcnt vmcnt(5)
    global_load_lds_dwordx4 v55, s[22:23] offset:3072
Lc_ntb2:
    ds_read_b64_tr_b16 a[112:113], v56 offset:8192
    ds_read_b64_tr_b16 a[114:115], v56 offset:40960
    ds_read_b64_tr_b16 a[116:117], v58 offset:8192
    ds_read_b64_tr_b16 a[118:119], v58 offset:40960
    ds_read_b64_tr_b16 a[120:121], v57 offset:8192
    ds_read_b64_tr_b16 a[122:123], v57 offset:40960
    ds_read_b64_tr_b16 a[124:125], v59 offset:8192
    ds_read_b64_tr_b16 a[126:127], v59 offset:40960
    s_waitcnt lgkmcnt(0)
    s_waitcnt vmcnt(24)
    s_barrier
    s_add_u32 s22, s10, 1048576
    s_addc_u32 s23, s11, 0
    s_add_u32 m0, s24, 8192
    s_bitcmp0_b32 0xa2222222, s18
    s_cbranch_scc1 Lc_nta3
    global_load_lds_dwordx4 v52, s[22:23] offset:0
    global_load_lds_dwordx4 v53, s[22:23] offset:1024
    global_load_lds_dwordx4 v54, s[22:23] offset:2048
    global_load_lds_dwordx4 v55, s[22:23] offset:3072
    s_branch Lc_ntb3
Lc_nta3:
    s_waitcnt vmcnt(5)
    global_load_lds_dwordx4 v52, s[22:23] offset:0
    s_waitcnt vmcnt(5)
    global_load_lds_dwordx4 v53, s[22:23] offset:1024
    s_waitcnt vmcnt(5)
    global_load_lds_dwordx4 v54, s[22:23] offset:2048
    s_waitcnt vmcnt(5)
    global_load_lds_dwordx4 v55, s[22:23] offset:3072
Lc_ntb3:
    ds_read_b64_tr_b16 a[128:129], v56 offset:12288
    ds_read_b64_tr_b16 a[130:131], v56 offset:45056
    ds_read_b64_tr_b16 a[132:133], v58 offset:12288
    ds_read_b64_tr_b16 a[134:135], v58 offset:45056
    ds_read_b64_tr_b16 a[136:137], v57 offset:12288
    ds_read_b64_tr_b16 a[138:139], v57 offset:45056
    ds_read_b64_tr_b16 a[140:141], v59 offset:12288
    ds_read_b64_tr_b16 a[142:143], v59 offset:45056
    s_waitcnt lgkmcnt(0)
    s_waitcnt vmcnt(24)
    s_barrier
    s_add_u32 s22, s10, 1572864
    s_addc_u32 s23, s11, 0
    s_add_u32 m0, s24, 12288
    s_bitcmp0_b32 0xa2222222, s18
    s_cbranch_scc1 Lc_nta4
    global_load_lds_dwordx4 v52, s[22:23] offset:0
    global_load_lds_dwordx4 v53, s[22:23] offset:1024
    global_load_lds_dwordx4 v54, s[22:23] offset:2048
    global_load_lds_dwordx4 v55, s[22:23] offset:3072
    s_branch Lc_ntb4
Lc_nta4:
    s_waitcnt vmcnt(5)
    global_load_lds_dwordx4 v52, s[22:23] offset:0
    s_waitcnt vmcnt(5)
    global_load_lds_dwordx4 v53, s[22:23] offset:1024
    s_waitcnt vmcnt(5)
    global_load_lds_dwordx4 v54, s[22:23] offset:2048
    s_waitcnt vmcnt(5)
    global_load_lds_dwordx4 v55, s[22:23] offset:3072
Lc_ntb4:
    ds_read_b64_tr_b16 a[144:145], v56 offset:16384
    ds_read_b64_tr_b16 a[146:147], v56 offset:49152
    ds_read_b64_tr_b16 a[148:149], v58 offset:16384
    ds_read_b64_tr_b16 a[150:151], v58 offset:49152
    ds_read_b64_tr_b16 a[152:153], v57 offset:16384
    ds_read_b64_tr_b16 a[154:155], v57 offset:49152
    ds_read_b64_tr_b16 a[156:157], v59 offset:16384
    ds_read_b64_tr_b16 a[158:159], v59 offset:49152
    s_waitcnt lgkmcnt(0)
    s_waitcnt vmcnt(24)
    s_barrier
    s_add_u32 s22, s10, 2097152
    s_addc_u32 s23, s11, 0
    s_add_u32 m0, s24, 16384
    s_bitcmp0_b32 0xa2222222, s18
    s_cbranch_scc1 Lc_nta5
    global_load_lds_dwordx4 v52, s[22:23] offset:0
    global_load_lds_dwordx4 v53, s[22:23] offset:1024
    global_load_lds_dwordx4 v54, s[22:23] offset:2048
    global_load_lds_dwordx4 v55, s[22:23] offset:3072
    s_branch Lc_ntb5
Lc_nta5:
    s_waitcnt vmcnt(5)
    global_load_lds_dwordx4 v52, s[22:23] offset:0
    s_waitcnt vmcnt(5)
    global_load_lds_dwordx4 v53, s[22:23] offset:1024
    s_waitcnt vmcnt(5)
    global_load_lds_dwordx4 v54, s[22:23] offset:2048
    s_waitcnt vmcnt(5)
    global_load_lds_dwordx4 v55, s[22:23] offset:3072
Lc_ntb5:
    ds_read_b64_tr_b16 a[160:161], v56 offset:20480
    ds_read_b64_tr_b16 a[162:163], v56 offset:53248
    ds_read_b64_tr_b16 a[164:165], v58 offset:20480
    ds_read_b64_tr_b16 a[166:167], v58 offset:53248
    ds_read_b64_tr_b16 a[168:169], v57 offset:20480
    ds_read_b64_tr_b16 a[170:171], v57 offset:53248
    ds_read_b64_tr_b16 a[172:173], v59 offset:20480
    ds_read_b64_tr_b16 a[174:175], v59 offset:53248
    s_waitcnt lgkmcnt(0)
    s_waitcnt vmcnt(24)
    s_barrier
    s_add_u32 s22, s10, 2621440
    s_addc_u32 s23, s11, 0
    s_add_u32 m0, s24, 20480
    s_bitcmp0_b32 0xa2222222, s18
    s_cbranch_scc1 Lc_nta6
    global_load_lds_dwordx4 v52, s[22:23] offset:0
    global_load_lds_dwordx4 v53, s[22:23] offset:1024
    global_load_lds_dwordx4 v54, s[22:23] offset:2048
    global_load_lds_dwordx4 v55, s[22:23] offset:3072
    s_branch Lc_ntb6
Lc_nta6:
    s_waitcnt vmcnt(5)
    global_load_lds_dwordx4 v52, s[22:23] offset:0
    s_waitcnt vmcnt(5)
    global_load_lds_dwordx4 v53, s[22:23] offset:1024
    s_waitcnt vmcnt(5)
    global_load_lds_dwordx4 v54, s[22:23] offset:2048
    s_waitcnt vmcnt(5)
    global_load_lds_dwordx4 v55, s[22:23] offset:3072
Lc_ntb6:
    ds_read_b64_tr_b16 v[240:241], v56 offset:24576
    ds_read_b64_tr_b16 v[242:243], v56 offset:57344
    ds_read_b64_tr_b16 v[244:245], v58 offset:24576
    ds_read_b64_tr_b16 v[246:247], v58 offset:57344
    ds_read_b64_tr_b16 v[248:249], v57 offset:24576
    ds_read_b64_tr_b16 v[250:251], v57 offset:57344
    ds_read_b64_tr_b16 v[252:253], v59 offset:24576
    ds_read_b64_tr_b16 v[254:255], v59 offset:57344
    s_waitcnt lgkmcnt(0)
    s_waitcnt vmcnt(24)
    s_barrier
    s_add_u32 s22, s10, 3145728
    s_addc_u32 s23, s11, 0
    s_add_u32 m0, s24, 24576
    s_bitcmp0_b32 0xa2222222, s18
    s_cbranch_scc1 Lc_nta7
    global_load_lds_dwordx4 v52, s[22:23] offset:0
    global_load_lds_dwordx4 v53, s[22:23] offset:1024
    global_load_lds_dwordx4 v54, s[22:23] offset:2048
    global_load_lds_dwordx4 v55, s[22:23] offset:3072
    s_branch Lc_ntb7
Lc_nta7:
    s_waitcnt vmcnt(5)
    global_load_lds_dwordx4 v52, s[22:23] offset:0
    s_waitcnt vmcnt(5)
    global_load_lds_dwordx4 v53, s[22:23] offset:1024
    s_waitcnt vmcnt(5)
    global_load_lds_dwordx4 v54, s[22:23] offset:2048
    s_waitcnt vmcnt(5)
    global_load_lds_dwordx4 v55, s[22:23] offset:3072
Lc_ntb7:
    ds_read_b64_tr_b16 v[80:81], v56 offset:28672
    ds_read_b64_tr_b16 v[82:83], v56 offset:61440
    ds_read_b64_tr_b16 v[84:85], v58 offset:28672
    ds_read_b64_tr_b16 v[86:87], v58 offset:61440
    ds_read_b64_tr_b16 v[88:89], v57 offset:28672
    ds_read_b64_tr_b16 v[90:91], v57 offset:61440
    ds_read_b64_tr_b16 v[92:93], v59 offset:28672
    ds_read_b64_tr_b16 v[94:95], v59 offset:61440
    s_waitcnt lgkmcnt(0)
    s_waitcnt vmcnt(24)
    s_barrier
    s_add_u32 s22, s10, 3670016
    s_addc_u32 s23, s11, 0
    s_add_u32 m0, s24, 28672
    s_bitcmp0_b32 0xa2222222, s18
    s_cbranch_scc1 Lc_nta8
    global_load_lds_dwordx4 v52, s[22:23] offset:0
    global_load_lds_dwordx4 v53, s[22:23] offset:1024
    global_load_lds_dwordx4 v54, s[22:23] offset:2048
    global_load_lds_dwordx4 v55, s[22:23] offset:3072
    s_branch Lc_ntb8
Lc_nta8:
    s_waitcnt vmcnt(5)
    global_load_lds_dwordx4 v52, s[22:23] offset:0
    s_waitcnt vmcnt(5)
    global_load_lds_dwordx4 v53, s[22:23] offset:1024
    s_waitcnt vmcnt(5)
    global_load_lds_dwordx4 v54, s[22:23] offset:2048
    s_waitcnt vmcnt(5)
    global_load_lds_dwordx4 v55, s[22:23] offset:3072
Lc_ntb8:
    ds_read_b64_tr_b16 a[176:177], v56 offset:0
    ds_read_b64_tr_b16 a[178:179], v56 offset:32768
    ds_read_b64_tr_b16 a[180:181], v58 offset:0
    ds_read_b64_tr_b16 a[182:183], v58 offset:32768
    ds_read_b64_tr_b16 a[184:185], v57 offset:0
    ds_read_b64_tr_b16 a[186:187], v57 offset:32768
    ds_read_b64_tr_b16 a[188:189], v59 offset:0
    ds_read_b64_tr_b16 a[190:191], v59 offset:32768
    s_waitcnt lgkmcnt(0)
    s_waitcnt vmcnt(24)
    s_barrier
    s_add_u32 s22, s6, 0
    s_addc_u32 s23, s7, 0
    s_add_u32 m0, s24, 0
    s_bitcmp0_b32 0xa2222222, s18
    s_cbranch_scc1 Lc_nta9
    global_load_lds_dwordx4 v52, s[22:23] offset:0
    global_load_lds_dwordx4 v53, s[22:23] offset:1024
    global_load_lds_dwordx4 v54, s[22:23] offset:2048
    global_load_lds_dwordx4 v55, s[22:23] offset:3072
    s_branch Lc_ntb9
Lc_nta9:
    s_waitcnt vmcnt(5)
    global_load_lds_dwordx4 v52, s[22:23] offset:0
    s_waitcnt vmcnt(5)
    global_load_lds_dwordx4 v53, s[22:23] offset:1024
    s_waitcnt vmcnt(5)
    global_load_lds_dwordx4 v54, s[22:23] offset:2048
    s_waitcnt vmcnt(5)
    global_load_lds_dwordx4 v55, s[22:23] offset:3072
Lc_ntb9:
    ds_read_b64_tr_b16 a[192:193], v56 offset:4096
    ds_read_b64_tr_b16 a[194:195], v56 offset:36864
    ds_read_b64_tr_b16 a[196:197], v58 offset:4096
    ds_read_b64_tr_b16 a[198:199], v58 offset:36864
    ds_read_b64_tr_b16 a[200:201], v57 offset:4096
    ds_read_b64_tr_b16 a[202:203], v57 offset:36864
    ds_read_b64_tr_b16 a[204:205], v59 offset:4096
    ds_read_b64_tr_b16 a[206:207], v59 offset:36864
    s_waitcnt lgkmcnt(0)
    s_waitcnt vmcnt(24)
    s_barrier
    s_add_u32 s22, s6, 524288
    s_addc_u32 s23, s7, 0
    s_add_u32 m0, s24, 4096
    s_bitcmp0_b32 0xa2222222, s18
    s_cbranch_scc1 Lc_nta10
    global_load_lds_dwordx4 v52, s[22:23] offset:0
    global_load_lds_dwordx4 v53, s[22:23] offset:1024
    global_load_lds_dwordx4 v54, s[22:23] offset:2048
    global_load_lds_dwordx4 v55, s[22:23] offset:3072
    s_branch Lc_ntb10
Lc_nta10:
    s_waitcnt vmcnt(5)
    global_load_lds_dwordx4 v52, s[22:23] offset:0
    s_waitcnt vmcnt(5)
    global_load_lds_dwordx4 v53, s[22:23] offset:1024
    s_waitcnt vmcnt(5)
    global_load_lds_dwordx4 v54, s[22:23] offset:2048
    s_waitcnt vmcnt(5)
    global_load_lds_dwordx4 v55, s[22:23] offset:3072
Lc_ntb10:
    ds_read_b64_tr_b16 a[208:209], v56 offset:8192
    ds_read_b64_tr_b16 a[210:211], v56 offset:40960
    ds_read_b64_tr_b16 a[212:213], v58 offset:8192
    ds_read_b64_tr_b16 a[214:215], v58 offset:40960
    ds_read_b64_tr_b16 a[216:217], v57 offset:8192
    ds_read_b64_tr_b16 a[218:219], v57 offset:40960
    ds_read_b64_tr_b16 a[220:221], v59 offset:8192
    ds_read_b64_tr_b16 a[222:223], v59 offset:40960
    global_load_dword v103, v102, s[14:15] sc1
    s_waitcnt lgkmcnt(0)
    s_waitcnt vmcnt(25)
    s_barrier
    s_add_u32 s22, s6, 1048576
    s_addc_u32 s23, s7, 0
    s_add_u32 m0, s24, 8192
    s_bitcmp0_b32 0xa2222222, s18
    s_cbranch_scc1 Lc_nta11
    global_load_lds_dwordx4 v52, s[22:23] offset:0
    global_load_lds_dwordx4 v53, s[22:23] offset:1024
    global_load_lds_dwordx4 v54, s[22:23] offset:2048
    global_load_lds_dwordx4 v55, s[22:23] offset:3072
    s_branch Lc_ntb11
Lc_nta11:
    s_waitcnt vmcnt(5)
    global_load_lds_dwordx4 v52, s[22:23] offset:0
    s_waitcnt vmcnt(5)
    global_load_lds_dwordx4 v53, s[22:23] offset:1024
    s_waitcnt vmcnt(5)
    global_load_lds_dwordx4 v54, s[22:23] offset:2048
    s_waitcnt vmcnt(5)
    global_load_lds_dwordx4 v55, s[22:23] offset:3072
Lc_ntb11:
    ds_read_b64_tr_b16 a[224:225], v56 offset:12288
    ds_read_b64_tr_b16 a[226:227], v56 offset:45056
    ds_read_b64_tr_b16 a[228:229], v58 offset:12288
    ds_read_b64_tr_b16 a[230:231], v58 offset:45056
    ds_read_b64_tr_b16 a[232:233], v57 offset:12288
    ds_read_b64_tr_b16 a[234:235], v57 offset:45056
    ds_read_b64_tr_b16 a[236:237], v59 offset:12288
    ds_read_b64_tr_b16 a[238:239], v59 offset:45056
    s_waitcnt lgkmcnt(0)
    s_waitcnt vmcnt(25)
    s_barrier
    s_add_u32 s22, s6, 1572864
    s_addc_u32 s23, s7, 0
    s_add_u32 m0, s24, 12288
    s_bitcmp0_b32 0xa2222222, s18
    s_cbranch_scc1 Lc_nta12
    global_load_lds_dwordx4 v52, s[22:23] offset:0
    global_load_lds_dwordx4 v53, s[22:23] offset:1024
    global_load_lds_dwordx4 v54, s[22:23] offset:2048
    global_load_lds_dwordx4 v55, s[22:23] offset:3072
    s_branch Lc_ntb12
Lc_nta12:
    s_waitcnt vmcnt(5)
    global_load_lds_dwordx4 v52, s[22:23] offset:0
    s_waitcnt vmcnt(5)
    global_load_lds_dwordx4 v53, s[22:23] offset:1024
    s_waitcnt vmcnt(5)
    global_load_lds_dwordx4 v54, s[22:23] offset:2048
    s_waitcnt vmcnt(5)
    global_load_lds_dwordx4 v55, s[22:23] offset:3072
Lc_ntb12:
    ds_read_b64_tr_b16 a[240:241], v56 offset:16384
    ds_read_b64_tr_b16 a[242:243], v56 offset:49152
    ds_read_b64_tr_b16 a[244:245], v58 offset:16384
    ds_read_b64_tr_b16 a[246:247], v58 offset:49152
    ds_read_b64_tr_b16 a[248:249], v57 offset:16384
    ds_read_b64_tr_b16 a[250:251], v57 offset:49152
    ds_read_b64_tr_b16 a[252:253], v59 offset:16384
    ds_read_b64_tr_b16 a[254:255], v59 offset:49152
    s_waitcnt lgkmcnt(0)
    s_waitcnt vmcnt(25)
    s_barrier
    s_add_u32 s22, s6, 2097152
    s_addc_u32 s23, s7, 0
    s_add_u32 m0, s24, 16384
    s_bitcmp0_b32 0xa2222222, s18
    s_cbranch_scc1 Lc_nta13
    global_load_lds_dwordx4 v52, s[22:23] offset:0
    global_load_lds_dwordx4 v53, s[22:23] offset:1024
    global_load_lds_dwordx4 v54, s[22:23] offset:2048
    global_load_lds_dwordx4 v55, s[22:23] offset:3072
    s_branch Lc_ntb13
Lc_nta13:
    s_waitcnt vmcnt(5)
    global_load_lds_dwordx4 v52, s[22:23] offset:0
    s_waitcnt vmcnt(5)
    global_load_lds_dwordx4 v53, s[22:23] offset:1024
    s_waitcnt vmcnt(5)
    global_load_lds_dwordx4 v54, s[22:23] offset:2048
    s_waitcnt vmcnt(5)
    global_load_lds_dwordx4 v55, s[22:23] offset:3072
Lc_ntb13:
    ds_read_b64_tr_b16 v[128:129], v56 offset:20480
    ds_read_b64_tr_b16 v[130:131], v56 offset:53248
    ds_read_b64_tr_b16 v[132:133], v58 offset:20480
    ds_read_b64_tr_b16 v[134:135], v58 offset:53248
    ds_read_b64_tr_b16 v[136:137], v57 offset:20480
    ds_read_b64_tr_b16 v[138:139], v57 offset:53248
    ds_read_b64_tr_b16 v[140:141], v59 offset:20480
    ds_read_b64_tr_b16 v[142:143], v59 offset:53248
    s_waitcnt lgkmcnt(0)
    s_waitcnt vmcnt(25)
    s_barrier
    s_add_u32 s22, s6, 2621440
    s_addc_u32 s23, s7, 0
    s_add_u32 m0, s24, 20480
    s_bitcmp0_b32 0xa2222222, s18
    s_cbranch_scc1 Lc_nta14
    global_load_lds_dwordx4 v52, s[22:23] offset:0
    global_load_lds_dwordx4 v53, s[22:23] offset:1024
    global_load_lds_dwordx4 v54, s[22:23] offset:2048
    global_load_lds_dwordx4 v55, s[22:23] offset:3072
    s_branch Lc_ntb14
Lc_nta14:
    s_waitcnt vmcnt(5)
    global_load_lds_dwordx4 v52, s[22:23] offset:0
    s_waitcnt vmcnt(5)
    global_load_lds_dwordx4 v53, s[22:23] offset:1024
    s_waitcnt vmcnt(5)
    global_load_lds_dwordx4 v54, s[22:23] offset:2048
    s_waitcnt vmcnt(5)
    global_load_lds_dwordx4 v55, s[22:23] offset:3072
Lc_ntb14:
    ds_read_b64_tr_b16 v[144:145], v56 offset:24576
    ds_read_b64_tr_b16 v[146:147], v56 offset:57344
    ds_read_b64_tr_b16 v[148:149], v58 offset:24576
    ds_read_b64_tr_b16 v[150:151], v58 offset:57344
    ds_read_b64_tr_b16 v[152:153], v57 offset:24576
    ds_read_b64_tr_b16 v[154:155], v57 offset:57344
    ds_read_b64_tr_b16 v[156:157], v59 offset:24576
    ds_read_b64_tr_b16 v[158:159], v59 offset:57344
    s_waitcnt lgkmcnt(0)
    s_waitcnt vmcnt(25)
    s_barrier
    s_add_u32 s22, s6, 3145728
    s_addc_u32 s23, s7, 0
    s_add_u32 m0, s24, 24576
    s_bitcmp0_b32 0xa2222222, s18
    s_cbranch_scc1 Lc_nta15
    global_load_lds_dwordx4 v52, s[22:23] offset:0
    global_load_lds_dwordx4 v53, s[22:23] offset:1024
    global_load_lds_dwordx4 v54, s[22:23] offset:2048
    global_load_lds_dwordx4 v55, s[22:23] offset:3072
    s_branch Lc_ntb15
Lc_nta15:
    s_waitcnt vmcnt(5)
    global_load_lds_dwordx4 v52, s[22:23] offset:0
    s_waitcnt vmcnt(5)
    global_load_lds_dwordx4 v53, s[22:23] offset:1024
    s_waitcnt vmcnt(5)
    global_load_lds_dwordx4 v54, s[22:23] offset:2048
    s_waitcnt vmcnt(5)
    global_load_lds_dwordx4 v55, s[22:23] offset:3072
Lc_ntb15:
    ds_read_b64_tr_b16 v[160:161], v56 offset:28672
    ds_read_b64_tr_b16 v[162:163], v56 offset:61440
    ds_read_b64_tr_b16 v[164:165], v58 offset:28672
    ds_read_b64_tr_b16 v[166:167], v58 offset:61440
    ds_read_b64_tr_b16 v[168:169], v57 offset:28672
    ds_read_b64_tr_b16 v[170:171], v57 offset:61440
    ds_read_b64_tr_b16 v[172:173], v59 offset:28672
    ds_read_b64_tr_b16 v[174:175], v59 offset:61440
    s_waitcnt lgkmcnt(0)
    s_waitcnt vmcnt(25)
    s_barrier
    s_add_u32 s22, s6, 3670016
    s_addc_u32 s23, s7, 0
    s_add_u32 m0, s24, 28672
    s_bitcmp0_b32 0xa2222222, s18
    s_cbranch_scc1 Lc_nta16
    global_load_lds_dwordx4 v52, s[22:23] offset:0
    global_load_lds_dwordx4 v53, s[22:23] offset:1024
    global_load_lds_dwordx4 v54, s[22:23] offset:2048
    global_load_lds_dwordx4 v55, s[22:23] offset:3072
    s_branch Lc_ntb16
Lc_nta16:
    s_waitcnt vmcnt(5)
    global_load_lds_dwordx4 v52, s[22:23] offset:0
    s_waitcnt vmcnt(5)
    global_load_lds_dwordx4 v53, s[22:23] offset:1024
    s_waitcnt vmcnt(5)
    global_load_lds_dwordx4 v54, s[22:23] offset:2048
    s_waitcnt vmcnt(5)
    global_load_lds_dwordx4 v55, s[22:23] offset:3072
Lc_ntb16:
    ds_read_b64_tr_b16 v[192:193], v56 offset:0
    ds_read_b64_tr_b16 v[194:195], v56 offset:32768
    ds_read_b64_tr_b16 v[196:197], v58 offset:0
    ds_read_b64_tr_b16 v[198:199], v58 offset:32768
    ds_read_b64_tr_b16 v[200:201], v57 offset:0
    ds_read_b64_tr_b16 v[202:203], v57 offset:32768
    ds_read_b64_tr_b16 v[204:205], v59 offset:0
    ds_read_b64_tr_b16 v[206:207], v59 offset:32768
    s_waitcnt lgkmcnt(0)
    s_waitcnt vmcnt(25)
    s_barrier
    s_xor_b32 s25, s19, 0
    s_lshl_b32 s25, s25, 15
    s_add_u32 s26, s25, 0
    s_add_u32 s22, s12, s26
    s_addc_u32 s23, s13, 0
    s_add_u32 m0, s24, 0
    s_nop 0
    global_load_lds_dwordx4 v105, s[22:23]
    s_add_u32 s26, s25, 2048
    s_add_u32 s22, s12, s26
    s_addc_u32 s23, s13, 0
    s_add_u32 m0, s24, 1024
    s_nop 0
    global_load_lds_dwordx4 v105, s[22:23]
    s_add_u32 s26, s25, 8192
    s_add_u32 s22, s12, s26
    s_addc_u32 s23, s13, 0
    s_add_u32 m0, s24, 2048
    s_nop 0
    global_load_lds_dwordx4 v105, s[22:23]
    s_add_u32 s26, s25, 10240
    s_add_u32 s22, s12, s26
    s_addc_u32 s23, s13, 0
    s_add_u32 m0, s24, 3072
    s_nop 0
    global_load_lds_dwordx4 v105, s[22:23]
    ds_read_b64_tr_b16 v[208:209], v56 offset:4096
    ds_read_b64_tr_b16 v[210:211], v56 offset:36864
    ds_read_b64_tr_b16 v[212:213], v58 offset:4096
    ds_read_b64_tr_b16 v[214:215], v58 offset:36864
    ds_read_b64_tr_b16 v[216:217], v57 offset:4096
    ds_read_b64_tr_b16 v[218:219], v57 offset:36864
    ds_read_b64_tr_b16 v[220:221], v59 offset:4096
    ds_read_b64_tr_b16 v[222:223], v59 offset:36864
    s_waitcnt lgkmcnt(0)
    s_waitcnt vmcnt(24)
    s_barrier
    s_xor_b32 s25, s19, 0
    s_lshl_b32 s25, s25, 15
    s_add_u32 s26, s25, 128
    s_add_u32 s22, s12, s26
    s_addc_u32 s23, s13, 0
    s_add_u32 m0, s24, 4096
    s_nop 0
    global_load_lds_dwordx4 v105, s[22:23]
    s_add_u32 s26, s25, 2176
    s_add_u32 s22, s12, s26
    s_addc_u32 s23, s13, 0
    s_add_u32 m0, s24, 5120
    s_nop 0
    global_load_lds_dwordx4 v105, s[22:23]
    s_add_u32 s26, s25, 8320
    s_add_u32 s22, s12, s26
    s_addc_u32 s23, s13, 0
    s_add_u32 m0, s24, 6144
    s_nop 0
    global_load_lds_dwordx4 v105, s[22:23]
    s_add_u32 s26, s25, 10368
    s_add_u32 s22, s12, s26
    s_addc_u32 s23, s13, 0
    s_add_u32 m0, s24, 7168
    s_nop 0
    global_load_lds_dwordx4 v105, s[22:23]
    ds_read_b64_tr_b16 a[0:1], v56 offset:8192
    ds_read_b64_tr_b16 a[2:3], v56 offset:40960
    ds_read_b64_tr_b16 a[4:5], v58 offset:8192
    ds_read_b64_tr_b16 a[6:7], v58 offset:40960
    ds_read_b64_tr_b16 a[8:9], v57 offset:8192
    ds_read_b64_tr_b16 a[10:11], v57 offset:40960
    ds_read_b64_tr_b16 a[12:13], v59 offset:8192
    ds_read_b64_tr_b16 a[14:15], v59 offset:40960
    s_mov_b32 s21, 0
Lc_tb0:
    v_and_b32 v99, 0x01010101, v103
    v_cmp_ne_u32 vcc, 0x01010101, v99
    s_and_b32 s25, vcc_lo, 16777215
    s_and_b32 s26, vcc_hi, 256
    s_or_b32 s25, s25, s26
    s_cbranch_scc0 Lc_tbo0
    s_sleep 4
    global_load_dword v103, v102, s[14:15] sc1
    s_add_u32 s21, s21, 1
    s_cmp_gt_u32 s21, 200000
    s_cbranch_scc1 Lc_end
    s_waitcnt vmcnt(0)
    s_branch Lc_tb0
Lc_tbo0:
    v_cmp_ne_u32 vcc, s3, v103
    s_and_b32 s3, vcc_lo, 0xff
    s_waitcnt lgkmcnt(0)
    s_waitcnt vmcnt(24)
    s_barrier
    s_xor_b32 s25, s19, 1
    s_lshl_b32 s25, s25, 15
    s_add_u32 s26, s25, 0
    s_add_u32 s22, s12, s26
    s_addc_u32 s23, s13, 0
    s_add_u32 m0, s24, 8192
    s_nop 0
    global_load_lds_dwordx4 v105, s[22:23]
    s_add_u32 s26, s25, 2048
    s_add_u32 s22, s12, s26
    s_addc_u32 s23, s13, 0
    s_add_u32 m0, s24, 9216
    s_nop 0
    global_load_lds_dwordx4 v105, s[22:23]
    s_add_u32 s26, s25, 8192
    s_add_u32 s22, s12, s26
    s_addc_u32 s23, s13, 0
    s_add_u32 m0, s24, 10240
    s_nop 0
    global_load_lds_dwordx4 v105, s[22:23]
    s_add_u32 s26, s25, 10240
    s_add_u32 s22, s12, s26
    s_addc_u32 s23, s13, 0
    s_add_u32 m0, s24, 11264
    s_nop 0
    global_load_lds_dwordx4 v105, s[22:23]
    ds_read_b64_tr_b16 a[16:17], v56 offset:12288
    ds_read_b64_tr_b16 a[18:19], v56 offset:45056
    ds_read_b64_tr_b16 a[20:21], v58 offset:12288
    ds_read_b64_tr_b16 a[22:23], v58 offset:45056
    ds_read_b64_tr_b16 a[24:25], v57 offset:12288
    ds_read_b64_tr_b16 a[26:27], v57 offset:45056
    ds_read_b64_tr_b16 a[28:29], v59 offset:12288
    ds_read_b64_tr_b16 a[30:31], v59 offset:45056
    s_waitcnt lgkmcnt(0)
    s_waitcnt vmcnt(24)
    s_barrier
    s_xor_b32 s25, s19, 1
    s_lshl_b32 s25, s25, 15
    s_add_u32 s26, s25, 128
    s_add_u32 s22, s12, s26
    s_addc_u32 s23, s13, 0
    s_add_u32 m0, s24, 12288
    s_nop 0
    global_load_lds_dwordx4 v105, s[22:23]
    s_add_u32 s26, s25, 2176
    s_add_u32 s22, s12, s26
    s_addc_u32 s23, s13, 0
    s_add_u32 m0, s24, 13312
    s_nop 0
    global_load_lds_dwordx4 v105, s[22:23]
    s_add_u32 s26, s25, 8320
    s_add_u32 s22, s12, s26
    s_addc_u32 s23, s13, 0
    s_add_u32 m0, s24, 14336
    s_nop 0
    global_load_lds_dwordx4 v105, s[22:23]
    s_add_u32 s26, s25, 10368
    s_add_u32 s22, s12, s26
    s_addc_u32 s23, s13, 0
    s_add_u32 m0, s24, 15360
    s_nop 0
    global_load_lds_dwordx4 v105, s[22:23]
    ds_read_b64_tr_b16 a[32:33], v56 offset:16384
    ds_read_b64_tr_b16 a[34:35], v56 offset:49152
    ds_read_b64_tr_b16 a[36:37], v58 offset:16384
    ds_read_b64_tr_b16 a[38:39], v58 offset:49152
    ds_read_b64_tr_b16 a[40:41], v57 offset:16384
    ds_read_b64_tr_b16 a[42:43], v57 offset:49152
    ds_read_b64_tr_b16 a[44:45], v59 offset:16384
    ds_read_b64_tr_b16 a[46:47], v59 offset:49152
    s_waitcnt lgkmcnt(0)
    s_waitcnt vmcnt(24)
    s_barrier
    s_xor_b32 s25, s19, 2
    s_lshl_b32 s25, s25, 15
    s_add_u32 s26, s25, 0
    s_add_u32 s22, s12, s26
    s_addc_u32 s23, s13, 0
    s_add_u32 m0, s24, 16384
    s_nop 0
    global_load_lds_dwordx4 v105, s[22:23]
    s_add_u32 s26, s25, 2048
    s_add_u32 s22, s12, s26
    s_addc_u32 s23, s13, 0
    s_add_u32 m0, s24, 17408
    s_nop 0
    global_load_lds_dwordx4 v105, s[22:23]
    s_add_u32 s26, s25, 8192
    s_add_u32 s22, s12, s26
    s_addc_u32 s23, s13, 0
    s_add_u32 m0, s24, 18432
    s_nop 0
    global_load_lds_dwordx4 v105, s[22:23]
    s_add_u32 s26, s25, 10240
    s_add_u32 s22, s12, s26
    s_addc_u32 s23, s13, 0
    s_add_u32 m0, s24, 19456
    s_nop 0
    global_load_lds_dwordx4 v105, s[22:23]
    ds_read_b64_tr_b16 a[48:49], v56 offset:20480
    ds_read_b64_tr_b16 a[50:51], v56 offset:53248
    ds_read_b64_tr_b16 a[52:53], v58 offset:20480
    ds_read_b64_tr_b16 a[54:55], v58 offset:53248
    ds_read_b64_tr_b16 a[56:57], v57 offset:20480
    ds_read_b64_tr_b16 a[58:59], v57 offset:53248
    ds_read_b64_tr_b16 a[60:61], v59 offset:20480
    ds_read_b64_tr_b16 a[62:63], v59 offset:53248
    s_waitcnt lgkmcnt(0)
    s_waitcnt vmcnt(24)
    s_barrier
    s_xor_b32 s25, s19, 2
    s_lshl_b32 s25, s25, 15
    s_add_u32 s26, s25, 128
    s_add_u32 s22, s12, s26
    s_addc_u32 s23, s13, 0
    s_add_u32 m0, s24, 20480
    s_nop 0
    global_load_lds_dwordx4 v105, s[22:23]
    s_add_u32 s26, s25, 2176
    s_add_u32 s22, s12, s26
    s_addc_u32 s23, s13, 0
    s_add_u32 m0, s24, 21504
    s_nop 0
    global_load_lds_dwordx4 v105, s[22:23]
    s_add_u32 s26, s25, 8320
    s_add_u32 s22, s12, s26
    s_addc_u32 s23, s13, 0
    s_add_u32 m0, s24, 22528
    s_nop 0
    global_load_lds_dwordx4 v105, s[22:23]
    s_add_u32 s26, s25, 10368
    s_add_u32 s22, s12, s26
    s_addc_u32 s23, s13, 0
    s_add_u32 m0, s24, 23552
    s_nop 0
    global_load_lds_dwordx4 v105, s[22:23]
    ds_read_b64_tr_b16 a[64:65], v56 offset:24576
    ds_read_b64_tr_b16 a[66:67], v56 offset:57344
    ds_read_b64_tr_b16 a[68:69], v58 offset:24576
    ds_read_b64_tr_b16 a[70:71], v58 offset:57344
    ds_read_b64_tr_b16 a[72:73], v57 offset:24576
    ds_read_b64_tr_b16 a[74:75], v57 offset:57344
    ds_read_b64_tr_b16 a[76:77], v59 offset:24576
    ds_read_b64_tr_b16 a[78:79], v59 offset:57344
    v_lshlrev_b32 v99, 7, v97
    v_and_b32 v101, 1, v98
    v_lshl_add_u32 v100, v101, 18, v99
    global_load_dword v103, v100, s[48:49] sc1
    v_lshl_add_u32 v99, v101, 13, v99
    global_load_dword v103, v99, s[50:51] sc1
    global_load_dword v48, v102, s[84:85] sc1
    s_waitcnt lgkmcnt(0)
    s_waitcnt vmcnt(27)
    s_barrier
    s_xor_b32 s25, s19, 3
    s_lshl_b32 s25, s25, 15
    s_add_u32 s26, s25, 0
    s_add_u32 s22, s12, s26
    s_addc_u32 s23, s13, 0
    s_add_u32 m0, s24, 24576
    s_nop 0
    global_load_lds_dwordx4 v105, s[22:23]
    s_add_u32 s26, s25, 2048
    s_add_u32 s22, s12, s26
    s_addc_u32 s23, s13, 0
    s_add_u32 m0, s24, 25600
    s_nop 0
    global_load_lds_dwordx4 v105, s[22:23]
    s_add_u32 s26, s25, 8192
    s_add_u32 s22, s12, s26
    s_addc_u32 s23, s13, 0
    s_add_u32 m0, s24, 26624
    s_nop 0
    global_load_lds_dwordx4 v105, s[22:23]
    s_add_u32 s26, s25, 10240
    s_add_u32 s22, s12, s26
    s_addc_u32 s23, s13, 0
    s_add_u32 m0, s24, 27648
    s_nop 0
    global_load_lds_dwordx4 v105, s[22:23]
    ds_read_b64_tr_b16 a[80:81], v56 offset:28672
    ds_read_b64_tr_b16 a[82:83], v56 offset:61440
    ds_read_b64_tr_b16 a[84:85], v58 offset:28672
    ds_read_b64_tr_b16 a[86:87], v58 offset:61440
    ds_read_b64_tr_b16 a[88:89], v57 offset:28672
    ds_read_b64_tr_b16 a[90:91], v57 offset:61440
    ds_read_b64_tr_b16 a[92:93], v59 offset:28672
    ds_read_b64_tr_b16 a[94:95], v59 offset:61440
    s_waitcnt lgkmcnt(0)
    s_branch Lc_pwe
Lc_pw1:
    s_waitcnt vmcnt(28)
    s_barrier
    ds_read_b64_tr_b16 a[112:113], v56 offset:0
    ds_read_b64_tr_b16 a[114:115], v56 offset:32768
    ds_read_b64_tr_b16 a[116:117], v58 offset:0
    ds_read_b64_tr_b16 a[118:119], v58 offset:32768
    ds_read_b64_tr_b16 a[120:121], v57 offset:0
    ds_read_b64_tr_b16 a[122:123], v57 offset:32768
    ds_read_b64_tr_b16 a[124:125], v59 offset:0
    ds_read_b64_tr_b16 a[126:127], v59 offset:32768
    ds_read_u16 v64, v100 offset:0
    ds_read_u16 v65, v100 offset:2
    ds_read_u16 v66, v100 offset:8
    ds_read_u16 v67, v100 offset:10
    ds_read_u16 v68, v100 offset:16
    ds_read_u16 v69, v100 offset:18
    ds_read_u16 v70, v100 offset:24
    ds_read_u16 v71, v100 offset:26
    ds_read_u16 v72, v100 offset:128
    ds_read_u16 v73, v100 offset:130
    ds_read_u16 v74, v100 offset:136
    ds_read_u16 v75, v100 offset:138
    ds_read_u16 v76, v100 offset:144
    ds_read_u16 v77, v100 offset:146
    ds_read_u16 v78, v100 offset:152
    ds_read_u16 v79, v100 offset:154
    s_waitcnt lgkmcnt(0)
    s_waitcnt vmcnt(24)
    s_barrier
    s_add_u32 s22, s10, 0
    s_addc_u32 s23, s11, 0
    s_add_u32 m0, s24, 0
    s_bitcmp0_b32 0xa2222222, s18
    s_cbranch_scc1 Lc_nta17
    global_load_lds_dwordx4 v52, s[22:23] offset:0
    global_load_lds_dwordx4 v53, s[22:23] offset:1024
    global_load_lds_dwordx4 v54, s[22:23] offset:2048
    global_load_lds_dwordx4 v55, s[22:23] offset:3072
    s_branch Lc_ntb17
Lc_nta17:
    s_waitcnt vmcnt(5)
    global_load_lds_dwordx4 v52, s[22:23] offset:0
    s_waitcnt vmcnt(5)
    global_load_lds_dwordx4 v53, s[22:23] offset:1024
    s_waitcnt vmcnt(5)
    global_load_lds_dwordx4 v54, s[22:23] offset:2048
    s_waitcnt vmcnt(5)
    global_load_lds_dwordx4 v55, s[22:23] offset:3072
Lc_ntb17:
    ds_read_b64_tr_b16 a[128:129], v56 offset:4096
    ds_read_b64_tr_b16 a[130:131], v56 offset:36864
    ds_read_b64_tr_b16 a[132:133], v58 offset:4096
    ds_read_b64_tr_b16 a[134:135], v58 offset:36864
    ds_read_b64_tr_b16 a[136:137], v57 offset:4096
    ds_read_b64_tr_b16 a[138:139], v57 offset:36864
    ds_read_b64_tr_b16 a[140:141], v59 offset:4096
    ds_read_b64_tr_b16 a[142:143], v59 offset:36864
    v_lshl_or_b32 v0, v65, 16, v64
    v_lshl_or_b32 v1, v67, 16, v66
    v_lshl_or_b32 v2, v69, 16, v68
    v_lshl_or_b32 v3, v71, 16, v70
    v_lshl_or_b32 v4, v73, 16, v72
    v_lshl_or_b32 v5, v75, 16, v74
    v_lshl_or_b32 v6, v77, 16, v76
    v_lshl_or_b32 v7, v79, 16, v78
    s_waitcnt lgkmcnt(0)
    s_waitcnt vmcnt(24)
    s_barrier
    s_add_u32 s22, s10, 524288
    s_addc_u32 s23, s11, 0
    s_add_u32 m0, s24, 4096
    s_bitcmp0_b32 0xa2222222, s18
    s_cbranch_scc1 Lc_nta18
    global_load_lds_dwordx4 v52, s[22:23] offset:0
    global_load_lds_dwordx4 v53, s[22:23] offset:1024
    global_load_lds_dwordx4 v54, s[22:23] offset:2048
    global_load_lds_dwordx4 v55, s[22:23] offset:3072
    s_branch Lc_ntb18
Lc_nta18:
    s_waitcnt vmcnt(5)
    global_load_lds_dwordx4 v52, s[22:23] offset:0
    s_waitcnt vmcnt(5)
    global_load_lds_dwordx4 v53, s[22:23] offset:1024
    s_waitcnt vmcnt(5)
    global_load_lds_dwordx4 v54, s[22:23] offset:2048
    s_waitcnt vmcnt(5)
    global_load_lds_dwordx4 v55, s[22:23] offset:3072
Lc_ntb18:
    ds_read_b64_tr_b16 v[224:225], v56 offset:8192
    ds_read_b64_tr_b16 v[226:227], v56 offset:40960
    ds_read_b64_tr_b16 v[228:229], v58 offset:8192
    ds_read_b64_tr_b16 v[230:231], v58 offset:40960
    ds_read_b64_tr_b16 v[232:233], v57 offset:8192
    ds_read_b64_tr_b16 v[234:235], v57 offset:40960
    ds_read_b64_tr_b16 v[236:237], v59 offset:8192
    ds_read_b64_tr_b16 v[238:239], v59 offset:40960
    s_waitcnt lgkmcnt(0)
    s_waitcnt vmcnt(24)
    s_barrier
    s_add_u32 s22, s10, 1048576
    s_addc_u32 s23, s11, 0
    s_add_u32 m0, s24, 8192
    s_bitcmp0_b32 0xa2222222, s18
    s_cbranch_scc1 Lc_nta19
    global_load_lds_dwordx4 v52, s[22:23] offset:0
    global_load_lds_dwordx4 v53, s[22:23] offset:1024
    global_load_lds_dwordx4 v54, s[22:23] offset:2048
    global_load_lds_dwordx4 v55, s[22:23] offset:3072
    s_branch Lc_ntb19
Lc_nta19:
    s_waitcnt vmcnt(5)
    global_load_lds_dwordx4 v52, s[22:23] offset:0
    s_waitcnt vmcnt(5)
    global_load_lds_dwordx4 v53, s[22:23] offset:1024
    s_waitcnt vmcnt(5)
    global_load_lds_dwordx4 v54, s[22:23] offset:2048
    s_waitcnt vmcnt(5)
    global_load_lds_dwordx4 v55, s[22:23] offset:3072
Lc_ntb19:
    ds_read_b64_tr_b16 a[96:97], v56 offset:12288
    ds_read_b64_tr_b16 a[98:99], v56 offset:45056
    ds_read_b64_tr_b16 a[100:101], v58 offset:12288
    ds_read_b64_tr_b16 a[102:103], v58 offset:45056
    ds_read_b64_tr_b16 a[104:105], v57 offset:12288
    ds_read_b64_tr_b16 a[106:107], v57 offset:45056
    ds_read_b64_tr_b16 a[108:109], v59 offset:12288
    ds_read_b64_tr_b16 a[110:111], v59 offset:45056
    s_waitcnt lgkmcnt(0)
    s_waitcnt vmcnt(24)
    s_barrier
    s_add_u32 s22, s10, 1572864
    s_addc_u32 s23, s11, 0
    s_add_u32 m0, s24, 12288
    s_bitcmp0_b32 0xa2222222, s18
    s_cbranch_scc1 Lc_nta20
    global_load_lds_dwordx4 v52, s[22:23] offset:0
    global_load_lds_dwordx4 v53, s[22:23] offset:1024
    global_load_lds_dwordx4 v54, s[22:23] offset:2048
    global_load_lds_dwordx4 v55, s[22:23] offset:3072
    s_branch Lc_ntb20
Lc_nta20:
    s_waitcnt vmcnt(5)
    global_load_lds_dwordx4 v52, s[22:23] offset:0
    s_waitcnt vmcnt(5)
    global_load_lds_dwordx4 v53, s[22:23] offset:1024
    s_waitcnt vmcnt(5)
    global_load_lds_dwordx4 v54, s[22:23] offset:2048
    s_waitcnt vmcnt(5)
    global_load_lds_dwordx4 v55, s[22:23] offset:3072
Lc_ntb20:
    ds_read_b64_tr_b16 v[240:241], v56 offset:16384
    ds_read_b64_tr_b16 v[242:243], v56 offset:49152
    ds_read_b64_tr_b16 v[244:245], v58 offset:16384
    ds_read_b64_tr_b16 v[246:247], v58 offset:49152
    ds_read_b64_tr_b16 v[248:249], v57 offset:16384
    ds_read_b64_tr_b16 v[250:251], v57 offset:49152
    ds_read_b64_tr_b16 v[252:253], v59 offset:16384
    ds_read_b64_tr_b16 v[254:255], v59 offset:49152
    s_waitcnt lgkmcnt(0)
    s_waitcnt vmcnt(24)
    s_barrier
    s_add_u32 s22, s10, 2097152
    s_addc_u32 s23, s11, 0
    s_add_u32 m0, s24, 16384
    s_bitcmp0_b32 0xa2222222, s18
    s_cbranch_scc1 Lc_nta21
    global_load_lds_dwordx4 v52, s[22:23] offset:0
    global_load_lds_dwordx4 v53, s[22:23] offset:1024
    global_load_lds_dwordx4 v54, s[22:23] offset:2048
    global_load_lds_dwordx4 v55, s[22:23] offset:3072
    s_branch Lc_ntb21
Lc_nta21:
    s_waitcnt vmcnt(5)
    global_load_lds_dwordx4 v52, s[22:23] offset:0
    s_waitcnt vmcnt(5)
    global_load_lds_dwordx4 v53, s[22:23] offset:1024
    s_waitcnt vmcnt(5)
    global_load_lds_dwordx4 v54, s[22:23] offset:2048
    s_waitcnt vmcnt(5)
    global_load_lds_dwordx4 v55, s[22:23] offset:3072
Lc_ntb21:
    ds_read_b64_tr_b16 v[80:81], v56 offset:20480
    ds_read_b64_tr_b16 v[82:83], v56 offset:53248
    ds_read_b64_tr_b16 v[84:85], v58 offset:20480
    ds_read_b64_tr_b16 v[86:87], v58 offset:53248
    ds_read_b64_tr_b16 v[88:89], v57 offset:20480
    ds_read_b64_tr_b16 v[90:91], v57 offset:53248
    ds_read_b64_tr_b16 v[92:93], v59 offset:20480
    ds_read_b64_tr_b16 v[94:95], v59 offset:53248
    s_waitcnt lgkmcnt(0)
    s_waitcnt vmcnt(24)
    s_barrier
    s_add_u32 s22, s10, 2621440
    s_addc_u32 s23, s11, 0
    s_add_u32 m0, s24, 20480
    s_bitcmp0_b32 0xa2222222, s18
    s_cbranch_scc1 Lc_nta22
    global_load_lds_dwordx4 v52, s[22:23] offset:0
    global_load_lds_dwordx4 v53, s[22:23] offset:1024
    global_load_lds_dwordx4 v54, s[22:23] offset:2048
    global_load_lds_dwordx4 v55, s[22:23] offset:3072
    s_branch Lc_ntb22
Lc_nta22:
    s_waitcnt vmcnt(5)
    global_load_lds_dwordx4 v52, s[22:23] offset:0
    s_waitcnt vmcnt(5)
    global_load_lds_dwordx4 v53, s[22:23] offset:1024
    s_waitcnt vmcnt(5)
    global_load_lds_dwordx4 v54, s[22:23] offset:2048
    s_waitcnt vmcnt(5)
    global_load_lds_dwordx4 v55, s[22:23] offset:3072
Lc_ntb22:
    ds_read_b64_tr_b16 a[144:145], v56 offset:24576
    ds_read_b64_tr_b16 a[146:147], v56 offset:57344
    ds_read_b64_tr_b16 a[148:149], v58 offset:24576
    ds_read_b64_tr_b16 a[150:151], v58 offset:57344
    ds_read_b64_tr_b16 a[152:153], v57 offset:24576
    ds_read_b64_tr_b16 a[154:155], v57 offset:57344
    ds_read_b64_tr_b16 a[156:157], v59 offset:24576
    ds_read_b64_tr_b16 a[158:159], v59 offset:57344
    s_waitcnt lgkmcnt(0)
    s_waitcnt vmcnt(24)
    s_barrier
    s_add_u32 s22, s10, 3145728
    s_addc_u32 s23, s11, 0
    s_add_u32 m0, s24, 24576
    s_bitcmp0_b32 0xa2222222, s18
    s_cbranch_scc1 Lc_nta23
    global_load_lds_dwordx4 v52, s[22:23] offset:0
    global_load_lds_dwordx4 v53, s[22:23] offset:1024
    global_load_lds_dwordx4 v54, s[22:23] offset:2048
    global_load_lds_dwordx4 v55, s[22:23] offset:3072
    s_branch Lc_ntb23
Lc_nta23:
    s_waitcnt vmcnt(5)
    global_load_lds_dwordx4 v52, s[22:23] offset:0
    s_waitcnt vmcnt(5)
    global_load_lds_dwordx4 v53, s[22:23] offset:1024
    s_waitcnt vmcnt(5)
    global_load_lds_dwordx4 v54, s[22:23] offset:2048
    s_waitcnt vmcnt(5)
    global_load_lds_dwordx4 v55, s[22:23] offset:3072
Lc_ntb23:
    ds_read_b64_tr_b16 a[160:161], v56 offset:28672
    ds_read_b64_tr_b16 a[162:163], v56 offset:61440
    ds_read_b64_tr_b16 a[164:165], v58 offset:28672
    ds_read_b64_tr_b16 a[166:167], v58 offset:61440
    ds_read_b64_tr_b16 a[168:169], v57 offset:28672
    ds_read_b64_tr_b16 a[170:171], v57 offset:61440
    ds_read_b64_tr_b16 a[172:173], v59 offset:28672
    ds_read_b64_tr_b16 a[174:175], v59 offset:61440
    s_waitcnt lgkmcnt(0)
    s_waitcnt vmcnt(24)
    s_barrier
    s_add_u32 s22, s10, 3670016
    s_addc_u32 s23, s11, 0
    s_add_u32 m0, s24, 28672
    s_bitcmp0_b32 0xa2222222, s18
    s_cbranch_scc1 Lc_nta24
    global_load_lds_dwordx4 v52, s[22:23] offset:0
    global_load_lds_dwordx4 v53, s[22:23] offset:1024
    global_load_lds_dwordx4 v54, s[22:23] offset:2048
    global_load_lds_dwordx4 v55, s[22:23] offset:3072
    s_branch Lc_ntb24
Lc_nta24:
    s_waitcnt vmcnt(5)
    global_load_lds_dwordx4 v52, s[22:23] offset:0
    s_waitcnt vmcnt(5)
    global_load_lds_dwordx4 v53, s[22:23] offset:1024
    s_waitcnt vmcnt(5)
    global_load_lds_dwordx4 v54, s[22:23] offset:2048
    s_waitcnt vmcnt(5)
    global_load_lds_dwordx4 v55, s[22:23] offset:3072
Lc_ntb24:
    ds_read_b64_tr_b16 a[208:209], v56 offset:0
    ds_read_b64_tr_b16 a[210:211], v56 offset:32768
    ds_read_b64_tr_b16 a[212:213], v58 offset:0
    ds_read_b64_tr_b16 a[214:215], v58 offset:32768
    ds_read_b64_tr_b16 a[216:217], v57 offset:0
    ds_read_b64_tr_b16 a[218:219], v57 offset:32768
    ds_read_b64_tr_b16 a[220:221], v59 offset:0
    ds_read_b64_tr_b16 a[222:223], v59 offset:32768
    s_waitcnt lgkmcnt(0)
    s_waitcnt vmcnt(24)
    s_barrier
    s_add_u32 s22, s6, 0
    s_addc_u32 s23, s7, 0
    s_add_u32 m0, s24, 0
    s_bitcmp0_b32 0xa2222222, s18
    s_cbranch_scc1 Lc_nta25
    global_load_lds_dwordx4 v52, s[22:23] offset:0
    global_load_lds_dwordx4 v53, s[22:23] offset:1024
    global_load_lds_dwordx4 v54, s[22:23] offset:2048
    global_load_lds_dwordx4 v55, s[22:23] offset:3072
    s_branch Lc_ntb25
Lc_nta25:
    s_waitcnt vmcnt(5)
    global_load_lds_dwordx4 v52, s[22:23] offset:0
    s_waitcnt vmcnt(5)
    global_load_lds_dwordx4 v53, s[22:23] offset:1024
    s_waitcnt vmcnt(5)
    global_load_lds_dwordx4 v54, s[22:23] offset:2048
    s_waitcnt vmcnt(5)
    global_load_lds_dwordx4 v55, s[22:23] offset:3072
Lc_ntb25:
    ds_read_b64_tr_b16 a[224:225], v56 offset:4096
    ds_read_b64_tr_b16 a[226:227], v56 offset:36864
    ds_read_b64_tr_b16 a[228:229], v58 offset:4096
    ds_read_b64_tr_b16 a[230:231], v58 offset:36864
    ds_read_b64_tr_b16 a[232:233], v57 offset:4096
    ds_read_b64_tr_b16 a[234:235], v57 offset:36864
    ds_read_b64_tr_b16 a[236:237], v59 offset:4096
    ds_read_b64_tr_b16 a[238:239], v59 offset:36864
    s_waitcnt lgkmcnt(0)
    s_waitcnt vmcnt(24)
    s_barrier
    s_add_u32 s22, s6, 524288
    s_addc_u32 s23, s7, 0
    s_add_u32 m0, s24, 4096
    s_bitcmp0_b32 0xa2222222, s18
    s_cbranch_scc1 Lc_nta26
    global_load_lds_dwordx4 v52, s[22:23] offset:0
    global_load_lds_dwordx4 v53, s[22:23] offset:1024
    global_load_lds_dwordx4 v54, s[22:23] offset:2048
    global_load_lds_dwordx4 v55, s[22:23] offset:3072
    s_branch Lc_ntb26
Lc_nta26:
    s_waitcnt vmcnt(5)
    global_load_lds_dwordx4 v52, s[22:23] offset:0
    s_waitcnt vmcnt(5)
    global_load_lds_dwordx4 v53, s[22:23] offset:1024
    s_waitcnt vmcnt(5)
    global_load_lds_dwordx4 v54, s[22:23] offset:2048
    s_waitcnt vmcnt(5)
    global_load_lds_dwordx4 v55, s[22:23] offset:3072
Lc_ntb26:
    ds_read_b64_tr_b16 a[176:177], v56 offset:8192
    ds_read_b64_tr_b16 a[178:179], v56 offset:40960
    ds_read_b64_tr_b16 a[180:181], v58 offset:8192
    ds_read_b64_tr_b16 a[182:183], v58 offset:40960
    ds_read_b64_tr_b16 a[184:185], v57 offset:8192
    ds_read_b64_tr_b16 a[186:187], v57 offset:40960
    ds_read_b64_tr_b16 a[188:189], v59 offset:8192
    ds_read_b64_tr_b16 a[190:191], v59 offset:40960
    global_load_dword v103, v102, s[14:15] sc1
    s_waitcnt lgkmcnt(0)
    s_waitcnt vmcnt(25)
    s_barrier
    s_add_u32 s22, s6, 1048576
    s_addc_u32 s23, s7, 0
    s_add_u32 m0, s24, 8192
    s_bitcmp0_b32 0xa2222222, s18
    s_cbranch_scc1 Lc_nta27
    global_load_lds_dwordx4 v52, s[22:23] offset:0
    global_load_lds_dwordx4 v53, s[22:23] offset:1024
    global_load_lds_dwordx4 v54, s[22:23] offset:2048
    global_load_lds_dwordx4 v55, s[22:23] offset:3072
    s_branch Lc_ntb27
Lc_nta27:
    s_waitcnt vmcnt(5)
    global_load_lds_dwordx4 v52, s[22:23] offset:0
    s_waitcnt vmcnt(5)
    global_load_lds_dwordx4 v53, s[22:23] offset:1024
    s_waitcnt vmcnt(5)
    global_load_lds_dwordx4 v54, s[22:23] offset:2048
    s_waitcnt vmcnt(5)
    global_load_lds_dwordx4 v55, s[22:23] offset:3072
Lc_ntb27:
    ds_read_b64_tr_b16 a[192:193], v56 offset:12288
    ds_read_b64_tr_b16 a[194:195], v56 offset:45056
    ds_read_b64_tr_b16 a[196:197], v58 offset:12288
    ds_read_b64_tr_b16 a[198:199], v58 offset:45056
    ds_read_b64_tr_b16 a[200:201], v57 offset:12288
    ds_read_b64_tr_b16 a[202:203], v57 offset:45056
    ds_read_b64_tr_b16 a[204:205], v59 offset:12288
    ds_read_b64_tr_b16 a[206:207], v59 offset:45056
    s_waitcnt lgkmcnt(0)
    s_waitcnt vmcnt(25)
    s_barrier
    s_add_u32 s22, s6, 1572864
    s_addc_u32 s23, s7, 0
    s_add_u32 m0, s24, 12288
    s_bitcmp0_b32 0xa2222222, s18
    s_cbranch_scc1 Lc_nta28
    global_load_lds_dwordx4 v52, s[22:23] offset:0
    global_load_lds_dwordx4 v53, s[22:23] offset:1024
    global_load_lds_dwordx4 v54, s[22:23] offset:2048
    global_load_lds_dwordx4 v55, s[22:23] offset:3072
    s_branch Lc_ntb28
Lc_nta28:
    s_waitcnt vmcnt(5)
    global_load_lds_dwordx4 v52, s[22:23] offset:0
    s_waitcnt vmcnt(5)
    global_load_lds_dwordx4 v53, s[22:23] offset:1024
    s_waitcnt vmcnt(5)
    global_load_lds_dwordx4 v54, s[22:23] offset:2048
    s_waitcnt vmcnt(5)
    global_load_lds_dwordx4 v55, s[22:23] offset:3072
Lc_ntb28:
    ds_read_b64_tr_b16 v[144:145], v56 offset:16384
    ds_read_b64_tr_b16 v[146:147], v56 offset:49152
    ds_read_b64_tr_b16 v[148:149], v58 offset:16384
    ds_read_b64_tr_b16 v[150:151], v58 offset:49152
    ds_read_b64_tr_b16 v[152:153], v57 offset:16384
    ds_read_b64_tr_b16 v[154:155], v57 offset:49152
    ds_read_b64_tr_b16 v[156:157], v59 offset:16384
    ds_read_b64_tr_b16 v[158:159], v59 offset:49152
    s_waitcnt lgkmcnt(0)
    s_waitcnt vmcnt(25)
    s_barrier
    s_add_u32 s22, s6, 2097152
    s_addc_u32 s23, s7, 0
    s_add_u32 m0, s24, 16384
    s_bitcmp0_b32 0xa2222222, s18
    s_cbranch_scc1 Lc_nta29
    global_load_lds_dwordx4 v52, s[22:23] offset:0
    global_load_lds_dwordx4 v53, s[22:23] offset:1024
    global_load_lds_dwordx4 v54, s[22:23] offset:2048
    global_load_lds_dwordx4 v55, s[22:23] offset:3072
    s_branch Lc_ntb29
Lc_nta29:
    s_waitcnt vmcnt(5)
    global_load_lds_dwordx4 v52, s[22:23] offset:0
    s_waitcnt vmcnt(5)
    global_load_lds_dwordx4 v53, s[22:23] offset:1024
    s_waitcnt vmcnt(5)
    global_load_lds_dwordx4 v54, s[22:23] offset:2048
    s_waitcnt vmcnt(5)
    global_load_lds_dwordx4 v55, s[22:23] offset:3072
Lc_ntb29:
    ds_read_b64_tr_b16 v[160:161], v56 offset:20480
    ds_read_b64_tr_b16 v[162:163], v56 offset:53248
    ds_read_b64_tr_b16 v[164:165], v58 offset:20480
    ds_read_b64_tr_b16 v[166:167], v58 offset:53248
    ds_read_b64_tr_b16 v[168:169], v57 offset:20480
    ds_read_b64_tr_b16 v[170:171], v57 offset:53248
    ds_read_b64_tr_b16 v[172:173], v59 offset:20480
    ds_read_b64_tr_b16 v[174:175], v59 offset:53248
    s_waitcnt lgkmcnt(0)
    s_waitcnt vmcnt(25)
    s_barrier
    s_add_u32 s22, s6, 2621440
    s_addc_u32 s23, s7, 0
    s_add_u32 m0, s24, 20480
    s_bitcmp0_b32 0xa2222222, s18
    s_cbranch_scc1 Lc_nta30
    global_load_lds_dwordx4 v52, s[22:23] offset:0
    global_load_lds_dwordx4 v53, s[22:23] offset:1024
    global_load_lds_dwordx4 v54, s[22:23] offset:2048
    global_load_lds_dwordx4 v55, s[22:23] offset:3072
    s_branch Lc_ntb30
Lc_nta30:
    s_waitcnt vmcnt(5)
    global_load_lds_dwordx4 v52, s[22:23] offset:0
    s_waitcnt vmcnt(5)
    global_load_lds_dwordx4 v53, s[22:23] offset:1024
    s_waitcnt vmcnt(5)
    global_load_lds_dwordx4 v54, s[22:23] offset:2048
    s_waitcnt vmcnt(5)
    global_load_lds_dwordx4 v55, s[22:23] offset:3072
Lc_ntb30:
    ds_read_b64_tr_b16 a[240:241], v56 offset:24576
    ds_read_b64_tr_b16 a[242:243], v56 offset:57344
    ds_read_b64_tr_b16 a[244:245], v58 offset:24576
    ds_read_b64_tr_b16 a[246:247], v58 offset:57344
    ds_read_b64_tr_b16 a[248:249], v57 offset:24576
    ds_read_b64_tr_b16 a[250:251], v57 offset:57344
    ds_read_b64_tr_b16 a[252:253], v59 offset:24576
    ds_read_b64_tr_b16 a[254:255], v59 offset:57344
    s_waitcnt lgkmcnt(0)
    s_waitcnt vmcnt(25)
    s_barrier
    s_add_u32 s22, s6, 3145728
    s_addc_u32 s23, s7, 0
    s_add_u32 m0, s24, 24576
    s_bitcmp0_b32 0xa2222222, s18
    s_cbranch_scc1 Lc_nta31
    global_load_lds_dwordx4 v52, s[22:23] offset:0
    global_load_lds_dwordx4 v53, s[22:23] offset:1024
    global_load_lds_dwordx4 v54, s[22:23] offset:2048
    global_load_lds_dwordx4 v55, s[22:23] offset:3072
    s_branch Lc_ntb31
Lc_nta31:
    s_waitcnt vmcnt(5)
    global_load_lds_dwordx4 v52, s[22:23] offset:0
    s_waitcnt vmcnt(5)
    global_load_lds_dwordx4 v53, s[22:23] offset:1024
    s_waitcnt vmcnt(5)
    global_load_lds_dwordx4 v54, s[22:23] offset:2048
    s_waitcnt vmcnt(5)
    global_load_lds_dwordx4 v55, s[22:23] offset:3072
Lc_ntb31:
    ds_read_b64_tr_b16 v[128:129], v56 offset:28672
    ds_read_b64_tr_b16 v[130:131], v56 offset:61440
    ds_read_b64_tr_b16 v[132:133], v58 offset:28672
    ds_read_b64_tr_b16 v[134:135], v58 offset:61440
    ds_read_b64_tr_b16 v[136:137], v57 offset:28672
    ds_read_b64_tr_b16 v[138:139], v57 offset:61440
    ds_read_b64_tr_b16 v[140:141], v59 offset:28672
    ds_read_b64_tr_b16 v[142:143], v59 offset:61440
    s_waitcnt lgkmcnt(0)
    s_waitcnt vmcnt(25)
    s_barrier
    s_add_u32 s22, s6, 3670016
    s_addc_u32 s23, s7, 0
    s_add_u32 m0, s24, 28672
    s_bitcmp0_b32 0xa2222222, s18
    s_cbranch_scc1 Lc_nta32
    global_load_lds_dwordx4 v52, s[22:23] offset:0
    global_load_lds_dwordx4 v53, s[22:23] offset:1024
    global_load_lds_dwordx4 v54, s[22:23] offset:2048
    global_load_lds_dwordx4 v55, s[22:23] offset:3072
    s_branch Lc_ntb32
Lc_nta32:
    s_waitcnt vmcnt(5)
    global_load_lds_dwordx4 v52, s[22:23] offset:0
    s_waitcnt vmcnt(5)
    global_load_lds_dwordx4 v53, s[22:23] offset:1024
    s_waitcnt vmcnt(5)
    global_load_lds_dwordx4 v54, s[22:23] offset:2048
    s_waitcnt vmcnt(5)
    global_load_lds_dwordx4 v55, s[22:23] offset:3072
Lc_ntb32:
    ds_read_b64_tr_b16 a[0:1], v56 offset:0
    ds_read_b64_tr_b16 a[2:3], v56 offset:32768
    ds_read_b64_tr_b16 a[4:5], v58 offset:0
    ds_read_b64_tr_b16 a[6:7], v58 offset:32768
    ds_read_b64_tr_b16 a[8:9], v57 offset:0
    ds_read_b64_tr_b16 a[10:11], v57 offset:32768
    ds_read_b64_tr_b16 a[12:13], v59 offset:0
    ds_read_b64_tr_b16 a[14:15], v59 offset:32768
    s_waitcnt lgkmcnt(0)
    s_waitcnt vmcnt(25)
    s_barrier
    s_xor_b32 s25, s19, 0
    s_lshl_b32 s25, s25, 15
    s_add_u32 s26, s25, 0
    s_add_u32 s22, s12, s26
    s_addc_u32 s23, s13, 0
    s_add_u32 m0, s24, 0
    s_nop 0
    global_load_lds_dwordx4 v105, s[22:23]
    s_add_u32 s26, s25, 2048
    s_add_u32 s22, s12, s26
    s_addc_u32 s23, s13, 0
    s_add_u32 m0, s24, 1024
    s_nop 0
    global_load_lds_dwordx4 v105, s[22:23]
    s_add_u32 s26, s25, 8192
    s_add_u32 s22, s12, s26
    s_addc_u32 s23, s13, 0
    s_add_u32 m0, s24, 2048
    s_nop 0
    global_load_lds_dwordx4 v105, s[22:23]
    s_add_u32 s26, s25, 10240
    s_add_u32 s22, s12, s26
    s_addc_u32 s23, s13, 0
    s_add_u32 m0, s24, 3072
    s_nop 0
    global_load_lds_dwordx4 v105, s[22:23]
    ds_read_b64_tr_b16 a[16:17], v56 offset:4096
    ds_read_b64_tr_b16 a[18:19], v56 offset:36864
    ds_read_b64_tr_b16 a[20:21], v58 offset:4096
    ds_read_b64_tr_b16 a[22:23], v58 offset:36864
    ds_read_b64_tr_b16 a[24:25], v57 offset:4096
    ds_read_b64_tr_b16 a[26:27], v57 offset:36864
    ds_read_b64_tr_b16 a[28:29], v59 offset:4096
    ds_read_b64_tr_b16 a[30:31], v59 offset:36864
    s_waitcnt lgkmcnt(0)
    s_waitcnt vmcnt(24)
    s_barrier
    s_xor_b32 s25, s19, 0
    s_lshl_b32 s25, s25, 15
    s_add_u32 s26, s25, 128
    s_add_u32 s22, s12, s26
    s_addc_u32 s23, s13, 0
    s_add_u32 m0, s24, 4096
    s_nop 0
    global_load_lds_dwordx4 v105, s[22:23]
    s_add_u32 s26, s25, 2176
    s_add_u32 s22, s12, s26
    s_addc_u32 s23, s13, 0
    s_add_u32 m0, s24, 5120
    s_nop 0
    global_load_lds_dwordx4 v105, s[22:23]
    s_add_u32 s26, s25, 8320
    s_add_u32 s22, s12, s26
    s_addc_u32 s23, s13, 0
    s_add_u32 m0, s24, 6144
    s_nop 0
    global_load_lds_dwordx4 v105, s[22:23]
    s_add_u32 s26, s25, 10368
    s_add_u32 s22, s12, s26
    s_addc_u32 s23, s13, 0
    s_add_u32 m0, s24, 7168
    s_nop 0
    global_load_lds_dwordx4 v105, s[22:23]
    ds_read_b64_tr_b16 v[192:193], v56 offset:8192
    ds_read_b64_tr_b16 v[194:195], v56 offset:40960
    ds_read_b64_tr_b16 v[196:197], v58 offset:8192
    ds_read_b64_tr_b16 v[198:199], v58 offset:40960
    ds_read_b64_tr_b16 v[200:201], v57 offset:8192
    ds_read_b64_tr_b16 v[202:203], v57 offset:40960
    ds_read_b64_tr_b16 v[204:205], v59 offset:8192
    ds_read_b64_tr_b16 v[206:207], v59 offset:40960
    s_mov_b32 s21, 0
Lc_tb1:
    v_and_b32 v99, 0x01010101, v103
    v_cmp_ne_u32 vcc, 0x01010101, v99
    s_and_b32 s25, vcc_lo, 16777215
    s_and_b32 s26, vcc_hi, 256
    s_or_b32 s25, s25, s26
    s_cbranch_scc0 Lc_tbo1
    s_sleep 4
    global_load_dword v103, v102, s[14:15] sc1
    s_add_u32 s21, s21, 1
    s_cmp_gt_u32 s21, 200000
    s_cbranch_scc1 Lc_end
    s_waitcnt vmcnt(0)
    s_branch Lc_tb1
Lc_tbo1:
    v_cmp_ne_u32 vcc, s3, v103
    s_and_b32 s3, vcc_lo, 0xff
    s_waitcnt lgkmcnt(0)
    s_waitcnt vmcnt(24)
    s_barrier
    s_xor_b32 s25, s19, 1
    s_lshl_b32 s25, s25, 15
    s_add_u32 s26, s25, 0
    s_add_u32 s22, s12, s26
    s_addc_u32 s23, s13, 0
    s_add_u32 m0, s24, 8192
    s_nop 0
    global_load_lds_dwordx4 v105, s[22:23]
    s_add_u32 s26, s25, 2048
    s_add_u32 s22, s12, s26
    s_addc_u32 s23, s13, 0
    s_add_u32 m0, s24, 9216
    s_nop 0
    global_load_lds_dwordx4 v105, s[22:23]
    s_add_u32 s26, s25, 8192
    s_add_u32 s22, s12, s26
    s_addc_u32 s23, s13, 0
    s_add_u32 m0, s24, 10240
    s_nop 0
    global_load_lds_dwordx4 v105, s[22:23]
    s_add_u32 s26, s25, 10240
    s_add_u32 s22, s12, s26
    s_addc_u32 s23, s13, 0
    s_add_u32 m0, s24, 11264
    s_nop 0
    global_load_lds_dwordx4 v105, s[22:23]
    ds_read_b64_tr_b16 v[208:209], v56 offset:12288
    ds_read_b64_tr_b16 v[210:211], v56 offset:45056
    ds_read_b64_tr_b16 v[212:213], v58 offset:12288
    ds_read_b64_tr_b16 v[214:215], v58 offset:45056
    ds_read_b64_tr_b16 v[216:217], v57 offset:12288
    ds_read_b64_tr_b16 v[218:219], v57 offset:45056
    ds_read_b64_tr_b16 v[220:221], v59 offset:12288
    ds_read_b64_tr_b16 v[222:223], v59 offset:45056
    s_waitcnt lgkmcnt(0)
    s_waitcnt vmcnt(24)
    s_barrier
    s_xor_b32 s25, s19, 1
    s_lshl_b32 s25, s25, 15
    s_add_u32 s26, s25, 128
    s_add_u32 s22, s12, s26
    s_addc_u32 s23, s13, 0
    s_add_u32 m0, s24, 12288
    s_nop 0
    global_load_lds_dwordx4 v105, s[22:23]
    s_add_u32 s26, s25, 2176
    s_add_u32 s22, s12, s26
    s_addc_u32 s23, s13, 0
    s_add_u32 m0, s24, 13312
    s_nop 0
    global_load_lds_dwordx4 v105, s[22:23]
    s_add_u32 s26, s25, 8320
    s_add_u32 s22, s12, s26
    s_addc_u32 s23, s13, 0
    s_add_u32 m0, s24, 14336
    s_nop 0
    global_load_lds_dwordx4 v105, s[22:23]
    s_add_u32 s26, s25, 10368
    s_add_u32 s22, s12, s26
    s_addc_u32 s23, s13, 0
    s_add_u32 m0, s24, 15360
    s_nop 0
    global_load_lds_dwordx4 v105, s[22:23]
    ds_read_b64_tr_b16 a[64:65], v56 offset:16384
    ds_read_b64_tr_b16 a[66:67], v56 offset:49152
    ds_read_b64_tr_b16 a[68:69], v58 offset:16384
    ds_read_b64_tr_b16 a[70:71], v58 offset:49152
    ds_read_b64_tr_b16 a[72:73], v57 offset:16384
    ds_read_b64_tr_b16 a[74:75], v57 offset:49152
    ds_read_b64_tr_b16 a[76:77], v59 offset:16384
    ds_read_b64_tr_b16 a[78:79], v59 offset:49152
    s_waitcnt lgkmcnt(0)
    s_waitcnt vmcnt(24)
    s_barrier
    s_xor_b32 s25, s19, 2
    s_lshl_b32 s25, s25, 15
    s_add_u32 s26, s25, 0
    s_add_u32 s22, s12, s26
    s_addc_u32 s23, s13, 0
    s_add_u32 m0, s24, 16384
    s_nop 0
    global_load_lds_dwordx4 v105, s[22:23]
    s_add_u32 s26, s25, 2048
    s_add_u32 s22, s12, s26
    s_addc_u32 s23, s13, 0
    s_add_u32 m0, s24, 17408
    s_nop 0
    global_load_lds_dwordx4 v105, s[22:23]
    s_add_u32 s26, s25, 8192
    s_add_u32 s22, s12, s26
    s_addc_u32 s23, s13, 0
    s_add_u32 m0, s24, 18432
    s_nop 0
    global_load_lds_dwordx4 v105, s[22:23]
    s_add_u32 s26, s25, 10240
    s_add_u32 s22, s12, s26
    s_addc_u32 s23, s13, 0
    s_add_u32 m0, s24, 19456
    s_nop 0
    global_load_lds_dwordx4 v105, s[22:23]
    ds_read_b64_tr_b16 a[80:81], v56 offset:20480
    ds_read_b64_tr_b16 a[82:83], v56 offset:53248
    ds_read_b64_tr_b16 a[84:85], v58 offset:20480
    ds_read_b64_tr_b16 a[86:87], v58 offset:53248
    ds_read_b64_tr_b16 a[88:89], v57 offset:20480
    ds_read_b64_tr_b16 a[90:91], v57 offset:53248
    ds_read_b64_tr_b16 a[92:93], v59 offset:20480
    ds_read_b64_tr_b16 a[94:95], v59 offset:53248
    s_waitcnt lgkmcnt(0)
    s_waitcnt vmcnt(24)
    s_barrier
    s_xor_b32 s25, s19, 2
    s_lshl_b32 s25, s25, 15
    s_add_u32 s26, s25, 128
    s_add_u32 s22, s12, s26
    s_addc_u32 s23, s13, 0
    s_add_u32 m0, s24, 20480
    s_nop 0
    global_load_lds_dwordx4 v105, s[22:23]
    s_add_u32 s26, s25, 2176
    s_add_u32 s22, s12, s26
    s_addc_u32 s23, s13, 0
    s_add_u32 m0, s24, 21504
    s_nop 0
    global_load_lds_dwordx4 v105, s[22:23]
    s_add_u32 s26, s25, 8320
    s_add_u32 s22, s12, s26
    s_addc_u32 s23, s13, 0
    s_add_u32 m0, s24, 22528
    s_nop 0
    global_load_lds_dwordx4 v105, s[22:23]
    s_add_u32 s26, s25, 10368
    s_add_u32 s22, s12, s26
    s_addc_u32 s23, s13, 0
    s_add_u32 m0, s24, 23552
    s_nop 0
    global_load_lds_dwordx4 v105, s[22:23]
    ds_read_b64_tr_b16 a[32:33], v56 offset:24576
    ds_read_b64_tr_b16 a[34:35], v56 offset:57344
    ds_read_b64_tr_b16 a[36:37], v58 offset:24576
    ds_read_b64_tr_b16 a[38:39], v58 offset:57344
    ds_read_b64_tr_b16 a[40:41], v57 offset:24576
    ds_read_b64_tr_b16 a[42:43], v57 offset:57344
    ds_read_b64_tr_b16 a[44:45], v59 offset:24576
    ds_read_b64_tr_b16 a[46:47], v59 offset:57344
    v_lshlrev_b32 v99, 7, v97
    v_and_b32 v101, 1, v98
    v_lshl_add_u32 v100, v101, 18, v99
    global_load_dword v103, v100, s[48:49] sc1
    v_lshl_add_u32 v99, v101, 13, v99
    global_load_dword v103, v99, s[50:51] sc1
    global_load_dword v48, v102, s[84:85] sc1
    s_waitcnt lgkmcnt(0)
    s_waitcnt vmcnt(27)
    s_barrier
    s_xor_b32 s25, s19, 3
    s_lshl_b32 s25, s25, 15
    s_add_u32 s26, s25, 0
    s_add_u32 s22, s12, s26
    s_addc_u32 s23, s13, 0
    s_add_u32 m0, s24, 24576
    s_nop 0
    global_load_lds_dwordx4 v105, s[22:23]
    s_add_u32 s26, s25, 2048
    s_add_u32 s22, s12, s26
    s_addc_u32 s23, s13, 0
    s_add_u32 m0, s24, 25600
    s_nop 0
    global_load_lds_dwordx4 v105, s[22:23]
    s_add_u32 s26, s25, 8192
    s_add_u32 s22, s12, s26
    s_addc_u32 s23, s13, 0
    s_add_u32 m0, s24, 26624
    s_nop 0
    global_load_lds_dwordx4 v105, s[22:23]
    s_add_u32 s26, s25, 10240
    s_add_u32 s22, s12, s26
    s_addc_u32 s23, s13, 0
    s_add_u32 m0, s24, 27648
    s_nop 0
    global_load_lds_dwordx4 v105, s[22:23]
    ds_read_b64_tr_b16 a[48:49], v56 offset:28672
    ds_read_b64_tr_b16 a[50:51], v56 offset:61440
    ds_read_b64_tr_b16 a[52:53], v58 offset:28672
    ds_read_b64_tr_b16 a[54:55], v58 offset:61440
    ds_read_b64_tr_b16 a[56:57], v57 offset:28672
    ds_read_b64_tr_b16 a[58:59], v57 offset:61440
    ds_read_b64_tr_b16 a[60:61], v59 offset:28672
    ds_read_b64_tr_b16 a[62:63], v59 offset:61440
    s_waitcnt lgkmcnt(0)
    s_branch Lc_pwe
Lc_pw2:
    s_waitcnt vmcnt(28)
    s_barrier
    ds_read_b64_tr_b16 a[144:145], v56 offset:0
    ds_read_b64_tr_b16 a[146:147], v56 offset:32768
    ds_read_b64_tr_b16 a[148:149], v58 offset:0
    ds_read_b64_tr_b16 a[150:151], v58 offset:32768
    ds_read_b64_tr_b16 a[152:153], v57 offset:0
    ds_read_b64_tr_b16 a[154:155], v57 offset:32768
    ds_read_b64_tr_b16 a[156:157], v59 offset:0
    ds_read_b64_tr_b16 a[158:159], v59 offset:32768
    ds_read_u16 v64, v100 offset:0
    ds_read_u16 v65, v100 offset:2
    ds_read_u16 v66, v100 offset:8
    ds_read_u16 v67, v100 offset:10
    ds_read_u16 v68, v100 offset:16
    ds_read_u16 v69, v100 offset:18
    ds_read_u16 v70, v100 offset:24
    ds_read_u16 v71, v100 offset:26
    ds_read_u16 v72, v100 offset:128
    ds_read_u16 v73, v100 offset:130
    ds_read_u16 v74, v100 offset:136
    ds_read_u16 v75, v100 offset:138
    ds_read_u16 v76, v100 offset:144
    ds_read_u16 v77, v100 offset:146
    ds_read_u16 v78, v100 offset:152
    ds_read_u16 v79, v100 offset:154
    s_waitcnt lgkmcnt(0)
    s_waitcnt vmcnt(24)
    s_barrier
    s_add_u32 s22, s10, 0
    s_addc_u32 s23, s11, 0
    s_add_u32 m0, s24, 0
    s_bitcmp0_b32 0xa2222222, s18
    s_cbranch_scc1 Lc_nta33
    global_load_lds_dwordx4 v52, s[22:23] offset:0
    global_load_lds_dwordx4 v53, s[22:23] offset:1024
    global_load_lds_dwordx4 v54, s[22:23] offset:2048
    global_load_lds_dwordx4 v55, s[22:23] offset:3072
    s_branch Lc_ntb33
Lc_nta33:
    s_waitcnt vmcnt(5)
    global_load_lds_dwordx4 v52, s[22:23] offset:0
    s_waitcnt vmcnt(5)
    global_load_lds_dwordx4 v53, s[22:23] offset:1024
    s_waitcnt vmcnt(5)
    global_load_lds_dwordx4 v54, s[22:23] offset:2048
    s_waitcnt vmcnt(5)
    global_load_lds_dwordx4 v55, s[22:23] offset:3072
Lc_ntb33:
    ds_read_b64_tr_b16 a[160:161], v56 offset:4096
    ds_read_b64_tr_b16 a[162:163], v56 offset:36864
    ds_read_b64_tr_b16 a[164:165], v58 offset:4096
    ds_read_b64_tr_b16 a[166:167], v58 offset:36864
    ds_read_b64_tr_b16 a[168:169], v57 offset:4096
    ds_read_b64_tr_b16 a[170:171], v57 offset:36864
    ds_read_b64_tr_b16 a[172:173], v59 offset:4096
    ds_read_b64_tr_b16 a[174:175], v59 offset:36864
    v_lshl_or_b32 v0, v65, 16, v64
    v_lshl_or_b32 v1, v67, 16, v66
    v_lshl_or_b32 v2, v69, 16, v68
    v_lshl_or_b32 v3, v71, 16, v70
    v_lshl_or_b32 v4, v73, 16, v72
    v_lshl_or_b32 v5, v75, 16, v74
    v_lshl_or_b32 v6, v77, 16, v76
    v_lshl_or_b32 v7, v79, 16, v78
    s_waitcnt lgkmcnt(0)
    s_waitcnt vmcnt(24)
    s_barrier
    s_add_u32 s22, s10, 524288
    s_addc_u32 s23, s11, 0
    s_add_u32 m0, s24, 4096
    s_bitcmp0_b32 0xa2222222, s18
    s_cbranch_scc1 Lc_nta34
    global_load_lds_dwordx4 v52, s[22:23] offset:0
    global_load_lds_dwordx4 v53, s[22:23] offset:1024
    global_load_lds_dwordx4 v54, s[22:23] offset:2048
    global_load_lds_dwordx4 v55, s[22:23] offset:3072
    s_branch Lc_ntb34
Lc_nta34:
    s_waitcnt vmcnt(5)
    global_load_lds_dwordx4 v52, s[22:23] offset:0
    s_waitcnt vmcnt(5)
    global_load_lds_dwordx4 v53, s[22:23] offset:1024
    s_waitcnt vmcnt(5)
    global_load_lds_dwordx4 v54, s[22:23] offset:2048
    s_waitcnt vmcnt(5)
    global_load_lds_dwordx4 v55, s[22:23] offset:3072
Lc_ntb34:
    ds_read_b64_tr_b16 v[240:241], v56 offset:8192
    ds_read_b64_tr_b16 v[242:243], v56 offset:40960
    ds_read_b64_tr_b16 v[244:245], v58 offset:8192
    ds_read_b64_tr_b16 v[246:247], v58 offset:40960
    ds_read_b64_tr_b16 v[248:249], v57 offset:8192
    ds_read_b64_tr_b16 v[250:251], v57 offset:40960
    ds_read_b64_tr_b16 v[252:253], v59 offset:8192
    ds_read_b64_tr_b16 v[254:255], v59 offset:40960
    s_waitcnt lgkmcnt(0)
    s_waitcnt vmcnt(24)
    s_barrier
    s_add_u32 s22, s10, 1048576
    s_addc_u32 s23, s11, 0
    s_add_u32 m0, s24, 8192
    s_bitcmp0_b32 0xa2222222, s18
    s_cbranch_scc1 Lc_nta35
    global_load_lds_dwordx4 v52, s[22:23] offset:0
    global_load_lds_dwordx4 v53, s[22:23] offset:1024
    global_load_lds_dwordx4 v54, s[22:23] offset:2048
    global_load_lds_dwordx4 v55, s[22:23] offset:3072
    s_branch Lc_ntb35
Lc_nta35:
    s_waitcnt vmcnt(5)
    global_load_lds_dwordx4 v52, s[22:23] offset:0
    s_waitcnt vmcnt(5)
    global_load_lds_dwordx4 v53, s[22:23] offset:1024
    s_waitcnt vmcnt(5)
    global_load_lds_dwordx4 v54, s[22:23] offset:2048
    s_waitcnt vmcnt(5)
    global_load_lds_dwordx4 v55, s[22:23] offset:3072
Lc_ntb35:
    ds_read_b64_tr_b16 v[80:81], v56 offset:12288
    ds_read_b64_tr_b16 v[82:83], v56 offset:45056
    ds_read_b64_tr_b16 v[84:85], v58 offset:12288
    ds_read_b64_tr_b16 v[86:87], v58 offset:45056
    ds_read_b64_tr_b16 v[88:89], v57 offset:12288
    ds_read_b64_tr_b16 v[90:91], v57 offset:45056
    ds_read_b64_tr_b16 v[92:93], v59 offset:12288
    ds_read_b64_tr_b16 v[94:95], v59 offset:45056
    s_waitcnt lgkmcnt(0)
    s_waitcnt vmcnt(24)
    s_barrier
    s_add_u32 s22, s10, 1572864
    s_addc_u32 s23, s11, 0
    s_add_u32 m0, s24, 12288
    s_bitcmp0_b32 0xa2222222, s18
    s_cbranch_scc1 Lc_nta36
    global_load_lds_dwordx4 v52, s[22:23] offset:0
    global_load_lds_dwordx4 v53, s[22:23] offset:1024
    global_load_lds_dwordx4 v54, s[22:23] offset:2048
    global_load_lds_dwordx4 v55, s[22:23] offset:3072
    s_branch Lc_ntb36
Lc_nta36:
    s_waitcnt vmcnt(5)
    global_load_lds_dwordx4 v52, s[22:23] offset:0
    s_waitcnt vmcnt(5)
    global_load_lds_dwordx4 v53, s[22:23] offset:1024
    s_waitcnt vmcnt(5)
    global_load_lds_dwordx4 v54, s[22:23] offset:2048
    s_waitcnt vmcnt(5)
    global_load_lds_dwordx4 v55, s[22:23] offset:3072
Lc_ntb36:
    ds_read_b64_tr_b16 v[224:225], v56 offset:16384
    ds_read_b64_tr_b16 v[226:227], v56 offset:49152
    ds_read_b64_tr_b16 v[228:229], v58 offset:16384
    ds_read_b64_tr_b16 v[230:231], v58 offset:49152
    ds_read_b64_tr_b16 v[232:233], v57 offset:16384
    ds_read_b64_tr_b16 v[234:235], v57 offset:49152
    ds_read_b64_tr_b16 v[236:237], v59 offset:16384
    ds_read_b64_tr_b16 v[238:239], v59 offset:49152
    s_waitcnt lgkmcnt(0)
    s_waitcnt vmcnt(24)
    s_barrier
    s_add_u32 s22, s10, 2097152
    s_addc_u32 s23, s11, 0
    s_add_u32 m0, s24, 16384
    s_bitcmp0_b32 0xa2222222, s18
    s_cbranch_scc1 Lc_nta37
    global_load_lds_dwordx4 v52, s[22:23] offset:0
    global_load_lds_dwordx4 v53, s[22:23] offset:1024
    global_load_lds_dwordx4 v54, s[22:23] offset:2048
    global_load_lds_dwordx4 v55, s[22:23] offset:3072
    s_branch Lc_ntb37
Lc_nta37:
    s_waitcnt vmcnt(5)
    global_load_lds_dwordx4 v52, s[22:23] offset:0
    s_waitcnt vmcnt(5)
    global_load_lds_dwordx4 v53, s[22:23] offset:1024
    s_waitcnt vmcnt(5)
    global_load_lds_dwordx4 v54, s[22:23] offset:2048
    s_waitcnt vmcnt(5)
    global_load_lds_dwordx4 v55, s[22:23] offset:3072
Lc_ntb37:
    ds_read_b64_tr_b16 a[96:97], v56 offset:20480
    ds_read_b64_tr_b16 a[98:99], v56 offset:53248
    ds_read_b64_tr_b16 a[100:101], v58 offset:20480
    ds_read_b64_tr_b16 a[102:103], v58 offset:53248
    ds_read_b64_tr_b16 a[104:105], v57 offset:20480
    ds_read_b64_tr_b16 a[106:107], v57 offset:53248
    ds_read_b64_tr_b16 a[108:109], v59 offset:20480
    ds_read_b64_tr_b16 a[110:111], v59 offset:53248
    s_waitcnt lgkmcnt(0)
    s_waitcnt vmcnt(24)
    s_barrier
    s_add_u32 s22, s10, 2621440
    s_addc_u32 s23, s11, 0
    s_add_u32 m0, s24, 20480
    s_bitcmp0_b32 0xa2222222, s18
    s_cbranch_scc1 Lc_nta38
    global_load_lds_dwordx4 v52, s[22:23] offset:0
    global_load_lds_dwordx4 v53, s[22:23] offset:1024
    global_load_lds_dwordx4 v54, s[22:23] offset:2048
    global_load_lds_dwordx4 v55, s[22:23] offset:3072
    s_branch Lc_ntb38
Lc_nta38:
    s_waitcnt vmcnt(5)
    global_load_lds_dwordx4 v52, s[22:23] offset:0
    s_waitcnt vmcnt(5)
    global_load_lds_dwordx4 v53, s[22:23] offset:1024
    s_waitcnt vmcnt(5)
    global_load_lds_dwordx4 v54, s[22:23] offset:2048
    s_waitcnt vmcnt(5)
    global_load_lds_dwordx4 v55, s[22:23] offset:3072
Lc_ntb38:
    ds_read_b64_tr_b16 a[112:113], v56 offset:24576
    ds_read_b64_tr_b16 a[114:115], v56 offset:57344
    ds_read_b64_tr_b16 a[116:117], v58 offset:24576
    ds_read_b64_tr_b16 a[118:119], v58 offset:57344
    ds_read_b64_tr_b16 a[120:121], v57 offset:24576
    ds_read_b64_tr_b16 a[122:123], v57 offset:57344
    ds_read_b64_tr_b16 a[124:125], v59 offset:24576
    ds_read_b64_tr_b16 a[126:127], v59 offset:57344
    s_waitcnt lgkmcnt(0)
    s_waitcnt vmcnt(24)
    s_barrier
    s_add_u32 s22, s10, 3145728
    s_addc_u32 s23, s11, 0
    s_add_u32 m0, s24, 24576
    s_bitcmp0_b32 0xa2222222, s18
    s_cbranch_scc1 Lc_nta39
    global_load_lds_dwordx4 v52, s[22:23] offset:0
    global_load_lds_dwordx4 v53, s[22:23] offset:1024
    global_load_lds_dwordx4 v54, s[22:23] offset:2048
    global_load_lds_dwordx4 v55, s[22:23] offset:3072
    s_branch Lc_ntb39
Lc_nta39:
    s_waitcnt vmcnt(5)
    global_load_lds_dwordx4 v52, s[22:23] offset:0
    s_waitcnt vmcnt(5)
    global_load_lds_dwordx4 v53, s[22:23] offset:1024
    s_waitcnt vmcnt(5)
    global_load_lds_dwordx4 v54, s[22:23] offset:2048
    s_waitcnt vmcnt(5)
    global_load_lds_dwordx4 v55, s[22:23] offset:3072
Lc_ntb39:
    ds_read_b64_tr_b16 a[128:129], v56 offset:28672
    ds_read_b64_tr_b16 a[130:131], v56 offset:61440
    ds_read_b64_tr_b16 a[132:133], v58 offset:28672
    ds_read_b64_tr_b16 a[134:135], v58 offset:61440
    ds_read_b64_tr_b16 a[136:137], v57 offset:28672
    ds_read_b64_tr_b16 a[138:139], v57 offset:61440
    ds_read_b64_tr_b16 a[140:141], v59 offset:28672
    ds_read_b64_tr_b16 a[142:143], v59 offset:61440
    s_waitcnt lgkmcnt(0)
    s_waitcnt vmcnt(24)
    s_barrier
    s_add_u32 s22, s10, 3670016
    s_addc_u32 s23, s11, 0
    s_add_u32 m0, s24, 28672
    s_bitcmp0_b32 0xa2222222, s18
    s_cbranch_scc1 Lc_nta40
    global_load_lds_dwordx4 v52, s[22:23] offset:0
    global_load_lds_dwordx4 v53, s[22:23] offset:1024
    global_load_lds_dwordx4 v54, s[22:23] offset:2048
    global_load_lds_dwordx4 v55, s[22:23] offset:3072
    s_branch Lc_ntb40
Lc_nta40:
    s_waitcnt vmcnt(5)
    global_load_lds_dwordx4 v52, s[22:23] offset:0
    s_waitcnt vmcnt(5)
    global_load_lds_dwordx4 v53, s[22:23] offset:1024
    s_waitcnt vmcnt(5)
    global_load_lds_dwordx4 v54, s[22:23] offset:2048
    s_waitcnt vmcnt(5)
    global_load_lds_dwordx4 v55, s[22:23] offset:3072
Lc_ntb40:
    ds_read_b64_tr_b16 a[240:241], v56 offset:0
    ds_read_b64_tr_b16 a[242:243], v56 offset:32768
    ds_read_b64_tr_b16 a[244:245], v58 offset:0
    ds_read_b64_tr_b16 a[246:247], v58 offset:32768
    ds_read_b64_tr_b16 a[248:249], v57 offset:0
    ds_read_b64_tr_b16 a[250:251], v57 offset:32768
    ds_read_b64_tr_b16 a[252:253], v59 offset:0
    ds_read_b64_tr_b16 a[254:255], v59 offset:32768
    s_waitcnt lgkmcnt(0)
    s_waitcnt vmcnt(24)
    s_barrier
    s_add_u32 s22, s6, 0
    s_addc_u32 s23, s7, 0
    s_add_u32 m0, s24, 0
    s_bitcmp0_b32 0xa2222222, s18
    s_cbranch_scc1 Lc_nta41
    global_load_lds_dwordx4 v52, s[22:23] offset:0
    global_load_lds_dwordx4 v53, s[22:23] offset:1024
    global_load_lds_dwordx4 v54, s[22:23] offset:2048
    global_load_lds_dwordx4 v55, s[22:23] offset:3072
    s_branch Lc_ntb41
Lc_nta41:
    s_waitcnt vmcnt(5)
    global_load_lds_dwordx4 v52, s[22:23] offset:0
    s_waitcnt vmcnt(5)
    global_load_lds_dwordx4 v53, s[22:23] offset:1024
    s_waitcnt vmcnt(5)
    global_load_lds_dwordx4 v54, s[22:23] offset:2048
    s_waitcnt vmcnt(5)
    global_load_lds_dwordx4 v55, s[22:23] offset:3072
Lc_ntb41:
    ds_read_b64_tr_b16 v[128:129], v56 offset:4096
    ds_read_b64_tr_b16 v[130:131], v56 offset:36864
    ds_read_b64_tr_b16 v[132:133], v58 offset:4096
    ds_read_b64_tr_b16 v[134:135], v58 offset:36864
    ds_read_b64_tr_b16 v[136:137], v57 offset:4096
    ds_read_b64_tr_b16 v[138:139], v57 offset:36864
    ds_read_b64_tr_b16 v[140:141], v59 offset:4096
    ds_read_b64_tr_b16 v[142:143], v59 offset:36864
    s_waitcnt lgkmcnt(0)
    s_waitcnt vmcnt(24)
    s_barrier
    s_add_u32 s22, s6, 524288
    s_addc_u32 s23, s7, 0
    s_add_u32 m0, s24, 4096
    s_bitcmp0_b32 0xa2222222, s18
    s_cbranch_scc1 Lc_nta42
    global_load_lds_dwordx4 v52, s[22:23] offset:0
    global_load_lds_dwordx4 v53, s[22:23] offset:1024
    global_load_lds_dwordx4 v54, s[22:23] offset:2048
    global_load_lds_dwordx4 v55, s[22:23] offset:3072
    s_branch Lc_ntb42
Lc_nta42:
    s_waitcnt vmcnt(5)
    global_load_lds_dwordx4 v52, s[22:23] offset:0
    s_waitcnt vmcnt(5)
    global_load_lds_dwordx4 v53, s[22:23] offset:1024
    s_waitcnt vmcnt(5)
    global_load_lds_dwordx4 v54, s[22:23] offset:2048
    s_waitcnt vmcnt(5)
    global_load_lds_dwordx4 v55, s[22:23] offset:3072
Lc_ntb42:
    ds_read_b64_tr_b16 v[144:145], v56 offset:8192
    ds_read_b64_tr_b16 v[146:147], v56 offset:40960
    ds_read_b64_tr_b16 v[148:149], v58 offset:8192
    ds_read_b64_tr_b16 v[150:151], v58 offset:40960
    ds_read_b64_tr_b16 v[152:153], v57 offset:8192
    ds_read_b64_tr_b16 v[154:155], v57 offset:40960
    ds_read_b64_tr_b16 v[156:157], v59 offset:8192
    ds_read_b64_tr_b16 v[158:159], v59 offset:40960
    global_load_dword v103, v102, s[14:15] sc1
    s_waitcnt lgkmcnt(0)
    s_waitcnt vmcnt(25)
    s_barrier
    s_add_u32 s22, s6, 1048576
    s_addc_u32 s23, s7, 0
    s_add_u32 m0, s24, 8192
    s_bitcmp0_b32 0xa2222222, s18
    s_cbranch_scc1 Lc_nta43
    global_load_lds_dwordx4 v52, s[22:23] offset:0
    global_load_lds_dwordx4 v53, s[22:23] offset:1024
    global_load_lds_dwordx4 v54, s[22:23] offset:2048
    global_load_lds_dwordx4 v55, s[22:23] offset:3072
    s_branch Lc_ntb43
Lc_nta43:
    s_waitcnt vmcnt(5)
    global_load_lds_dwordx4 v52, s[22:23] offset:0
    s_waitcnt vmcnt(5)
    global_load_lds_dwordx4 v53, s[22:23] offset:1024
    s_waitcnt vmcnt(5)
    global_load_lds_dwordx4 v54, s[22:23] offset:2048
    s_waitcnt vmcnt(5)
    global_load_lds_dwordx4 v55, s[22:23] offset:3072
Lc_ntb43:
    ds_read_b64_tr_b16 v[160:161], v56 offset:12288
    ds_read_b64_tr_b16 v[162:163], v56 offset:45056
    ds_read_b64_tr_b16 v[164:165], v58 offset:12288
    ds_read_b64_tr_b16 v[166:167], v58 offset:45056
    ds_read_b64_tr_b16 v[168:169], v57 offset:12288
    ds_read_b64_tr_b16 v[170:171], v57 offset:45056
    ds_read_b64_tr_b16 v[172:173], v59 offset:12288
    ds_read_b64_tr_b16 v[174:175], v59 offset:45056
    s_waitcnt lgkmcnt(0)
    s_waitcnt vmcnt(25)
    s_barrier
    s_add_u32 s22, s6, 1572864
    s_addc_u32 s23, s7, 0
    s_add_u32 m0, s24, 12288
    s_bitcmp0_b32 0xa2222222, s18
    s_cbranch_scc1 Lc_nta44
    global_load_lds_dwordx4 v52, s[22:23] offset:0
    global_load_lds_dwordx4 v53, s[22:23] offset:1024
    global_load_lds_dwordx4 v54, s[22:23] offset:2048
    global_load_lds_dwordx4 v55, s[22:23] offset:3072
    s_branch Lc_ntb44
Lc_nta44:
    s_waitcnt vmcnt(5)
    global_load_lds_dwordx4 v52, s[22:23] offset:0
    s_waitcnt vmcnt(5)
    global_load_lds_dwordx4 v53, s[22:23] offset:1024
    s_waitcnt vmcnt(5)
    global_load_lds_dwordx4 v54, s[22:23] offset:2048
    s_waitcnt vmcnt(5)
    global_load_lds_dwordx4 v55, s[22:23] offset:3072
Lc_ntb44:
    ds_read_b64_tr_b16 a[176:177], v56 offset:16384
    ds_read_b64_tr_b16 a[178:179], v56 offset:49152
    ds_read_b64_tr_b16 a[180:181], v58 offset:16384
    ds_read_b64_tr_b16 a[182:183], v58 offset:49152
    ds_read_b64_tr_b16 a[184:185], v57 offset:16384
    ds_read_b64_tr_b16 a[186:187], v57 offset:49152
    ds_read_b64_tr_b16 a[188:189], v59 offset:16384
    ds_read_b64_tr_b16 a[190:191], v59 offset:49152
    s_waitcnt lgkmcnt(0)
    s_waitcnt vmcnt(25)
    s_barrier
    s_add_u32 s22, s6, 2097152
    s_addc_u32 s23, s7, 0
    s_add_u32 m0, s24, 16384
    s_bitcmp0_b32 0xa2222222, s18
    s_cbranch_scc1 Lc_nta45
    global_load_lds_dwordx4 v52, s[22:23] offset:0
    global_load_lds_dwordx4 v53, s[22:23] offset:1024
    global_load_lds_dwordx4 v54, s[22:23] offset:2048
    global_load_lds_dwordx4 v55, s[22:23] offset:3072
    s_branch Lc_ntb45
Lc_nta45:
    s_waitcnt vmcnt(5)
    global_load_lds_dwordx4 v52, s[22:23] offset:0
    s_waitcnt vmcnt(5)
    global_load_lds_dwordx4 v53, s[22:23] offset:1024
    s_waitcnt vmcnt(5)
    global_load_lds_dwordx4 v54, s[22:23] offset:2048
    s_waitcnt vmcnt(5)
    global_load_lds_dwordx4 v55, s[22:23] offset:3072
Lc_ntb45:
    ds_read_b64_tr_b16 a[192:193], v56 offset:20480
    ds_read_b64_tr_b16 a[194:195], v56 offset:53248
    ds_read_b64_tr_b16 a[196:197], v58 offset:20480
    ds_read_b64_tr_b16 a[198:199], v58 offset:53248
    ds_read_b64_tr_b16 a[200:201], v57 offset:20480
    ds_read_b64_tr_b16 a[202:203], v57 offset:53248
    ds_read_b64_tr_b16 a[204:205], v59 offset:20480
    ds_read_b64_tr_b16 a[206:207], v59 offset:53248
    s_waitcnt lgkmcnt(0)
    s_waitcnt vmcnt(25)
    s_barrier
    s_add_u32 s22, s6, 2621440
    s_addc_u32 s23, s7, 0
    s_add_u32 m0, s24, 20480
    s_bitcmp0_b32 0xa2222222, s18
    s_cbranch_scc1 Lc_nta46
    global_load_lds_dwordx4 v52, s[22:23] offset:0
    global_load_lds_dwordx4 v53, s[22:23] offset:1024
    global_load_lds_dwordx4 v54, s[22:23] offset:2048
    global_load_lds_dwordx4 v55, s[22:23] offset:3072
    s_branch Lc_ntb46
Lc_nta46:
    s_waitcnt vmcnt(5)
    global_load_lds_dwordx4 v52, s[22:23] offset:0
    s_waitcnt vmcnt(5)
    global_load_lds_dwordx4 v53, s[22:23] offset:1024
    s_waitcnt vmcnt(5)
    global_load_lds_dwordx4 v54, s[22:23] offset:2048
    s_waitcnt vmcnt(5)
    global_load_lds_dwordx4 v55, s[22:23] offset:3072
Lc_ntb46:
    ds_read_b64_tr_b16 a[208:209], v56 offset:24576
    ds_read_b64_tr_b16 a[210:211], v56 offset:57344
    ds_read_b64_tr_b16 a[212:213], v58 offset:24576
    ds_read_b64_tr_b16 a[214:215], v58 offset:57344
    ds_read_b64_tr_b16 a[216:217], v57 offset:24576
    ds_read_b64_tr_b16 a[218:219], v57 offset:57344
    ds_read_b64_tr_b16 a[220:221], v59 offset:24576
    ds_read_b64_tr_b16 a[222:223], v59 offset:57344
    s_waitcnt lgkmcnt(0)
    s_waitcnt vmcnt(25)
    s_barrier
    s_add_u32 s22, s6, 3145728
    s_addc_u32 s23, s7, 0
    s_add_u32 m0, s24, 24576
    s_bitcmp0_b32 0xa2222222, s18
    s_cbranch_scc1 Lc_nta47
    global_load_lds_dwordx4 v52, s[22:23] offset:0
    global_load_lds_dwordx4 v53, s[22:23] offset:1024
    global_load_lds_dwordx4 v54, s[22:23] offset:2048
    global_load_lds_dwordx4 v55, s[22:23] offset:3072
    s_branch Lc_ntb47
Lc_nta47:
    s_waitcnt vmcnt(5)
    global_load_lds_dwordx4 v52, s[22:23] offset:0
    s_waitcnt vmcnt(5)
    global_load_lds_dwordx4 v53, s[22:23] offset:1024
    s_waitcnt vmcnt(5)
    global_load_lds_dwordx4 v54, s[22:23] offset:2048
    s_waitcnt vmcnt(5)
    global_load_lds_dwordx4 v55, s[22:23] offset:3072
Lc_ntb47:
    ds_read_b64_tr_b16 a[224:225], v56 offset:28672
    ds_read_b64_tr_b16 a[226:227], v56 offset:61440
    ds_read_b64_tr_b16 a[228:229], v58 offset:28672
    ds_read_b64_tr_b16 a[230:231], v58 offset:61440
    ds_read_b64_tr_b16 a[232:233], v57 offset:28672
    ds_read_b64_tr_b16 a[234:235], v57 offset:61440
    ds_read_b64_tr_b16 a[236:237], v59 offset:28672
    ds_read_b64_tr_b16 a[238:239], v59 offset:61440
    s_waitcnt lgkmcnt(0)
    s_waitcnt vmcnt(25)
    s_barrier
    s_add_u32 s22, s6, 3670016
    s_addc_u32 s23, s7, 0
    s_add_u32 m0, s24, 28672
    s_bitcmp0_b32 0xa2222222, s18
    s_cbranch_scc1 Lc_nta48
    global_load_lds_dwordx4 v52, s[22:23] offset:0
    global_load_lds_dwordx4 v53, s[22:23] offset:1024
    global_load_lds_dwordx4 v54, s[22:23] offset:2048
    global_load_lds_dwordx4 v55, s[22:23] offset:3072
    s_branch Lc_ntb48
Lc_nta48:
    s_waitcnt vmcnt(5)
    global_load_lds_dwordx4 v52, s[22:23] offset:0
    s_waitcnt vmcnt(5)
    global_load_lds_dwordx4 v53, s[22:23] offset:1024
    s_waitcnt vmcnt(5)
    global_load_lds_dwordx4 v54, s[22:23] offset:2048
    s_waitcnt vmcnt(5)
    global_load_lds_dwordx4 v55, s[22:23] offset:3072
Lc_ntb48:
    ds_read_b64_tr_b16 a[32:33], v56 offset:0
    ds_read_b64_tr_b16 a[34:35], v56 offset:32768
    ds_read_b64_tr_b16 a[36:37], v58 offset:0
    ds_read_b64_tr_b16 a[38:39], v58 offset:32768
    ds_read_b64_tr_b16 a[40:41], v57 offset:0
    ds_read_b64_tr_b16 a[42:43], v57 offset:32768
    ds_read_b64_tr_b16 a[44:45], v59 offset:0
    ds_read_b64_tr_b16 a[46:47], v59 offset:32768
    s_waitcnt lgkmcnt(0)
    s_waitcnt vmcnt(25)
    s_barrier
    s_xor_b32 s25, s19, 0
    s_lshl_b32 s25, s25, 15
    s_add_u32 s26, s25, 0
    s_add_u32 s22, s12, s26
    s_addc_u32 s23, s13, 0
    s_add_u32 m0, s24, 0
    s_nop 0
    global_load_lds_dwordx4 v105, s[22:23]
    s_add_u32 s26, s25, 2048
    s_add_u32 s22, s12, s26
    s_addc_u32 s23, s13, 0
    s_add_u32 m0, s24, 1024
    s_nop 0
    global_load_lds_dwordx4 v105, s[22:23]
    s_add_u32 s26, s25, 8192
    s_add_u32 s22, s12, s26
    s_addc_u32 s23, s13, 0
    s_add_u32 m0, s24, 2048
    s_nop 0
    global_load_lds_dwordx4 v105, s[22:23]
    s_add_u32 s26, s25, 10240
    s_add_u32 s22, s12, s26
    s_addc_u32 s23, s13, 0
    s_add_u32 m0, s24, 3072
    s_nop 0
    global_load_lds_dwordx4 v105, s[22:23]
    ds_read_b64_tr_b16 a[48:49], v56 offset:4096
    ds_read_b64_tr_b16 a[50:51], v56 offset:36864
    ds_read_b64_tr_b16 a[52:53], v58 offset:4096
    ds_read_b64_tr_b16 a[54:55], v58 offset:36864
    ds_read_b64_tr_b16 a[56:57], v57 offset:4096
    ds_read_b64_tr_b16 a[58:59], v57 offset:36864
    ds_read_b64_tr_b16 a[60:61], v59 offset:4096
    ds_read_b64_tr_b16 a[62:63], v59 offset:36864
    s_waitcnt lgkmcnt(0)
    s_waitcnt vmcnt(24)
    s_barrier
    s_xor_b32 s25, s19, 0
    s_lshl_b32 s25, s25, 15
    s_add_u32 s26, s25, 128
    s_add_u32 s22, s12, s26
    s_addc_u32 s23, s13, 0
    s_add_u32 m0, s24, 4096
    s_nop 0
    global_load_lds_dwordx4 v105, s[22:23]
    s_add_u32 s26, s25, 2176
    s_add_u32 s22, s12, s26
    s_addc_u32 s23, s13, 0
    s_add_u32 m0, s24, 5120
    s_nop 0
    global_load_lds_dwordx4 v105, s[22:23]
    s_add_u32 s26, s25, 8320
    s_add_u32 s22, s12, s26
    s_addc_u32 s23, s13, 0
    s_add_u32 m0, s24, 6144
    s_nop 0
    global_load_lds_dwordx4 v105, s[22:23]
    s_add_u32 s26, s25, 10368
    s_add_u32 s22, s12, s26
    s_addc_u32 s23, s13, 0
    s_add_u32 m0, s24, 7168
    s_nop 0
    global_load_lds_dwordx4 v105, s[22:23]
    ds_read_b64_tr_b16 a[64:65], v56 offset:8192
    ds_read_b64_tr_b16 a[66:67], v56 offset:40960
    ds_read_b64_tr_b16 a[68:69], v58 offset:8192
    ds_read_b64_tr_b16 a[70:71], v58 offset:40960
    ds_read_b64_tr_b16 a[72:73], v57 offset:8192
    ds_read_b64_tr_b16 a[74:75], v57 offset:40960
    ds_read_b64_tr_b16 a[76:77], v59 offset:8192
    ds_read_b64_tr_b16 a[78:79], v59 offset:40960
    s_mov_b32 s21, 0
Lc_tb2:
    v_and_b32 v99, 0x01010101, v103
    v_cmp_ne_u32 vcc, 0x01010101, v99
    s_and_b32 s25, vcc_lo, 16777215
    s_and_b32 s26, vcc_hi, 256
    s_or_b32 s25, s25, s26
    s_cbranch_scc0 Lc_tbo2
    s_sleep 4
    global_load_dword v103, v102, s[14:15] sc1
    s_add_u32 s21, s21, 1
    s_cmp_gt_u32 s21, 200000
    s_cbranch_scc1 Lc_end
    s_waitcnt vmcnt(0)
    s_branch Lc_tb2
Lc_tbo2:
    v_cmp_ne_u32 vcc, s3, v103
    s_and_b32 s3, vcc_lo, 0xff
    s_waitcnt lgkmcnt(0)
    s_waitcnt vmcnt(24)
    s_barrier
    s_xor_b32 s25, s19, 1
    s_lshl_b32 s25, s25, 15
    s_add_u32 s26, s25, 0
    s_add_u32 s22, s12, s26
    s_addc_u32 s23, s13, 0
    s_add_u32 m0, s24, 8192
    s_nop 0
    global_load_lds_dwordx4 v105, s[22:23]
    s_add_u32 s26, s25, 2048
    s_add_u32 s22, s12, s26
    s_addc_u32 s23, s13, 0
    s_add_u32 m0, s24, 9216
    s_nop 0
    global_load_lds_dwordx4 v105, s[22:23]
    s_add_u32 s26, s25, 8192
    s_add_u32 s22, s12, s26
    s_addc_u32 s23, s13, 0
    s_add_u32 m0, s24, 10240
    s_nop 0
    global_load_lds_dwordx4 v105, s[22:23]
    s_add_u32 s26, s25, 10240
    s_add_u32 s22, s12, s26
    s_addc_u32 s23, s13, 0
    s_add_u32 m0, s24, 11264
    s_nop 0
    global_load_lds_dwordx4 v105, s[22:23]
    ds_read_b64_tr_b16 a[80:81], v56 offset:12288
    ds_read_b64_tr_b16 a[82:83], v56 offset:45056
    ds_read_b64_tr_b16 a[84:85], v58 offset:12288
    ds_read_b64_tr_b16 a[86:87], v58 offset:45056
    ds_read_b64_tr_b16 a[88:89], v57 offset:12288
    ds_read_b64_tr_b16 a[90:91], v57 offset:45056
    ds_read_b64_tr_b16 a[92:93], v59 offset:12288
    ds_read_b64_tr_b16 a[94:95], v59 offset:45056
    s_waitcnt lgkmcnt(0)
    s_waitcnt vmcnt(24)
    s_barrier
    s_xor_b32 s25, s19, 1
    s_lshl_b32 s25, s25, 15
    s_add_u32 s26, s25, 128
    s_add_u32 s22, s12, s26
    s_addc_u32 s23, s13, 0
    s_add_u32 m0, s24, 12288
    s_nop 0
    global_load_lds_dwordx4 v105, s[22:23]
    s_add_u32 s26, s25, 2176
    s_add_u32 s22, s12, s26
    s_addc_u32 s23, s13, 0
    s_add_u32 m0, s24, 13312
    s_nop 0
    global_load_lds_dwordx4 v105, s[22:23]
    s_add_u32 s26, s25, 8320
    s_add_u32 s22, s12, s26
    s_addc_u32 s23, s13, 0
    s_add_u32 m0, s24, 14336
    s_nop 0
    global_load_lds_dwordx4 v105, s[22:23]
    s_add_u32 s26, s25, 10368
    s_add_u32 s22, s12, s26
    s_addc_u32 s23, s13, 0
    s_add_u32 m0, s24, 15360
    s_nop 0
    global_load_lds_dwordx4 v105, s[22:23]
    ds_read_b64_tr_b16 v[192:193], v56 offset:16384
    ds_read_b64_tr_b16 v[194:195], v56 offset:49152
    ds_read_b64_tr_b16 v[196:197], v58 offset:16384
    ds_read_b64_tr_b16 v[198:199], v58 offset:49152
    ds_read_b64_tr_b16 v[200:201], v57 offset:16384
    ds_read_b64_tr_b16 v[202:203], v57 offset:49152
    ds_read_b64_tr_b16 v[204:205], v59 offset:16384
    ds_read_b64_tr_b16 v[206:207], v59 offset:49152
    s_waitcnt lgkmcnt(0)
    s_waitcnt vmcnt(24)
    s_barrier
    s_xor_b32 s25, s19, 2
    s_lshl_b32 s25, s25, 15
    s_add_u32 s26, s25, 0
    s_add_u32 s22, s12, s26
    s_addc_u32 s23, s13, 0
    s_add_u32 m0, s24, 16384
    s_nop 0
    global_load_lds_dwordx4 v105, s[22:23]
    s_add_u32 s26, s25, 2048
    s_add_u32 s22, s12, s26
    s_addc_u32 s23, s13, 0
    s_add_u32 m0, s24, 17408
    s_nop 0
    global_load_lds_dwordx4 v105, s[22:23]
    s_add_u32 s26, s25, 8192
    s_add_u32 s22, s12, s26
    s_addc_u32 s23, s13, 0
    s_add_u32 m0, s24, 18432
    s_nop 0
    global_load_lds_dwordx4 v105, s[22:23]
    s_add_u32 s26, s25, 10240
    s_add_u32 s22, s12, s26
    s_addc_u32 s23, s13, 0
    s_add_u32 m0, s24, 19456
    s_nop 0
    global_load_lds_dwordx4 v105, s[22:23]
    ds_read_b64_tr_b16 v[208:209], v56 offset:20480
    ds_read_b64_tr_b16 v[210:211], v56 offset:53248
    ds_read_b64_tr_b16 v[212:213], v58 offset:20480
    ds_read_b64_tr_b16 v[214:215], v58 offset:53248
    ds_read_b64_tr_b16 v[216:217], v57 offset:20480
    ds_read_b64_tr_b16 v[218:219], v57 offset:53248
    ds_read_b64_tr_b16 v[220:221], v59 offset:20480
    ds_read_b64_tr_b16 v[222:223], v59 offset:53248
    s_waitcnt lgkmcnt(0)
    s_waitcnt vmcnt(24)
    s_barrier
    s_xor_b32 s25, s19, 2
    s_lshl_b32 s25, s25, 15
    s_add_u32 s26, s25, 128
    s_add_u32 s22, s12, s26
    s_addc_u32 s23, s13, 0
    s_add_u32 m0, s24, 20480
    s_nop 0
    global_load_lds_dwordx4 v105, s[22:23]
    s_add_u32 s26, s25, 2176
    s_add_u32 s22, s12, s26
    s_addc_u32 s23, s13, 0
    s_add_u32 m0, s24, 21504
    s_nop 0
    global_load_lds_dwordx4 v105, s[22:23]
    s_add_u32 s26, s25, 8320
    s_add_u32 s22, s12, s26
    s_addc_u32 s23, s13, 0
    s_add_u32 m0, s24, 22528
    s_nop 0
    global_load_lds_dwordx4 v105, s[22:23]
    s_add_u32 s26, s25, 10368
    s_add_u32 s22, s12, s26
    s_addc_u32 s23, s13, 0
    s_add_u32 m0, s24, 23552
    s_nop 0
    global_load_lds_dwordx4 v105, s[22:23]
    ds_read_b64_tr_b16 a[0:1], v56 offset:24576
    ds_read_b64_tr_b16 a[2:3], v56 offset:57344
    ds_read_b64_tr_b16 a[4:5], v58 offset:24576
    ds_read_b64_tr_b16 a[6:7], v58 offset:57344
    ds_read_b64_tr_b16 a[8:9], v57 offset:24576
    ds_read_b64_tr_b16 a[10:11], v57 offset:57344
    ds_read_b64_tr_b16 a[12:13], v59 offset:24576
    ds_read_b64_tr_b16 a[14:15], v59 offset:57344
    v_lshlrev_b32 v99, 7, v97
    v_and_b32 v101, 1, v98
    v_lshl_add_u32 v100, v101, 18, v99
    global_load_dword v103, v100, s[48:49] sc1
    v_lshl_add_u32 v99, v101, 13, v99
    global_load_dword v103, v99, s[50:51] sc1
    global_load_dword v48, v102, s[84:85] sc1
    s_waitcnt lgkmcnt(0)
    s_waitcnt vmcnt(27)
    s_barrier
    s_xor_b32 s25, s19, 3
    s_lshl_b32 s25, s25, 15
    s_add_u32 s26, s25, 0
    s_add_u32 s22, s12, s26
    s_addc_u32 s23, s13, 0
    s_add_u32 m0, s24, 24576
    s_nop 0
    global_load_lds_dwordx4 v105, s[22:23]
    s_add_u32 s26, s25, 2048
    s_add_u32 s22, s12, s26
    s_addc_u32 s23, s13, 0
    s_add_u32 m0, s24, 25600
    s_nop 0
    global_load_lds_dwordx4 v105, s[22:23]
    s_add_u32 s26, s25, 8192
    s_add_u32 s22, s12, s26
    s_addc_u32 s23, s13, 0
    s_add_u32 m0, s24, 26624
    s_nop 0
    global_load_lds_dwordx4 v105, s[22:23]
    s_add_u32 s26, s25, 10240
    s_add_u32 s22, s12, s26
    s_addc_u32 s23, s13, 0
    s_add_u32 m0, s24, 27648
    s_nop 0
    global_load_lds_dwordx4 v105, s[22:23]
    ds_read_b64_tr_b16 a[16:17], v56 offset:28672
    ds_read_b64_tr_b16 a[18:19], v56 offset:61440
    ds_read_b64_tr_b16 a[20:21], v58 offset:28672
    ds_read_b64_tr_b16 a[22:23], v58 offset:61440
    ds_read_b64_tr_b16 a[24:25], v57 offset:28672
    ds_read_b64_tr_b16 a[26:27], v57 offset:61440
    ds_read_b64_tr_b16 a[28:29], v59 offset:28672
    ds_read_b64_tr_b16 a[30:31], v59 offset:61440
    s_waitcnt lgkmcnt(0)
    s_branch Lc_pwe
Lc_pw3:
    s_waitcnt vmcnt(28)
    s_barrier
    ds_read_b64_tr_b16 v[240:241], v56 offset:0
    ds_read_b64_tr_b16 v[242:243], v56 offset:32768
    ds_read_b64_tr_b16 v[244:245], v58 offset:0
    ds_read_b64_tr_b16 v[246:247], v58 offset:32768
    ds_read_b64_tr_b16 v[248:249], v57 offset:0
    ds_read_b64_tr_b16 v[250:251], v57 offset:32768
    ds_read_b64_tr_b16 v[252:253], v59 offset:0
    ds_read_b64_tr_b16 v[254:255], v59 offset:32768
    ds_read_u16 v64, v100 offset:0
    ds_read_u16 v65, v100 offset:2
    ds_read_u16 v66, v100 offset:8
    ds_read_u16 v67, v100 offset:10
    ds_read_u16 v68, v100 offset:16
    ds_read_u16 v69, v100 offset:18
    ds_read_u16 v70, v100 offset:24
    ds_read_u16 v71, v100 offset:26
    ds_read_u16 v72, v100 offset:128
    ds_read_u16 v73, v100 offset:130
    ds_read_u16 v74, v100 offset:136
    ds_read_u16 v75, v100 offset:138
    ds_read_u16 v76, v100 offset:144
    ds_read_u16 v77, v100 offset:146
    ds_read_u16 v78, v100 offset:152
    ds_read_u16 v79, v100 offset:154
    s_waitcnt lgkmcnt(0)
    s_waitcnt vmcnt(24)
    s_barrier
    s_add_u32 s22, s10, 0
    s_addc_u32 s23, s11, 0
    s_add_u32 m0, s24, 0
    s_bitcmp0_b32 0xa2222222, s18
    s_cbranch_scc1 Lc_nta49
    global_load_lds_dwordx4 v52, s[22:23] offset:0
    global_load_lds_dwordx4 v53, s[22:23] offset:1024
    global_load_lds_dwordx4 v54, s[22:23] offset:2048
    global_load_lds_dwordx4 v55, s[22:23] offset:3072
    s_branch Lc_ntb49
Lc_nta49:
    s_waitcnt vmcnt(5)
    global_load_lds_dwordx4 v52, s[22:23] offset:0
    s_waitcnt vmcnt(5)
    global_load_lds_dwordx4 v53, s[22:23] offset:1024
    s_waitcnt vmcnt(5)
    global_load_lds_dwordx4 v54, s[22:23] offset:2048
    s_waitcnt vmcnt(5)
    global_load_lds_dwordx4 v55, s[22:23] offset:3072
Lc_ntb49:
    ds_read_b64_tr_b16 v[80:81], v56 offset:4096
    ds_read_b64_tr_b16 v[82:83], v56 offset:36864
    ds_read_b64_tr_b16 v[84:85], v58 offset:4096
    ds_read_b64_tr_b16 v[86:87], v58 offset:36864
    ds_read_b64_tr_b16 v[88:89], v57 offset:4096
    ds_read_b64_tr_b16 v[90:91], v57 offset:36864
    ds_read_b64_tr_b16 v[92:93], v59 offset:4096
    ds_read_b64_tr_b16 v[94:95], v59 offset:36864
    v_lshl_or_b32 v0, v65, 16, v64
    v_lshl_or_b32 v1, v67, 16, v66
    v_lshl_or_b32 v2, v69, 16, v68
    v_lshl_or_b32 v3, v71, 16, v70
    v_lshl_or_b32 v4, v73, 16, v72
    v_lshl_or_b32 v5, v75, 16, v74
    v_lshl_or_b32 v6, v77, 16, v76
    v_lshl_or_b32 v7, v79, 16, v78
    s_waitcnt lgkmcnt(0)
    s_waitcnt vmcnt(24)
    s_barrier
    s_add_u32 s22, s10, 524288
    s_addc_u32 s23, s11, 0
    s_add_u32 m0, s24, 4096
    s_bitcmp0_b32 0xa2222222, s18
    s_cbranch_scc1 Lc_nta50
    global_load_lds_dwordx4 v52, s[22:23] offset:0
    global_load_lds_dwordx4 v53, s[22:23] offset:1024
    global_load_lds_dwordx4 v54, s[22:23] offset:2048
    global_load_lds_dwordx4 v55, s[22:23] offset:3072
    s_branch Lc_ntb50
Lc_nta50:
    s_waitcnt vmcnt(5)
    global_load_lds_dwordx4 v52, s[22:23] offset:0
    s_waitcnt vmcnt(5)
    global_load_lds_dwordx4 v53, s[22:23] offset:1024
    s_waitcnt vmcnt(5)
    global_load_lds_dwordx4 v54, s[22:23] offset:2048
    s_waitcnt vmcnt(5)
    global_load_lds_dwordx4 v55, s[22:23] offset:3072
Lc_ntb50:
    ds_read_b64_tr_b16 a[144:145], v56 offset:8192
    ds_read_b64_tr_b16 a[146:147], v56 offset:40960
    ds_read_b64_tr_b16 a[148:149], v58 offset:8192
    ds_read_b64_tr_b16 a[150:151], v58 offset:40960
    ds_read_b64_tr_b16 a[152:153], v57 offset:8192
    ds_read_b64_tr_b16 a[154:155], v57 offset:40960
    ds_read_b64_tr_b16 a[156:157], v59 offset:8192
    ds_read_b64_tr_b16 a[158:159], v59 offset:40960
    s_waitcnt lgkmcnt(0)
    s_waitcnt vmcnt(24)
    s_barrier
    s_add_u32 s22, s10, 1048576
    s_addc_u32 s23, s11, 0
    s_add_u32 m0, s24, 8192
    s_bitcmp0_b32 0xa2222222, s18
    s_cbranch_scc1 Lc_nta51
    global_load_lds_dwordx4 v52, s[22:23] offset:0
    global_load_lds_dwordx4 v53, s[22:23] offset:1024
    global_load_lds_dwordx4 v54, s[22:23] offset:2048
    global_load_lds_dwordx4 v55, s[22:23] offset:3072
    s_branch Lc_ntb51
Lc_nta51:
    s_waitcnt vmcnt(5)
    global_load_lds_dwordx4 v52, s[22:23] offset:0
    s_waitcnt vmcnt(5)
    global_load_lds_dwordx4 v53, s[22:23] offset:1024
    s_waitcnt vmcnt(5)
    global_load_lds_dwordx4 v54, s[22:23] offset:2048
    s_waitcnt vmcnt(5)
    global_load_lds_dwordx4 v55, s[22:23] offset:3072
Lc_ntb51:
    ds_read_b64_tr_b16 a[160:161], v56 offset:12288
    ds_read_b64_tr_b16 a[162:163], v56 offset:45056
    ds_read_b64_tr_b16 a[164:165], v58 offset:12288
    ds_read_b64_tr_b16 a[166:167], v58 offset:45056
    ds_read_b64_tr_b16 a[168:169], v57 offset:12288
    ds_read_b64_tr_b16 a[170:171], v57 offset:45056
    ds_read_b64_tr_b16 a[172:173], v59 offset:12288
    ds_read_b64_tr_b16 a[174:175], v59 offset:45056
    s_waitcnt lgkmcnt(0)
    s_waitcnt vmcnt(24)
    s_barrier
    s_add_u32 s22, s10, 1572864
    s_addc_u32 s23, s11, 0
    s_add_u32 m0, s24, 12288
    s_bitcmp0_b32 0xa2222222, s18
    s_cbranch_scc1 Lc_nta52
    global_load_lds_dwordx4 v52, s[22:23] offset:0
    global_load_lds_dwordx4 v53, s[22:23] offset:1024
    global_load_lds_dwordx4 v54, s[22:23] offset:2048
    global_load_lds_dwordx4 v55, s[22:23] offset:3072
    s_branch Lc_ntb52
Lc_nta52:
    s_waitcnt vmcnt(5)
    global_load_lds_dwordx4 v52, s[22:23] offset:0
    s_waitcnt vmcnt(5)
    global_load_lds_dwordx4 v53, s[22:23] offset:1024
    s_waitcnt vmcnt(5)
    global_load_lds_dwordx4 v54, s[22:23] offset:2048
    s_waitcnt vmcnt(5)
    global_load_lds_dwordx4 v55, s[22:23] offset:3072
Lc_ntb52:
    ds_read_b64_tr_b16 a[112:113], v56 offset:16384
    ds_read_b64_tr_b16 a[114:115], v56 offset:49152
    ds_read_b64_tr_b16 a[116:117], v58 offset:16384
    ds_read_b64_tr_b16 a[118:119], v58 offset:49152
    ds_read_b64_tr_b16 a[120:121], v57 offset:16384
    ds_read_b64_tr_b16 a[122:123], v57 offset:49152
    ds_read_b64_tr_b16 a[124:125], v59 offset:16384
    ds_read_b64_tr_b16 a[126:127], v59 offset:49152
    s_waitcnt lgkmcnt(0)
    s_waitcnt vmcnt(24)
    s_barrier
    s_add_u32 s22, s10, 2097152
    s_addc_u32 s23, s11, 0
    s_add_u32 m0, s24, 16384
    s_bitcmp0_b32 0xa2222222, s18
    s_cbranch_scc1 Lc_nta53
    global_load_lds_dwordx4 v52, s[22:23] offset:0
    global_load_lds_dwordx4 v53, s[22:23] offset:1024
    global_load_lds_dwordx4 v54, s[22:23] offset:2048
    global_load_lds_dwordx4 v55, s[22:23] offset:3072
    s_branch Lc_ntb53
Lc_nta53:
    s_waitcnt vmcnt(5)
    global_load_lds_dwordx4 v52, s[22:23] offset:0
    s_waitcnt vmcnt(5)
    global_load_lds_dwordx4 v53, s[22:23] offset:1024
    s_waitcnt vmcnt(5)
    global_load_lds_dwordx4 v54, s[22:23] offset:2048
    s_waitcnt vmcnt(5)
    global_load_lds_dwordx4 v55, s[22:23] offset:3072
Lc_ntb53:
    ds_read_b64_tr_b16 a[128:129], v56 offset:20480
    ds_read_b64_tr_b16 a[130:131], v56 offset:53248
    ds_read_b64_tr_b16 a[132:133], v58 offset:20480
    ds_read_b64_tr_b16 a[134:135], v58 offset:53248
    ds_read_b64_tr_b16 a[136:137], v57 offset:20480
    ds_read_b64_tr_b16 a[138:139], v57 offset:53248
    ds_read_b64_tr_b16 a[140:141], v59 offset:20480
    ds_read_b64_tr_b16 a[142:143], v59 offset:53248
    s_waitcnt lgkmcnt(0)
    s_waitcnt vmcnt(24)
    s_barrier
    s_add_u32 s22, s10, 2621440
    s_addc_u32 s23, s11, 0
    s_add_u32 m0, s24, 20480
    s_bitcmp0_b32 0xa2222222, s18
    s_cbranch_scc1 Lc_nta54
    global_load_lds_dwordx4 v52, s[22:23] offset:0
    global_load_lds_dwordx4 v53, s[22:23] offset:1024
    global_load_lds_dwordx4 v54, s[22:23] offset:2048
    global_load_lds_dwordx4 v55, s[22:23] offset:3072
    s_branch Lc_ntb54
Lc_nta54:
    s_waitcnt vmcnt(5)
    global_load_lds_dwordx4 v52, s[22:23] offset:0
    s_waitcnt vmcnt(5)
    global_load_lds_dwordx4 v53, s[22:23] offset:1024
    s_waitcnt vmcnt(5)
    global_load_lds_dwordx4 v54, s[22:23] offset:2048
    s_waitcnt vmcnt(5)
    global_load_lds_dwordx4 v55, s[22:23] offset:3072
Lc_ntb54:
    ds_read_b64_tr_b16 v[224:225], v56 offset:24576
    ds_read_b64_tr_b16 v[226:227], v56 offset:57344
    ds_read_b64_tr_b16 v[228:229], v58 offset:24576
    ds_read_b64_tr_b16 v[230:231], v58 offset:57344
    ds_read_b64_tr_b16 v[232:233], v57 offset:24576
    ds_read_b64_tr_b16 v[234:235], v57 offset:57344
    ds_read_b64_tr_b16 v[236:237], v59 offset:24576
    ds_read_b64_tr_b16 v[238:239], v59 offset:57344
    s_waitcnt lgkmcnt(0)
    s_waitcnt vmcnt(24)
    s_barrier
    s_add_u32 s22, s10, 3145728
    s_addc_u32 s23, s11, 0
    s_add_u32 m0, s24, 24576
    s_bitcmp0_b32 0xa2222222, s18
    s_cbranch_scc1 Lc_nta55
    global_load_lds_dwordx4 v52, s[22:23] offset:0
    global_load_lds_dwordx4 v53, s[22:23] offset:1024
    global_load_lds_dwordx4 v54, s[22:23] offset:2048
    global_load_lds_dwordx4 v55, s[22:23] offset:3072
    s_branch Lc_ntb55
Lc_nta55:
    s_waitcnt vmcnt(5)
    global_load_lds_dwordx4 v52, s[22:23] offset:0
    s_waitcnt vmcnt(5)
    global_load_lds_dwordx4 v53, s[22:23] offset:1024
    s_waitcnt vmcnt(5)
    global_load_lds_dwordx4 v54, s[22:23] offset:2048
    s_waitcnt vmcnt(5)
    global_load_lds_dwordx4 v55, s[22:23] offset:3072
Lc_ntb55:
    ds_read_b64_tr_b16 a[96:97], v56 offset:28672
    ds_read_b64_tr_b16 a[98:99], v56 offset:61440
    ds_read_b64_tr_b16 a[100:101], v58 offset:28672
    ds_read_b64_tr_b16 a[102:103], v58 offset:61440
    ds_read_b64_tr_b16 a[104:105], v57 offset:28672
    ds_read_b64_tr_b16 a[106:107], v57 offset:61440
    ds_read_b64_tr_b16 a[108:109], v59 offset:28672
    ds_read_b64_tr_b16 a[110:111], v59 offset:61440
    s_waitcnt lgkmcnt(0)
    s_waitcnt vmcnt(24)
    s_barrier
    s_add_u32 s22, s10, 3670016
    s_addc_u32 s23, s11, 0
    s_add_u32 m0, s24, 28672
    s_bitcmp0_b32 0xa2222222, s18
    s_cbranch_scc1 Lc_nta56
    global_load_lds_dwordx4 v52, s[22:23] offset:0
    global_load_lds_dwordx4 v53, s[22:23] offset:1024
    global_load_lds_dwordx4 v54, s[22:23] offset:2048
    global_load_lds_dwordx4 v55, s[22:23] offset:3072
    s_branch Lc_ntb56
Lc_nta56:
    s_waitcnt vmcnt(5)
    global_load_lds_dwordx4 v52, s[22:23] offset:0
    s_waitcnt vmcnt(5)
    global_load_lds_dwordx4 v53, s[22:23] offset:1024
    s_waitcnt vmcnt(5)
    global_load_lds_dwordx4 v54, s[22:23] offset:2048
    s_waitcnt vmcnt(5)
    global_load_lds_dwordx4 v55, s[22:23] offset:3072
Lc_ntb56:
    ds_read_b64_tr_b16 v[144:145], v56 offset:0
    ds_read_b64_tr_b16 v[146:147], v56 offset:32768
    ds_read_b64_tr_b16 v[148:149], v58 offset:0
    ds_read_b64_tr_b16 v[150:151], v58 offset:32768
    ds_read_b64_tr_b16 v[152:153], v57 offset:0
    ds_read_b64_tr_b16 v[154:155], v57 offset:32768
    ds_read_b64_tr_b16 v[156:157], v59 offset:0
    ds_read_b64_tr_b16 v[158:159], v59 offset:32768
    s_waitcnt lgkmcnt(0)
    s_waitcnt vmcnt(24)
    s_barrier
    s_add_u32 s22, s6, 0
    s_addc_u32 s23, s7, 0
    s_add_u32 m0, s24, 0
    s_bitcmp0_b32 0xa2222222, s18
    s_cbranch_scc1 Lc_nta57
    global_load_lds_dwordx4 v52, s[22:23] offset:0
    global_load_lds_dwordx4 v53, s[22:23] offset:1024
    global_load_lds_dwordx4 v54, s[22:23] offset:2048
    global_load_lds_dwordx4 v55, s[22:23] offset:3072
    s_branch Lc_ntb57
Lc_nta57:
    s_waitcnt vmcnt(5)
    global_load_lds_dwordx4 v52, s[22:23] offset:0
    s_waitcnt vmcnt(5)
    global_load_lds_dwordx4 v53, s[22:23] offset:1024
    s_waitcnt vmcnt(5)
    global_load_lds_dwordx4 v54, s[22:23] offset:2048
    s_waitcnt vmcnt(5)
    global_load_lds_dwordx4 v55, s[22:23] offset:3072
Lc_ntb57:
    ds_read_b64_tr_b16 v[160:161], v56 offset:4096
    ds_read_b64_tr_b16 v[162:163], v56 offset:36864
    ds_read_b64_tr_b16 v[164:165], v58 offset:4096
    ds_read_b64_tr_b16 v[166:167], v58 offset:36864
    ds_read_b64_tr_b16 v[168:169], v57 offset:4096
    ds_read_b64_tr_b16 v[170:171], v57 offset:36864
    ds_read_b64_tr_b16 v[172:173], v59 offset:4096
    ds_read_b64_tr_b16 v[174:175], v59 offset:36864
    s_waitcnt lgkmcnt(0)
    s_waitcnt vmcnt(24)
    s_barrier
    s_add_u32 s22, s6, 524288
    s_addc_u32 s23, s7, 0
    s_add_u32 m0, s24, 4096
    s_bitcmp0_b32 0xa2222222, s18
    s_cbranch_scc1 Lc_nta58
    global_load_lds_dwordx4 v52, s[22:23] offset:0
    global_load_lds_dwordx4 v53, s[22:23] offset:1024
    global_load_lds_dwordx4 v54, s[22:23] offset:2048
    global_load_lds_dwordx4 v55, s[22:23] offset:3072
    s_branch Lc_ntb58
Lc_nta58:
    s_waitcnt vmcnt(5)
    global_load_lds_dwordx4 v52, s[22:23] offset:0
    s_waitcnt vmcnt(5)
    global_load_lds_dwordx4 v53, s[22:23] offset:1024
    s_waitcnt vmcnt(5)
    global_load_lds_dwordx4 v54, s[22:23] offset:2048
    s_waitcnt vmcnt(5)
    global_load_lds_dwordx4 v55, s[22:23] offset:3072
Lc_ntb58:
    ds_read_b64_tr_b16 a[240:241], v56 offset:8192
    ds_read_b64_tr_b16 a[242:243], v56 offset:40960
    ds_read_b64_tr_b16 a[244:245], v58 offset:8192
    ds_read_b64_tr_b16 a[246:247], v58 offset:40960
    ds_read_b64_tr_b16 a[248:249], v57 offset:8192
    ds_read_b64_tr_b16 a[250:251], v57 offset:40960
    ds_read_b64_tr_b16 a[252:253], v59 offset:8192
    ds_read_b64_tr_b16 a[254:255], v59 offset:40960
    global_load_dword v103, v102, s[14:15] sc1
    s_waitcnt lgkmcnt(0)
    s_waitcnt vmcnt(25)
    s_barrier
    s_add_u32 s22, s6, 1048576
    s_addc_u32 s23, s7, 0
    s_add_u32 m0, s24, 8192
    s_bitcmp0_b32 0xa2222222, s18
    s_cbranch_scc1 Lc_nta59
    global_load_lds_dwordx4 v52, s[22:23] offset:0
    global_load_lds_dwordx4 v53, s[22:23] offset:1024
    global_load_lds_dwordx4 v54, s[22:23] offset:2048
    global_load_lds_dwordx4 v55, s[22:23] offset:3072
    s_branch Lc_ntb59
Lc_nta59:
    s_waitcnt vmcnt(5)
    global_load_lds_dwordx4 v52, s[22:23] offset:0
    s_waitcnt vmcnt(5)
    global_load_lds_dwordx4 v53, s[22:23] offset:1024
    s_waitcnt vmcnt(5)
    global_load_lds_dwordx4 v54, s[22:23] offset:2048
    s_waitcnt vmcnt(5)
    global_load_lds_dwordx4 v55, s[22:23] offset:3072
Lc_ntb59:
    ds_read_b64_tr_b16 v[128:129], v56 offset:12288
    ds_read_b64_tr_b16 v[130:131], v56 offset:45056
    ds_read_b64_tr_b16 v[132:133], v58 offset:12288
    ds_read_b64_tr_b16 v[134:135], v58 offset:45056
    ds_read_b64_tr_b16 v[136:137], v57 offset:12288
    ds_read_b64_tr_b16 v[138:139], v57 offset:45056
    ds_read_b64_tr_b16 v[140:141], v59 offset:12288
    ds_read_b64_tr_b16 v[142:143], v59 offset:45056
    s_waitcnt lgkmcnt(0)
    s_waitcnt vmcnt(25)
    s_barrier
    s_add_u32 s22, s6, 1572864
    s_addc_u32 s23, s7, 0
    s_add_u32 m0, s24, 12288
    s_bitcmp0_b32 0xa2222222, s18
    s_cbranch_scc1 Lc_nta60
    global_load_lds_dwordx4 v52, s[22:23] offset:0
    global_load_lds_dwordx4 v53, s[22:23] offset:1024
    global_load_lds_dwordx4 v54, s[22:23] offset:2048
    global_load_lds_dwordx4 v55, s[22:23] offset:3072
    s_branch Lc_ntb60
Lc_nta60:
    s_waitcnt vmcnt(5)
    global_load_lds_dwordx4 v52, s[22:23] offset:0
    s_waitcnt vmcnt(5)
    global_load_lds_dwordx4 v53, s[22:23] offset:1024
    s_waitcnt vmcnt(5)
    global_load_lds_dwordx4 v54, s[22:23] offset:2048
    s_waitcnt vmcnt(5)
    global_load_lds_dwordx4 v55, s[22:23] offset:3072
Lc_ntb60:
    ds_read_b64_tr_b16 a[208:209], v56 offset:16384
    ds_read_b64_tr_b16 a[210:211], v56 offset:49152
    ds_read_b64_tr_b16 a[212:213], v58 offset:16384
    ds_read_b64_tr_b16 a[214:215], v58 offset:49152
    ds_read_b64_tr_b16 a[216:217], v57 offset:16384
    ds_read_b64_tr_b16 a[218:219], v57 offset:49152
    ds_read_b64_tr_b16 a[220:221], v59 offset:16384
    ds_read_b64_tr_b16 a[222:223], v59 offset:49152
    s_waitcnt lgkmcnt(0)
    s_waitcnt vmcnt(25)
    s_barrier
    s_add_u32 s22, s6, 2097152
    s_addc_u32 s23, s7, 0
    s_add_u32 m0, s24, 16384
    s_bitcmp0_b32 0xa2222222, s18
    s_cbranch_scc1 Lc_nta61
    global_load_lds_dwordx4 v52, s[22:23] offset:0
    global_load_lds_dwordx4 v53, s[22:23] offset:1024
    global_load_lds_dwordx4 v54, s[22:23] offset:2048
    global_load_lds_dwordx4 v55, s[22:23] offset:3072
    s_branch Lc_ntb61
Lc_nta61:
    s_waitcnt vmcnt(5)
    global_load_lds_dwordx4 v52, s[22:23] offset:0
    s_waitcnt vmcnt(5)
    global_load_lds_dwordx4 v53, s[22:23] offset:1024
    s_waitcnt vmcnt(5)
    global_load_lds_dwordx4 v54, s[22:23] offset:2048
    s_waitcnt vmcnt(5)
    global_load_lds_dwordx4 v55, s[22:23] offset:3072
Lc_ntb61:
    ds_read_b64_tr_b16 a[224:225], v56 offset:20480
    ds_read_b64_tr_b16 a[226:227], v56 offset:53248
    ds_read_b64_tr_b16 a[228:229], v58 offset:20480
    ds_read_b64_tr_b16 a[230:231], v58 offset:53248
    ds_read_b64_tr_b16 a[232:233], v57 offset:20480
    ds_read_b64_tr_b16 a[234:235], v57 offset:53248
    ds_read_b64_tr_b16 a[236:237], v59 offset:20480
    ds_read_b64_tr_b16 a[238:239], v59 offset:53248
    s_waitcnt lgkmcnt(0)
    s_waitcnt vmcnt(25)
    s_barrier
    s_add_u32 s22, s6, 2621440
    s_addc_u32 s23, s7, 0
    s_add_u32 m0, s24, 20480
    s_bitcmp0_b32 0xa2222222, s18
    s_cbranch_scc1 Lc_nta62
    global_load_lds_dwordx4 v52, s[22:23] offset:0
    global_load_lds_dwordx4 v53, s[22:23] offset:1024
    global_load_lds_dwordx4 v54, s[22:23] offset:2048
    global_load_lds_dwordx4 v55, s[22:23] offset:3072
    s_branch Lc_ntb62
Lc_nta62:
    s_waitcnt vmcnt(5)
    global_load_lds_dwordx4 v52, s[22:23] offset:0
    s_waitcnt vmcnt(5)
    global_load_lds_dwordx4 v53, s[22:23] offset:1024
    s_waitcnt vmcnt(5)
    global_load_lds_dwordx4 v54, s[22:23] offset:2048
    s_waitcnt vmcnt(5)
    global_load_lds_dwordx4 v55, s[22:23] offset:3072
Lc_ntb62:
    ds_read_b64_tr_b16 a[176:177], v56 offset:24576
    ds_read_b64_tr_b16 a[178:179], v56 offset:57344
    ds_read_b64_tr_b16 a[180:181], v58 offset:24576
    ds_read_b64_tr_b16 a[182:183], v58 offset:57344
    ds_read_b64_tr_b16 a[184:185], v57 offset:24576
    ds_read_b64_tr_b16 a[186:187], v57 offset:57344
    ds_read_b64_tr_b16 a[188:189], v59 offset:24576
    ds_read_b64_tr_b16 a[190:191], v59 offset:57344
    s_waitcnt lgkmcnt(0)
    s_waitcnt vmcnt(25)
    s_barrier
    s_add_u32 s22, s6, 3145728
    s_addc_u32 s23, s7, 0
    s_add_u32 m0, s24, 24576
    s_bitcmp0_b32 0xa2222222, s18
    s_cbranch_scc1 Lc_nta63
    global_load_lds_dwordx4 v52, s[22:23] offset:0
    global_load_lds_dwordx4 v53, s[22:23] offset:1024
    global_load_lds_dwordx4 v54, s[22:23] offset:2048
    global_load_lds_dwordx4 v55, s[22:23] offset:3072
    s_branch Lc_ntb63
Lc_nta63:
    s_waitcnt vmcnt(5)
    global_load_lds_dwordx4 v52, s[22:23] offset:0
    s_waitcnt vmcnt(5)
    global_load_lds_dwordx4 v53, s[22:23] offset:1024
    s_waitcnt vmcnt(5)
    global_load_lds_dwordx4 v54, s[22:23] offset:2048
    s_waitcnt vmcnt(5)
    global_load_lds_dwordx4 v55, s[22:23] offset:3072
Lc_ntb63:
    ds_read_b64_tr_b16 a[192:193], v56 offset:28672
    ds_read_b64_tr_b16 a[194:195], v56 offset:61440
    ds_read_b64_tr_b16 a[196:197], v58 offset:28672
    ds_read_b64_tr_b16 a[198:199], v58 offset:61440
    ds_read_b64_tr_b16 a[200:201], v57 offset:28672
    ds_read_b64_tr_b16 a[202:203], v57 offset:61440
    ds_read_b64_tr_b16 a[204:205], v59 offset:28672
    ds_read_b64_tr_b16 a[206:207], v59 offset:61440
    s_waitcnt lgkmcnt(0)
    s_waitcnt vmcnt(25)
    s_barrier
    s_add_u32 s22, s6, 3670016
    s_addc_u32 s23, s7, 0
    s_add_u32 m0, s24, 28672
    s_bitcmp0_b32 0xa2222222, s18
    s_cbranch_scc1 Lc_nta64
    global_load_lds_dwordx4 v52, s[22:23] offset:0
    global_load_lds_dwordx4 v53, s[22:23] offset:1024
    global_load_lds_dwordx4 v54, s[22:23] offset:2048
    global_load_lds_dwordx4 v55, s[22:23] offset:3072
    s_branch Lc_ntb64
Lc_nta64:
    s_waitcnt vmcnt(5)
    global_load_lds_dwordx4 v52, s[22:23] offset:0
    s_waitcnt vmcnt(5)
    global_load_lds_dwordx4 v53, s[22:23] offset:1024
    s_waitcnt vmcnt(5)
    global_load_lds_dwordx4 v54, s[22:23] offset:2048
    s_waitcnt vmcnt(5)
    global_load_lds_dwordx4 v55, s[22:23] offset:3072
Lc_ntb64:
    ds_read_b64_tr_b16 a[64:65], v56 offset:0
    ds_read_b64_tr_b16 a[66:67], v56 offset:32768
    ds_read_b64_tr_b16 a[68:69], v58 offset:0
    ds_read_b64_tr_b16 a[70:71], v58 offset:32768
    ds_read_b64_tr_b16 a[72:73], v57 offset:0
    ds_read_b64_tr_b16 a[74:75], v57 offset:32768
    ds_read_b64_tr_b16 a[76:77], v59 offset:0
    ds_read_b64_tr_b16 a[78:79], v59 offset:32768
    s_waitcnt lgkmcnt(0)
    s_waitcnt vmcnt(25)
    s_barrier
    s_xor_b32 s25, s19, 0
    s_lshl_b32 s25, s25, 15
    s_add_u32 s26, s25, 0
    s_add_u32 s22, s12, s26
    s_addc_u32 s23, s13, 0
    s_add_u32 m0, s24, 0
    s_nop 0
    global_load_lds_dwordx4 v105, s[22:23]
    s_add_u32 s26, s25, 2048
    s_add_u32 s22, s12, s26
    s_addc_u32 s23, s13, 0
    s_add_u32 m0, s24, 1024
    s_nop 0
    global_load_lds_dwordx4 v105, s[22:23]
    s_add_u32 s26, s25, 8192
    s_add_u32 s22, s12, s26
    s_addc_u32 s23, s13, 0
    s_add_u32 m0, s24, 2048
    s_nop 0
    global_load_lds_dwordx4 v105, s[22:23]
    s_add_u32 s26, s25, 10240
    s_add_u32 s22, s12, s26
    s_addc_u32 s23, s13, 0
    s_add_u32 m0, s24, 3072
    s_nop 0
    global_load_lds_dwordx4 v105, s[22:23]
    ds_read_b64_tr_b16 a[80:81], v56 offset:4096
    ds_read_b64_tr_b16 a[82:83], v56 offset:36864
    ds_read_b64_tr_b16 a[84:85], v58 offset:4096
    ds_read_b64_tr_b16 a[86:87], v58 offset:36864
    ds_read_b64_tr_b16 a[88:89], v57 offset:4096
    ds_read_b64_tr_b16 a[90:91], v57 offset:36864
    ds_read_b64_tr_b16 a[92:93], v59 offset:4096
    ds_read_b64_tr_b16 a[94:95], v59 offset:36864
    s_waitcnt lgkmcnt(0)
    s_waitcnt vmcnt(24)
    s_barrier
    s_xor_b32 s25, s19, 0
    s_lshl_b32 s25, s25, 15
    s_add_u32 s26, s25, 128
    s_add_u32 s22, s12, s26
    s_addc_u32 s23, s13, 0
    s_add_u32 m0, s24, 4096
    s_nop 0
    global_load_lds_dwordx4 v105, s[22:23]
    s_add_u32 s26, s25, 2176
    s_add_u32 s22, s12, s26
    s_addc_u32 s23, s13, 0
    s_add_u32 m0, s24, 5120
    s_nop 0
    global_load_lds_dwordx4 v105, s[22:23]
    s_add_u32 s26, s25, 8320
    s_add_u32 s22, s12, s26
    s_addc_u32 s23, s13, 0
    s_add_u32 m0, s24, 6144
    s_nop 0
    global_load_lds_dwordx4 v105, s[22:23]
    s_add_u32 s26, s25, 10368
    s_add_u32 s22, s12, s26
    s_addc_u32 s23, s13, 0
    s_add_u32 m0, s24, 7168
    s_nop 0
    global_load_lds_dwordx4 v105, s[22:23]
    ds_read_b64_tr_b16 a[32:33], v56 offset:8192
    ds_read_b64_tr_b16 a[34:35], v56 offset:40960
    ds_read_b64_tr_b16 a[36:37], v58 offset:8192
    ds_read_b64_tr_b16 a[38:39], v58 offset:40960
    ds_read_b64_tr_b16 a[40:41], v57 offset:8192
    ds_read_b64_tr_b16 a[42:43], v57 offset:40960
    ds_read_b64_tr_b16 a[44:45], v59 offset:8192
    ds_read_b64_tr_b16 a[46:47], v59 offset:40960
    s_mov_b32 s21, 0
Lc_tb3:
    v_and_b32 v99, 0x01010101, v103
    v_cmp_ne_u32 vcc, 0x01010101, v99
    s_and_b32 s25, vcc_lo, 16777215
    s_and_b32 s26, vcc_hi, 256
    s_or_b32 s25, s25, s26
    s_cbranch_scc0 Lc_tbo3
    s_sleep 4
    global_load_dword v103, v102, s[14:15] sc1
    s_add_u32 s21, s21, 1
    s_cmp_gt_u32 s21, 200000
    s_cbranch_scc1 Lc_end
    s_waitcnt vmcnt(0)
    s_branch Lc_tb3
Lc_tbo3:
    v_cmp_ne_u32 vcc, s3, v103
    s_and_b32 s3, vcc_lo, 0xff
    s_waitcnt lgkmcnt(0)
    s_waitcnt vmcnt(24)
    s_barrier
    s_xor_b32 s25, s19, 1
    s_lshl_b32 s25, s25, 15
    s_add_u32 s26, s25, 0
    s_add_u32 s22, s12, s26
    s_addc_u32 s23, s13, 0
    s_add_u32 m0, s24, 8192
    s_nop 0
    global_load_lds_dwordx4 v105, s[22:23]
    s_add_u32 s26, s25, 2048
    s_add_u32 s22, s12, s26
    s_addc_u32 s23, s13, 0
    s_add_u32 m0, s24, 9216
    s_nop 0
    global_load_lds_dwordx4 v105, s[22:23]
    s_add_u32 s26, s25, 8192
    s_add_u32 s22, s12, s26
    s_addc_u32 s23, s13, 0
    s_add_u32 m0, s24, 10240
    s_nop 0
    global_load_lds_dwordx4 v105, s[22:23]
    s_add_u32 s26, s25, 10240
    s_add_u32 s22, s12, s26
    s_addc_u32 s23, s13, 0
    s_add_u32 m0, s24, 11264
    s_nop 0
    global_load_lds_dwordx4 v105, s[22:23]
    ds_read_b64_tr_b16 a[48:49], v56 offset:12288
    ds_read_b64_tr_b16 a[50:51], v56 offset:45056
    ds_read_b64_tr_b16 a[52:53], v58 offset:12288
    ds_read_b64_tr_b16 a[54:55], v58 offset:45056
    ds_read_b64_tr_b16 a[56:57], v57 offset:12288
    ds_read_b64_tr_b16 a[58:59], v57 offset:45056
    ds_read_b64_tr_b16 a[60:61], v59 offset:12288
    ds_read_b64_tr_b16 a[62:63], v59 offset:45056
    s_waitcnt lgkmcnt(0)
    s_waitcnt vmcnt(24)
    s_barrier
    s_xor_b32 s25, s19, 1
    s_lshl_b32 s25, s25, 15
    s_add_u32 s26, s25, 128
    s_add_u32 s22, s12, s26
    s_addc_u32 s23, s13, 0
    s_add_u32 m0, s24, 12288
    s_nop 0
    global_load_lds_dwordx4 v105, s[22:23]
    s_add_u32 s26, s25, 2176
    s_add_u32 s22, s12, s26
    s_addc_u32 s23, s13, 0
    s_add_u32 m0, s24, 13312
    s_nop 0
    global_load_lds_dwordx4 v105, s[22:23]
    s_add_u32 s26, s25, 8320
    s_add_u32 s22, s12, s26
    s_addc_u32 s23, s13, 0
    s_add_u32 m0, s24, 14336
    s_nop 0
    global_load_lds_dwordx4 v105, s[22:23]
    s_add_u32 s26, s25, 10368
    s_add_u32 s22, s12, s26
    s_addc_u32 s23, s13, 0
    s_add_u32 m0, s24, 15360
    s_nop 0
    global_load_lds_dwordx4 v105, s[22:23]
    ds_read_b64_tr_b16 a[0:1], v56 offset:16384
    ds_read_b64_tr_b16 a[2:3], v56 offset:49152
    ds_read_b64_tr_b16 a[4:5], v58 offset:16384
    ds_read_b64_tr_b16 a[6:7], v58 offset:49152
    ds_read_b64_tr_b16 a[8:9], v57 offset:16384
    ds_read_b64_tr_b16 a[10:11], v57 offset:49152
    ds_read_b64_tr_b16 a[12:13], v59 offset:16384
    ds_read_b64_tr_b16 a[14:15], v59 offset:49152
    s_waitcnt lgkmcnt(0)
    s_waitcnt vmcnt(24)
    s_barrier
    s_xor_b32 s25, s19, 2
    s_lshl_b32 s25, s25, 15
    s_add_u32 s26, s25, 0
    s_add_u32 s22, s12, s26
    s_addc_u32 s23, s13, 0
    s_add_u32 m0, s24, 16384
    s_nop 0
    global_load_lds_dwordx4 v105, s[22:23]
    s_add_u32 s26, s25, 2048
    s_add_u32 s22, s12, s26
    s_addc_u32 s23, s13, 0
    s_add_u32 m0, s24, 17408
    s_nop 0
    global_load_lds_dwordx4 v105, s[22:23]
    s_add_u32 s26, s25, 8192
    s_add_u32 s22, s12, s26
    s_addc_u32 s23, s13, 0
    s_add_u32 m0, s24, 18432
    s_nop 0
    global_load_lds_dwordx4 v105, s[22:23]
    s_add_u32 s26, s25, 10240
    s_add_u32 s22, s12, s26
    s_addc_u32 s23, s13, 0
    s_add_u32 m0, s24, 19456
    s_nop 0
    global_load_lds_dwordx4 v105, s[22:23]
    ds_read_b64_tr_b16 a[16:17], v56 offset:20480
    ds_read_b64_tr_b16 a[18:19], v56 offset:53248
    ds_read_b64_tr_b16 a[20:21], v58 offset:20480
    ds_read_b64_tr_b16 a[22:23], v58 offset:53248
    ds_read_b64_tr_b16 a[24:25], v57 offset:20480
    ds_read_b64_tr_b16 a[26:27], v57 offset:53248
    ds_read_b64_tr_b16 a[28:29], v59 offset:20480
    ds_read_b64_tr_b16 a[30:31], v59 offset:53248
    s_waitcnt lgkmcnt(0)
    s_waitcnt vmcnt(24)
    s_barrier
    s_xor_b32 s25, s19, 2
    s_lshl_b32 s25, s25, 15
    s_add_u32 s26, s25, 128
    s_add_u32 s22, s12, s26
    s_addc_u32 s23, s13, 0
    s_add_u32 m0, s24, 20480
    s_nop 0
    global_load_lds_dwordx4 v105, s[22:23]
    s_add_u32 s26, s25, 2176
    s_add_u32 s22, s12, s26
    s_addc_u32 s23, s13, 0
    s_add_u32 m0, s24, 21504
    s_nop 0
    global_load_lds_dwordx4 v105, s[22:23]
    s_add_u32 s26, s25, 8320
    s_add_u32 s22, s12, s26
    s_addc_u32 s23, s13, 0
    s_add_u32 m0, s24, 22528
    s_nop 0
    global_load_lds_dwordx4 v105, s[22:23]
    s_add_u32 s26, s25, 10368
    s_add_u32 s22, s12, s26
    s_addc_u32 s23, s13, 0
    s_add_u32 m0, s24, 23552
    s_nop 0
    global_load_lds_dwordx4 v105, s[22:23]
    ds_read_b64_tr_b16 v[192:193], v56 offset:24576
    ds_read_b64_tr_b16 v[194:195], v56 offset:57344
    ds_read_b64_tr_b16 v[196:197], v58 offset:24576
    ds_read_b64_tr_b16 v[198:199], v58 offset:57344
    ds_read_b64_tr_b16 v[200:201], v57 offset:24576
    ds_read_b64_tr_b16 v[202:203], v57 offset:57344
    ds_read_b64_tr_b16 v[204:205], v59 offset:24576
    ds_read_b64_tr_b16 v[206:207], v59 offset:57344
    v_lshlrev_b32 v99, 7, v97
    v_and_b32 v101, 1, v98
    v_lshl_add_u32 v100, v101, 18, v99
    global_load_dword v103, v100, s[48:49] sc1
    v_lshl_add_u32 v99, v101, 13, v99
    global_load_dword v103, v99, s[50:51] sc1
    global_load_dword v48, v102, s[84:85] sc1
    s_waitcnt lgkmcnt(0)
    s_waitcnt vmcnt(27)
    s_barrier
    s_xor_b32 s25, s19, 3
    s_lshl_b32 s25, s25, 15
    s_add_u32 s26, s25, 0
    s_add_u32 s22, s12, s26
    s_addc_u32 s23, s13, 0
    s_add_u32 m0, s24, 24576
    s_nop 0
    global_load_lds_dwordx4 v105, s[22:23]
    s_add_u32 s26, s25, 2048
    s_add_u32 s22, s12, s26
    s_addc_u32 s23, s13, 0
    s_add_u32 m0, s24, 25600
    s_nop 0
    global_load_lds_dwordx4 v105, s[22:23]
    s_add_u32 s26, s25, 8192
    s_add_u32 s22, s12, s26
    s_addc_u32 s23, s13, 0
    s_add_u32 m0, s24, 26624
    s_nop 0
    global_load_lds_dwordx4 v105, s[22:23]
    s_add_u32 s26, s25, 10240
    s_add_u32 s22, s12, s26
    s_addc_u32 s23, s13, 0
    s_add_u32 m0, s24, 27648
    s_nop 0
    global_load_lds_dwordx4 v105, s[22:23]
    ds_read_b64_tr_b16 v[208:209], v56 offset:28672
    ds_read_b64_tr_b16 v[210:211], v56 offset:61440
    ds_read_b64_tr_b16 v[212:213], v58 offset:28672
    ds_read_b64_tr_b16 v[214:215], v58 offset:61440
    ds_read_b64_tr_b16 v[216:217], v57 offset:28672
    ds_read_b64_tr_b16 v[218:219], v57 offset:61440
    ds_read_b64_tr_b16 v[220:221], v59 offset:28672
    ds_read_b64_tr_b16 v[222:223], v59 offset:61440
    s_waitcnt lgkmcnt(0)
Lc_pwe:
    s_waitcnt vmcnt(27)
    s_barrier
    s_xor_b32 s25, s19, 3
    s_lshl_b32 s25, s25, 15
    s_add_u32 s26, s25, 128
    s_add_u32 s22, s12, s26
    s_addc_u32 s23, s13, 0
    s_add_u32 m0, s24, 28672
    s_nop 0
    global_load_lds_dwordx4 v105, s[22:23]
    s_add_u32 s26, s25, 2176
    s_add_u32 s22, s12, s26
    s_addc_u32 s23, s13, 0
    s_add_u32 m0, s24, 29696
    s_nop 0
    global_load_lds_dwordx4 v105, s[22:23]
    s_add_u32 s26, s25, 8320
    s_add_u32 s22, s12, s26
    s_addc_u32 s23, s13, 0
    s_add_u32 m0, s24, 30720
    s_nop 0
    global_load_lds_dwordx4 v105, s[22:23]
    s_add_u32 s26, s25, 10368
    s_add_u32 s22, s12, s26
    s_addc_u32 s23, s13, 0
    s_add_u32 m0, s24, 31744
    s_nop 0
    global_load_lds_dwordx4 v105, s[22:23]
    ds_read_b64_tr_b16 v[176:177], v50 offset:0
    ds_read_b64_tr_b16 v[178:179], v50 offset:1024
    ds_read_b64_tr_b16 v[180:181], v50 offset:2048
    ds_read_b64_tr_b16 v[182:183], v50 offset:3072
    ds_read_b64_tr_b16 v[184:185], v51 offset:0
    ds_read_b64_tr_b16 v[186:187], v51 offset:1024
    ds_read_b64_tr_b16 v[188:189], v51 offset:2048
    ds_read_b64_tr_b16 v[190:191], v51 offset:3072
    ds_write_b128 v120, v[192:195] offset:0
    ds_write_b128 v120, v[196:199] offset:1024
    ds_write_b128 v120, v[200:203] offset:2048
    ds_write_b128 v120, v[204:207] offset:3072
    s_waitcnt vmcnt(27)
    ds_read_b64_tr_b16 v[192:193], v50 offset:4096
    ds_read_b64_tr_b16 v[194:195], v50 offset:5120
    ds_read_b64_tr_b16 v[196:197], v50 offset:6144
    ds_read_b64_tr_b16 v[198:199], v50 offset:7168
    ds_read_b64_tr_b16 v[200:201], v51 offset:4096
    ds_read_b64_tr_b16 v[202:203], v51 offset:5120
    ds_read_b64_tr_b16 v[204:205], v51 offset:6144
    ds_read_b64_tr_b16 v[206:207], v51 offset:7168
    ds_write_b128 v120, v[208:211] offset:4096
    ds_write_b128 v120, v[212:215] offset:5120
    ds_write_b128 v120, v[216:219] offset:6144
    ds_write_b128 v120, v[220:223] offset:7168
    s_waitcnt vmcnt(23)
    ds_read_b64_tr_b16 v[208:209], v50 offset:8192
    ds_read_b64_tr_b16 v[210:211], v50 offset:9216
    ds_read_b64_tr_b16 v[212:213], v50 offset:10240
    ds_read_b64_tr_b16 v[214:215], v50 offset:11264
    ds_read_b64_tr_b16 v[216:217], v51 offset:8192
    ds_read_b64_tr_b16 v[218:219], v51 offset:9216
    ds_read_b64_tr_b16 v[220:221], v51 offset:10240
    ds_read_b64_tr_b16 v[222:223], v51 offset:11264
    ds_write_b128 v120, v[224:227] offset:8192
    ds_write_b128 v120, v[228:231] offset:9216
    ds_write_b128 v120, v[232:235] offset:10240
    ds_write_b128 v120, v[236:239] offset:11264
    s_waitcnt vmcnt(19)
    ds_read_b64_tr_b16 v[224:225], v50 offset:12288
    ds_read_b64_tr_b16 v[226:227], v50 offset:13312
    ds_read_b64_tr_b16 v[228:229], v50 offset:14336
    ds_read_b64_tr_b16 v[230:231], v50 offset:15360
    ds_read_b64_tr_b16 v[232:233], v51 offset:12288
    ds_read_b64_tr_b16 v[234:235], v51 offset:13312
    ds_read_b64_tr_b16 v[236:237], v51 offset:14336
    ds_read_b64_tr_b16 v[238:239], v51 offset:15360
    ds_write_b128 v120, v[240:243] offset:12288
    ds_write_b128 v120, v[244:247] offset:13312
    ds_write_b128 v120, v[248:251] offset:14336
    ds_write_b128 v120, v[252:255] offset:15360
    s_waitcnt vmcnt(15)
    s_waitcnt vmcnt(8)
    v_cmp_eq_u32 vcc, 0x01010101, v48
    s_or_b32 s22, vcc_lo, 0xaaaaaaaa
    s_or_b32 s23, vcc_hi, 0xaaaaaaaa
    s_ff0_i32_b64 s86, s[22:23]
    s_min_u32 s86, s86, 100
    s_cmp_lg_u32 s86, 0
    s_cbranch_scc1 Lc_k1
    global_load_dword v48, v102, s[84:85] sc1
    global_load_dword v48, v102, s[84:85] sc1
    global_load_dword v48, v102, s[84:85] sc1
    s_branch Lc_k2
Lc_k1:
    s_mov_b32 m0, s68
    s_nop 0
    global_load_lds_dwordx4 v113, s[30:31] sc1
    global_load_lds_dwordx4 v113, s[30:31] offset:1024 sc1
    global_load_lds_dword v115, s[16:17] offset:2048 sc1
Lc_k2:
    ds_read_b64_tr_b16 v[240:241], v50 offset:16384
    ds_read_b64_tr_b16 v[242:243], v50 offset:17408
    ds_read_b64_tr_b16 v[244:245], v50 offset:18432
    ds_read_b64_tr_b16 v[246:247], v50 offset:19456
    ds_read_b64_tr_b16 v[248:249], v51 offset:16384
    ds_read_b64_tr_b16 v[250:251], v51 offset:17408
    ds_read_b64_tr_b16 v[252:253], v51 offset:18432
    ds_read_b64_tr_b16 v[254:255], v51 offset:19456
    ds_write_b128 v120, v[80:83] offset:16384
    ds_write_b128 v120, v[84:87] offset:17408
    ds_write_b128 v120, v[88:91] offset:18432
    ds_write_b128 v120, v[92:95] offset:19456
    s_waitcnt vmcnt(14)
    ds_read_b64_tr_b16 v[80:81], v50 offset:20480
    ds_read_b64_tr_b16 v[82:83], v50 offset:21504
    ds_read_b64_tr_b16 v[84:85], v50 offset:22528
    ds_read_b64_tr_b16 v[86:87], v50 offset:23552
    ds_read_b64_tr_b16 v[88:89], v51 offset:20480
    ds_read_b64_tr_b16 v[90:91], v51 offset:21504
    ds_read_b64_tr_b16 v[92:93], v51 offset:22528
    ds_read_b64_tr_b16 v[94:95], v51 offset:23552
    s_waitcnt lgkmcnt(0)
    ds_write_b128 v120, v[80:83] offset:20480
    ds_write_b128 v120, v[84:87] offset:21504
    ds_write_b128 v120, v[88:91] offset:22528
    ds_write_b128 v120, v[92:95] offset:23552
    s_waitcnt vmcnt(7)
    ds_read_b64_tr_b16 v[64:65], v50 offset:24576
    ds_read_b64_tr_b16 v[66:67], v50 offset:25600
    ds_read_b64_tr_b16 v[68:69], v50 offset:26624
    ds_read_b64_tr_b16 v[70:71], v50 offset:27648
    ds_read_b64_tr_b16 v[72:73], v51 offset:24576
    ds_read_b64_tr_b16 v[74:75], v51 offset:25600
    ds_read_b64_tr_b16 v[76:77], v51 offset:26624
    ds_read_b64_tr_b16 v[78:79], v51 offset:27648
    s_waitcnt lgkmcnt(0)
    ds_write_b128 v120, v[64:67] offset:24576
    ds_write_b128 v120, v[68:71] offset:25600
    ds_write_b128 v120, v[72:75] offset:26624
    ds_write_b128 v120, v[76:79] offset:27648
    s_waitcnt vmcnt(3)
    ds_read_b64_tr_b16 v[80:81], v50 offset:28672
    ds_read_b64_tr_b16 v[82:83], v50 offset:29696
    ds_read_b64_tr_b16 v[84:85], v50 offset:30720
    ds_read_b64_tr_b16 v[86:87], v50 offset:31744
    ds_read_b64_tr_b16 v[88:89], v51 offset:28672
    ds_read_b64_tr_b16 v[90:91], v51 offset:29696
    ds_read_b64_tr_b16 v[92:93], v51 offset:30720
    ds_read_b64_tr_b16 v[94:95], v51 offset:31744
    s_waitcnt lgkmcnt(0)
    ds_write_b128 v120, v[80:83] offset:28672
    ds_write_b128 v120, v[84:87] offset:29696
    ds_write_b128 v120, v[88:91] offset:30720
    ds_write_b128 v120, v[92:95] offset:31744
    s_cmp_lg_u32 s86, 0
    s_cbranch_scc1 Lc_kwe
    s_mov_b32 s21, 0
Lc_kw:
    s_waitcnt vmcnt(0)
    v_cmp_eq_u32 vcc, 0x01010101, v48
    s_or_b32 s22, vcc_lo, 0xaaaaaaaa
    s_or_b32 s23, vcc_hi, 0xaaaaaaaa
    s_ff0_i32_b64 s86, s[22:23]
    s_min_u32 s86, s86, 100
    s_cmp_lg_u32 s86, 0
    s_cbranch_scc1 Lc_kwd
    s_sleep 2
    global_load_dword v48, v102, s[84:85] sc1
    s_add_u32 s21, s21, 1
    s_cmp_gt_u32 s21, 200000
    s_cbranch_scc1 Lc_end
    s_branch Lc_kw
Lc_kwd:
    s_mov_b32 m0, s68
    s_nop 0
    global_load_lds_dwordx4 v113, s[30:31] sc1
    global_load_lds_dwordx4 v113, s[30:31] offset:1024 sc1
    global_load_lds_dword v115, s[16:17] offset:2048 sc1
Lc_kwe:
    s_mov_b64 s[12:13], s[30:31]
    s_mov_b32 s20, 0
    s_mov_b32 s21, 0
    s_not_b64 s[4:5], s[54:55]
    s_mov_b32 s8, 0x3f803f80
    s_mov_b32 s9, 0x3f803f80
    s_mov_b32 s10, 0x3f003f00
    s_mov_b32 s11, 0x3f003f00
    ds_read_b128 v[64:67], v120 offset:0
    ds_read_b128 v[68:71], v120 offset:1024
    ds_read_b128 v[72:75], v120 offset:2048
    ds_read_b128 v[76:79], v120 offset:3072
    ds_read_b128 v[80:83], v120 offset:4096
    ds_read_b128 v[84:87], v120 offset:5120
    ds_read_b128 v[88:91], v120 offset:6144
    ds_read_b128 v[92:95], v120 offset:7168
    v_min_u32 v0, -2, v0
    v_min_u32 v1, -2, v1
    v_min_u32 v2, -2, v2
    v_min_u32 v3, -2, v3
    v_min_u32 v4, -2, v4
    v_min_u32 v5, -2, v5
    v_min_u32 v6, -2, v6
    v_min_u32 v7, -2, v7
    s_and_b32 s25, s20, 1
    s_lshl_b32 s27, s25, 13
    s_add_u32 s42, s50, s27
    s_addc_u32 s43, s51, 0
    s_xor_b32 s26, s25, 1
    ds_read_b128 v[16:19], v120 offset:8192
    ds_read_b128 v[20:23], v120 offset:9216
    ds_read_b128 v[24:27], v120 offset:10240
    ds_read_b128 v[28:31], v120 offset:11264
    v_mov_b64 v[32:33], 0
    v_mov_b64 v[34:35], 0
    v_mov_b64 v[36:37], 0
    v_mov_b64 v[38:39], 0
    v_mov_b64 v[40:41], 0
    v_mov_b64 v[42:43], 0
    v_mov_b64 v[44:45], 0
    v_mov_b64 v[46:47], 0
    v_mov_b64 v[104:105], 0
    v_mov_b64 v[106:107], 0
    v_mov_b64 v[108:109], 0
    v_mov_b64 v[110:111], 0
    s_mov_b32 exec_hi, 0
    v_add_u32 v115, 262144, v115
    s_mov_b32 exec_hi, -1
    s_lshl_b32 s27, s26, 13
    s_add_u32 s44, s52, s27
    s_addc_u32 s45, s53, 0
    s_lshl_b32 s27, s26, 18
    s_add_u32 s40, s48, s27
    s_addc_u32 s41, s49, 0
    s_lshl_b32 s27, s25, 18
    s_add_u32 s34, s46, s27
    s_addc_u32 s35, s47, 0
    s_add_u32 s36, s34, 32768
    s_addc_u32 s37, s35, 0
    s_add_u32 s38, s48, s27
    s_addc_u32 s39, s49, 0
    s_add_u32 s30, s12, 16777216
    s_addc_u32 s31, s13, 0
    s_add_u32 s12, s12, 262144
    s_addc_u32 s13, s13, 0
    s_add_u32 s32, s32, 131072
    s_addc_u32 s33, s33, 0
    s_mul_i32 s27, s26, 9216
    s_add_u32 m0, s27, s68
    s_mul_i32 s27, s25, 9216
    s_add_u32 s27, s27, 139264
    v_add_u32 v114, s27, v113
    s_lshl_b32 s27, s19, 11
    s_add_u32 s27, s27, 131072
    v_add_u32 v99, s27, v113
    s_add_u32 s27, s20, 0
    v_mov_b32 v100, s27
    v_xor_b32 v96, 2048, v99
    v_xor_b32 v97, 4096, v99
    v_xor_b32 v98, 6144, v99
    s_waitcnt vmcnt(0) lgkmcnt(0)
    s_cmp_lg_u32 s3, 0
    s_cbranch_scc1 Lc_s_try
    s_branch Lc_try
s_nop 0
s_nop 0
s_nop 0
s_nop 0
s_nop 0
s_nop 0
s_nop 0
Lc_retry:
    s_add_u32 s21, s21, 1
    s_cmp_gt_u32 s21, 200000
    s_cbranch_scc1 Lc_end
    s_nop 6
    v_mov_b64 v[104:105], 0
    v_mov_b64 v[106:107], 0
    v_mov_b64 v[108:109], 0
    v_mov_b64 v[110:111], 0
    s_waitcnt vmcnt(1)
    v_smfmac_f32_16x16x64_bf16 v[104:107], v[56:59], v[64:71], v112
    ds_write_b128 v99, v[56:59]
    v_smfmac_f32_16x16x64_bf16 v[108:111], v[56:59], v[72:79], v112
    s_waitcnt vmcnt(0)
    ds_write_b128 v99, v[60:63] offset:1024
    v_max3_u32 v8, v56, v58, v60
    v_max_u32 v8, v8, v62
    v_mov_b64 v[0:1], v[56:57]
    v_mov_b64 v[2:3], v[58:59]
    v_smfmac_f32_16x16x64_bf16 v[104:107], v[60:63], v[80:87], v112
    v_cmp_eq_u32 vcc, -1, v8
    v_mov_b64 v[4:5], v[60:61]
    v_mov_b64 v[6:7], v[62:63]
    v_smfmac_f32_16x16x64_bf16 v[108:111], v[60:63], v[88:95], v112
    s_cbranch_vccz Lc_try2
    global_load_dwordx4 v[56:59], v113, s[42:43] sc1
    global_load_dwordx4 v[60:63], v113, s[42:43] offset:1024 sc1
    s_branch Lc_retry
s_nop 0
s_nop 0
s_nop 0
s_nop 0
s_nop 0
Lc_step:
    v_lshrrev_b32 v101, 2, v113
    v_add_u32 v102, m0, v101
    ds_read_b32 v102, v102 offset:2048
    s_and_b32 s25, s20, 1
    s_lshl_b32 s27, s25, 13
    s_add_u32 s42, s50, s27
    s_addc_u32 s43, s51, 0
    s_xor_b32 s26, s25, 1
    ds_read_b128 v[16:19], v120 offset:8192
    ds_read_b128 v[20:23], v120 offset:9216
    ds_read_b128 v[24:27], v120 offset:10240
    ds_read_b128 v[28:31], v120 offset:11264
    v_mov_b64 v[32:33], 0
    v_mov_b64 v[34:35], 0
    v_mov_b64 v[36:37], 0
    v_mov_b64 v[38:39], 0
    v_mov_b64 v[40:41], 0
    v_mov_b64 v[42:43], 0
    v_mov_b64 v[44:45], 0
    v_mov_b64 v[46:47], 0
    v_mov_b64 v[104:105], 0
    v_mov_b64 v[106:107], 0
    v_mov_b64 v[108:109], 0
    v_mov_b64 v[110:111], 0
    s_nop 14
    s_cmp_eq_u32 s19, 3
    s_cbranch_scc1 Lc_p1
    s_nop 1
    s_cmp_eq_u32 s19, 2
    s_cbranch_scc1 Lc_p1
    s_nop 1
    s_cmp_eq_u32 s19, 1
    s_cbranch_scc1 Lc_p1
    s_nop 7
Lc_p1:
    global_load_dwordx4 v[0:3], v113, s[42:43] sc1
    global_load_dwordx4 v[4:7], v113, s[42:43] offset:1024 sc1
    s_mov_b32 exec_hi, 0
    v_add_u32 v115, 262144, v115
    s_mov_b32 exec_hi, -1
    s_lshl_b32 s27, s26, 13
    s_add_u32 s44, s52, s27
    s_addc_u32 s45, s53, 0
    s_lshl_b32 s27, s26, 18
    s_add_u32 s40, s48, s27
    s_addc_u32 s41, s49, 0
    s_lshl_b32 s27, s25, 18
    s_add_u32 s34, s46, s27
    s_addc_u32 s35, s47, 0
    s_add_u32 s36, s34, 32768
    s_addc_u32 s37, s35, 0
    s_add_u32 s38, s48, s27
    s_addc_u32 s39, s49, 0
    s_add_u32 s30, s12, 16777216
    s_addc_u32 s31, s13, 0
    s_add_u32 s12, s12, 262144
    s_addc_u32 s13, s13, 0
    s_add_u32 s32, s32, 131072
    s_addc_u32 s33, s33, 0
    s_mul_i32 s27, s26, 9216
    s_add_u32 m0, s27, s68
    s_mul_i32 s27, s25, 9216
    s_add_u32 s27, s27, 139264
    v_add_u32 v114, s27, v113
    s_lshl_b32 s27, s19, 11
    s_add_u32 s27, s27, 131072
    v_add_u32 v99, s27, v113
    s_add_u32 s27, s20, 0
    v_mov_b32 v100, s27
    v_xor_b32 v96, 2048, v99
    v_xor_b32 v97, 4096, v99
    v_xor_b32 v98, 6144, v99
    s_waitcnt lgkmcnt(0)
    v_cmp_eq_u32 vcc, 0x01010101, v102
    s_add_u32 s25, s20, 1
    s_ff0_i32_b32 s86, vcc_hi
    s_lshl_b32 s86, s86, 1
    s_cmp_lt_u32 s25, s86
    s_cbranch_scc0 Lc_rp
Lc_rk:
    global_load_dwordx4 v[56:59], v113, s[42:43] sc1
    global_load_dwordx4 v[60:63], v113, s[42:43] offset:1024 sc1
    s_waitcnt vmcnt(3) lgkmcnt(0)
Lc_try:
    v_smfmac_f32_16x16x64_bf16 v[104:107], v[0:3], v[64:71], v112
    ds_write_b128 v99, v[0:3]
    v_smfmac_f32_16x16x64_bf16 v[108:111], v[0:3], v[72:79], v112
    s_waitcnt vmcnt(2)
    ds_write_b128 v99, v[4:7] offset:1024
    v_max3_u32 v8, v0, v2, v4
    v_max_u32 v8, v8, v6
    v_smfmac_f32_16x16x64_bf16 v[104:107], v[4:7], v[80:87], v112
    v_cmp_eq_u32 vcc, -1, v8
    v_smfmac_f32_16x16x64_bf16 v[108:111], v[4:7], v[88:95], v112
    s_cbranch_vccnz Lc_retry
Lc_try2:
    v_smfmac_f32_16x16x64_bf16 v[40:43], v[0:3], v[16:23], v112
    global_store_dwordx4 v113, v[124:127], s[32:33] sc1
    s_waitcnt lgkmcnt(0)
    s_barrier
    ds_read_b128 v[8:11], v96 offset:0
    ds_read_b128 v[12:15], v96 offset:1024
    v_smfmac_f32_16x16x64_bf16 v[44:47], v[0:3], v[24:31], v112
    ds_read_b128 v[16:19], v97 offset:0
    v_smfmac_f32_16x16x64_bf16 v[40:43], v[4:7], a[96:103], v112
    ds_read_b128 v[20:23], v97 offset:1024
    v_smfmac_f32_16x16x64_bf16 v[44:47], v[4:7], a[104:111], v112
    ds_read_b128 v[24:27], v98 offset:0
    global_load_dwordx4 v[56:59], v113, s[30:31] offset:0 sc1
    v_smfmac_f32_16x16x64_bf16 v[32:35], v[0:3], a[176:183], v112
    ds_read_b128 v[28:31], v98 offset:1024
    v_smfmac_f32_16x16x64_bf16 v[36:39], v[0:3], a[184:191], v112
    ds_read_b128 v[64:67], v120 offset:12288
    global_load_dwordx4 v[60:63], v113, s[30:31] offset:1024 sc1
    v_smfmac_f32_16x16x64_bf16 v[32:35], v[4:7], a[192:199], v112
    ds_read_b128 v[68:71], v120 offset:13312
    v_smfmac_f32_16x16x64_bf16 v[36:39], v[4:7], a[200:207], v112
    ds_read_b128 v[72:75], v120 offset:14336
    s_waitcnt lgkmcnt(8)
    v_smfmac_f32_16x16x64_bf16 v[104:107], v[8:11], a[0:7], v112
    s_waitcnt lgkmcnt(7)
    ds_read_b128 v[76:79], v120 offset:15360
    v_mov_b32 v4, -1
    v_smfmac_f32_16x16x64_bf16 v[104:107], v[12:15], a[16:23], v112
    s_waitcnt lgkmcnt(7)
    ds_read_b128 v[80:83], v120 offset:16384
    global_store_dword v119, v4, s[44:45]
    v_smfmac_f32_16x16x64_bf16 v[104:107], v[16:19], a[32:39], v112
    s_waitcnt lgkmcnt(7)
    ds_read_b128 v[84:87], v120 offset:17408
    v_smfmac_f32_16x16x64_bf16 v[104:107], v[20:23], a[48:55], v112
    s_waitcnt lgkmcnt(7)
    ds_read_b128 v[88:91], v120 offset:18432
    global_load_lds_dwordx4 v113, s[12:13] offset:0 sc1
    v_smfmac_f32_16x16x64_bf16 v[104:107], v[24:27], a[64:71], v112
    s_waitcnt lgkmcnt(7)
    ds_read_b128 v[92:95], v120 offset:19456
    v_mov_b64 v[0:1], 0
    v_smfmac_f32_16x16x64_bf16 v[104:107], v[28:31], a[80:87], v112
    s_mov_b64 exec, s[100:101]
    global_store_dword v113, v100, s[28:29] sc1
    s_mov_b64 exec, -1
    v_mov_b64 v[2:3], 0
    v_smfmac_f32_16x16x64_bf16 v[108:111], v[8:11], a[8:15], v112
    v_smfmac_f32_16x16x64_bf16 v[108:111], v[12:15], a[24:31], v112
    s_waitcnt lgkmcnt(6)
    v_add_f32 v104, v104, v106
    v_smfmac_f32_16x16x64_bf16 v[40:43], v[24:27], v[64:71], v112
    s_waitcnt lgkmcnt(4)
    global_load_lds_dwordx4 v113, s[12:13] offset:1024 sc1
    v_add_f32 v105, v105, v107
    v_smfmac_f32_16x16x64_bf16 v[44:47], v[24:27], v[72:79], v112
    s_waitcnt lgkmcnt(2)
    v_cvt_pk_bf16_f32 v102, v104, v105
    v_smfmac_f32_16x16x64_bf16 v[40:43], v[28:31], v[80:87], v112
    s_waitcnt lgkmcnt(0)
    ds_write_b32 v116, v102 offset:0
    v_smfmac_f32_16x16x64_bf16 v[44:47], v[28:31], v[88:95], v112
    global_load_lds_dword v115, s[16:17] offset:2048 sc1
    v_smfmac_f32_16x16x64_bf16 v[108:111], v[16:19], a[40:47], v112
    ds_read_b128 v[64:67], v114 offset:0
    v_smfmac_f32_16x16x64_bf16 v[108:111], v[20:23], a[56:63], v112
    ds_read_b128 v[68:71], v114 offset:1024
    v_smfmac_f32_16x16x64_bf16 v[108:111], v[24:27], a[72:79], v112
    ds_read_b128 v[72:75], v114 offset:2304
    v_smfmac_f32_16x16x64_bf16 v[108:111], v[28:31], a[88:95], v112
    ds_read_b128 v[76:79], v114 offset:3328
    global_store_dword v113, v4, s[40:41] offset:0
    v_smfmac_f32_16x16x64_bf16 v[40:43], v[8:11], a[112:119], v112
    ds_read_b128 v[80:83], v114 offset:4608
    v_smfmac_f32_16x16x64_bf16 v[40:43], v[12:15], a[128:135], v112
    ds_read_b128 v[84:87], v114 offset:5632
    v_add_f32 v108, v108, v110
    v_smfmac_f32_16x16x64_bf16 v[40:43], v[16:19], a[144:151], v112
    ds_read_b128 v[88:91], v114 offset:6912
    v_add_f32 v109, v109, v111
    v_smfmac_f32_16x16x64_bf16 v[40:43], v[20:23], a[160:167], v112
    ds_read_b128 v[92:95], v114 offset:7936
    global_store_dword v113, v4, s[40:41] offset:1024
    v_cvt_pk_bf16_f32 v103, v108, v109
    v_smfmac_f32_16x16x64_bf16 v[44:47], v[8:11], a[120:127], v112
    ds_write_b32 v116, v103 offset:512
    v_smfmac_f32_16x16x64_bf16 v[44:47], v[12:15], a[136:143], v112
    v_add_f32 v40, v40, v42
    v_smfmac_f32_16x16x64_bf16 v[44:47], v[16:19], a[152:159], v112
    v_add_f32 v41, v41, v43
    v_smfmac_f32_16x16x64_bf16 v[44:47], v[20:23], a[168:175], v112
    v_cvt_pk_bf16_f32 v124, v40, v41
    v_smfmac_f32_16x16x64_bf16 v[32:35], v[16:19], a[240:247], v112
    ds_write_b32 v116, v124 offset:4
    v_smfmac_f32_16x16x64_bf16 v[36:39], v[16:19], a[248:255], v112
    v_add_f32 v44, v44, v46
    v_add_f32 v45, v45, v47
    v_cvt_pk_bf16_f32 v125, v44, v45
    ds_write_b32 v116, v125 offset:516
    v_smfmac_f32_16x16x64_bf16 v[32:35], v[20:23], v[128:135], v112
    s_mov_b64 vcc, s[4:5]
    s_cmp_eq_u32 s20, 63
    v_mov_b64 v[108:109], s[8:9]
    v_smfmac_f32_16x16x64_bf16 v[36:39], v[20:23], v[136:143], v112
    v_mov_b64 v[110:111], s[10:11]
    v_smfmac_f32_16x16x64_bf16 v[32:35], v[24:27], v[144:151], v112
    v_mov_b32 v103, s69
    v_smfmac_f32_16x16x64_bf16 v[36:39], v[24:27], v[152:159], v112
    s_waitcnt lgkmcnt(0)
    s_barrier
    ds_read_b64_tr_b16 v[40:41], v117 offset:0
    ds_read_b64_tr_b16 v[42:43], v117 offset:512
    v_smfmac_f32_16x16x64_bf16 v[32:35], v[28:31], v[160:167], v112
    ds_read_b64_tr_b16 v[44:45], v117 offset:1024
    ds_read_b64_tr_b16 v[46:47], v117 offset:1536
    v_mov_b64 v[6:7], 0
    v_smfmac_f32_16x16x64_bf16 v[36:39], v[28:31], v[168:175], v112
    ds_read_b64_tr_b16 v[48:49], v117 offset:2048
    ds_read_b64_tr_b16 v[50:51], v117 offset:2560
    v_mov_b64 v[4:5], 0
    v_smfmac_f32_16x16x64_bf16 v[32:35], v[8:11], a[208:215], v112
    ds_read_b64_tr_b16 v[52:53], v117 offset:3072
    ds_read_b64_tr_b16 v[54:55], v117 offset:3584
    v_smfmac_f32_16x16x64_bf16 v[36:39], v[8:11], a[216:223], v112
    ds_read_b128 v[16:19], v120 offset:28672
    v_smfmac_f32_16x16x64_bf16 v[32:35], v[12:15], a[224:231], v112
    ds_read_b128 v[20:23], v120 offset:29696
    v_smfmac_f32_16x16x64_bf16 v[36:39], v[12:15], a[232:239], v112
    ds_read_b128 v[24:27], v120 offset:30720
    s_cbranch_scc1 Lc_last
    s_waitcnt lgkmcnt(7)
    v_mfma_f32_16x16x32_bf16 v[96:99], v[64:67], v[40:43], 0
    ds_read_b128 v[28:31], v120 offset:31744
    v_mfma_f32_16x16x32_bf16 v[104:107], v[68:71], v[40:43], 0
    v_add_f32 v32, v32, v34
    v_add_f32 v33, v33, v35
    v_mfma_f32_16x16x32_bf16 v[96:99], v[72:75], v[44:47], v[96:99]
    v_cvt_pk_bf16_f32 v126, v32, v33
    v_add_f32 v36, v36, v38
    v_mfma_f32_16x16x32_bf16 v[104:107], v[76:79], v[44:47], v[104:107]
    s_waitcnt lgkmcnt(4)
    v_add_f32 v37, v37, v39
    v_mfma_f32_16x16x32_bf16 v[96:99], v[80:83], v[48:51], v[96:99]
    ds_read_b128 v[64:67], v120 offset:20480
    v_cvt_pk_bf16_f32 v127, v36, v37
    v_mfma_f32_16x16x32_bf16 v[104:107], v[84:87], v[48:51], v[104:107]
    ds_read_b128 v[68:71], v120 offset:21504
    v_mfma_f32_16x16x32_bf16 v[96:99], v[88:91], v[52:55], v[96:99]
    ds_read_b128 v[72:75], v120 offset:22528
    ds_read_b128 v[80:83], v120 offset:24576
    v_mfma_f32_16x16x32_bf16 v[104:107], v[92:95], v[52:55], v[104:107]
    ds_read_b128 v[76:79], v120 offset:23552
    ds_read_b128 v[84:87], v120 offset:25600
    v_mfma_f32_16x16x32_bf16 v[32:35], v[40:43], v[40:43], 0
    ds_read_b128 v[88:91], v120 offset:26624
    ds_read_b128 v[92:95], v120 offset:27648
    v_mfma_f32_16x16x32_bf16 v[32:35], v[44:47], v[44:47], v[32:35]
    v_cndmask_b32_dpp v96, v104, v96, vcc quad_perm:[0,1,0,1] row_mask:0xf bank_mask:0xf
    v_cndmask_b32_dpp v97, v105, v97, vcc quad_perm:[0,1,0,1] row_mask:0xf bank_mask:0xf
    v_mfma_f32_16x16x32_bf16 v[32:35], v[48:51], v[48:51], v[32:35]
    v_cndmask_b32_dpp v98, v106, v98, vcc quad_perm:[0,1,0,1] row_mask:0xf bank_mask:0xf
    v_cndmask_b32_dpp v99, v107, v99, vcc quad_perm:[0,1,0,1] row_mask:0xf bank_mask:0xf
    v_mfma_f32_16x16x32_bf16 v[32:35], v[52:55], v[52:55], v[32:35]
    v_max3_f32 v100, v96, v97, v98
    v_max_f32 v100, v100, v99
    s_nop 1
    v_max_f32_dpp v100, v100, v100 quad_perm:[2,3,0,1] row_mask:0xf bank_mask:0xf
    v_mul_f32 v100, v100, v103
    s_nop 1
    v_mul_f32_dpp v32, v34, v103 quad_perm:[0,1,0,1] row_mask:0xf bank_mask:0xf
    v_mul_f32_dpp v33, v35, v103 quad_perm:[0,1,0,1] row_mask:0xf bank_mask:0xf
    v_max3_f32 v101, v100, v32, v33
    v_max3_f32 v100, v100, v32, v33
    v_mov_b64 v[14:15], 0
    v_mov_b64 v[12:13], 0
    v_permlane16_swap_b32 v100, v101
    v_max_f32 v102, v100, v101
    v_max_f32 v100, v100, v101
    v_mov_b64 v[10:11], 0
    v_mov_b64 v[8:9], 0
    v_permlane32_swap_b32 v100, v102
    v_max_f32 v100, v100, v102
    v_pk_add_f32 v[32:33], v[32:33], v[100:101] op_sel_hi:[1,0] neg_lo:[0,1] neg_hi:[0,1]
    v_pk_fma_f32 v[96:97], v[96:97], v[102:103], v[100:101] op_sel:[0,1,0] op_sel_hi:[1,1,0] neg_lo:[0,0,1] neg_hi:[0,0,1]
    v_pk_fma_f32 v[98:99], v[98:99], v[102:103], v[100:101] op_sel:[0,1,0] op_sel_hi:[1,1,0] neg_lo:[0,0,1] neg_hi:[0,0,1]
    v_exp_f32 v32, v32
    v_exp_f32 v33, v33
    v_exp_f32 v96, v96
    v_exp_f32 v97, v97
    v_cvt_pk_bf16_f32 v32, v32, v33
    v_exp_f32 v98, v98
    v_exp_f32 v99, v99
    v_cvt_pk_bf16_f32 v104, v96, v97
    v_and_b32 v106, v32, v122
    v_and_b32 v107, v32, v123
    v_cvt_pk_bf16_f32 v105, v98, v99
    v_and_b32 v40, v104, v122
    v_mfma_f32_16x16x16_bf16 v[48:51], v[126:127], v[106:107], 0
    v_and_b32_dpp v42, v104, v122 quad_perm:[2,3,0,1] row_mask:0xf bank_mask:0xf
    v_and_b32 v41, v105, v122
    v_mfma_f32_16x16x32_bf16 v[52:55], v[108:111], v[104:107], 0
    s_waitcnt vmcnt(8)
    v_and_b32_dpp v43, v105, v122 quad_perm:[2,3,0,1] row_mask:0xf bank_mask:0xf
    v_and_b32_dpp v44, v104, v123 quad_perm:[2,3,0,1] row_mask:0xf bank_mask:0xf
    v_and_b32_dpp v45, v105, v123 quad_perm:[2,3,0,1] row_mask:0xf bank_mask:0xf
    v_mfma_f32_16x16x32_bf16 v[48:51], v[56:59], v[40:43], v[48:51]
    v_and_b32 v46, v104, v123
    v_and_b32 v47, v105, v123
    v_and_b32 v100, -9, v121
    s_waitcnt vmcnt(7)
    v_mfma_f32_16x16x32_bf16 v[48:51], v[60:63], v[44:47], v[48:51]
    v_add_f32_dpp v52, v52, v52 quad_perm:[2,3,0,1] row_mask:0xf bank_mask:0xf
    v_rcp_f32 v52, v52
    v_xor_b32 v102, 1024, v100
    v_xor_b32 v103, 1536, v100
    v_xor_b32 v101, 512, v100
    s_nop 2
    v_pk_mul_f32 v[48:49], v[48:49], v[52:53] op_sel_hi:[1,0]
    v_pk_mul_f32 v[50:51], v[50:51], v[52:53] op_sel_hi:[1,0]
    v_cvt_pk_bf16_f32 v48, v48, v49
    v_cvt_pk_bf16_f32 v49, v50, v51
    ds_write_b64 v121, v[48:49]
    ds_read_b128 v[40:43], v100
    s_waitcnt lgkmcnt(1)
    s_barrier
    ds_read_b128 v[44:47], v101
    ds_read_b128 v[48:51], v102
    ds_read_b128 v[52:55], v103
    s_waitcnt lgkmcnt(3)
    v_smfmac_f32_16x16x64_bf16 v[0:3], v[40:43], v[176:183], v112
    v_smfmac_f32_16x16x64_bf16 v[4:7], v[40:43], v[184:191], v112
    v_smfmac_f32_16x16x64_bf16 v[8:11], v[40:43], v[192:199], v112
    s_waitcnt vmcnt(6)
    v_smfmac_f32_16x16x64_bf16 v[12:15], v[40:43], v[200:207], v112
    s_waitcnt lgkmcnt(2)
    v_smfmac_f32_16x16x64_bf16 v[0:3], v[44:47], v[208:215], v112
    s_waitcnt lgkmcnt(1)
    v_smfmac_f32_16x16x64_bf16 v[0:3], v[48:51], v[240:247], v112
    s_waitcnt lgkmcnt(0)
    v_smfmac_f32_16x16x64_bf16 v[0:3], v[52:55], v[80:87], v112
    v_smfmac_f32_16x16x64_bf16 v[4:7], v[44:47], v[216:223], v112
    v_mov_b32 v98, 0x3f80
    v_smfmac_f32_16x16x64_bf16 v[4:7], v[48:51], v[248:255], v112
    v_cvt_pk_bf16_f32 v32, v0, v1
    v_smfmac_f32_16x16x64_bf16 v[4:7], v[52:55], v[88:95], v112
    global_store_dword v118, v32, s[34:35] offset:-4096
    v_cvt_pk_bf16_f32 v33, v2, v3
    v_smfmac_f32_16x16x64_bf16 v[8:11], v[44:47], v[224:231], v112
    global_store_dword v118, v33, s[36:37] offset:-4096
    v_mov_b32 v99, 0x3f800000
    v_smfmac_f32_16x16x64_bf16 v[8:11], v[48:51], v[64:71], v112
    v_cvt_pk_bf16_f32 v34, v4, v5
    v_smfmac_f32_16x16x64_bf16 v[8:11], v[52:55], v[16:23], v112
    global_store_dword v118, v34, s[34:35] offset:-2048
    v_cvt_pk_bf16_f32 v35, v6, v7
    v_smfmac_f32_16x16x64_bf16 v[12:15], v[44:47], v[232:239], v112
    global_store_dword v118, v35, s[36:37] offset:-2048
    v_cndmask_b32 v98, v98, v99, s[64:65]
    v_smfmac_f32_16x16x64_bf16 v[12:15], v[48:51], v[72:79], v112
    v_cvt_pk_bf16_f32 v36, v8, v9
    v_smfmac_f32_16x16x64_bf16 v[12:15], v[52:55], v[24:31], v112
    global_store_dword v118, v36, s[34:35] offset:0
    v_cvt_pk_bf16_f32 v37, v10, v11
    v_cndmask_b32 v100, 0, v98, s[56:57]
    global_store_dword v118, v37, s[36:37] offset:0
    v_cndmask_b32 v101, 0, v98, s[58:59]
    v_cndmask_b32 v102, 0, v98, s[60:61]
    v_cndmask_b32 v103, 0, v98, s[62:63]
    s_nop 0
    v_cvt_pk_bf16_f32 v38, v12, v13
    v_cvt_pk_bf16_f32 v39, v14, v15
    global_store_dword v118, v38, s[34:35] offset:2048
    global_store_dword v118, v39, s[36:37] offset:2048
    ds_read_b128 v[64:67], v120 offset:0
    ds_read_b128 v[68:71], v120 offset:1024
    ds_read_b128 v[72:75], v120 offset:2048
    ds_read_b128 v[76:79], v120 offset:3072
    ds_read_b128 v[80:83], v120 offset:4096
    ds_read_b128 v[84:87], v120 offset:5120
    ds_read_b128 v[88:91], v120 offset:6144
    ds_read_b128 v[92:95], v120 offset:7168
    s_nop 0
    s_nop 14
    s_nop 7
    s_cmp_eq_u32 s19, 0
    s_cbranch_scc1 Lc_p0
    s_nop 5
    s_cmp_eq_u32 s19, 1
    s_cbranch_scc1 Lc_p0
    s_nop 3
    s_cmp_eq_u32 s19, 2
    s_cbranch_scc1 Lc_p0
    s_nop 5
Lc_p0:
    global_load_dwordx4 v[8:11], v113, s[38:39] sc1
    global_load_dwordx4 v[12:15], v113, s[38:39] offset:1024 sc1
    s_nop 15
    s_nop 15
    s_nop 5
Lc_pa:
    global_load_dwordx4 v[56:59], v113, s[38:39] sc1
    global_load_dwordx4 v[60:63], v113, s[38:39] offset:1024 sc1
    s_waitcnt vmcnt(3)
    v_mfma_f32_16x16x32_bf16 v[104:107], v[100:103], v[8:11], 0
    s_waitcnt vmcnt(2)
    v_mfma_f32_16x16x32_bf16 v[104:107], v[100:103], v[12:15], v[104:107]
    v_max_u32 v96, v8, v12
    v_cmp_eq_u32 vcc, -1, v96
    s_cbranch_vccnz Lc_pb
Lc_qa:
    s_nop 4
    v_add_f32_dpp v104, v104, v104 row_ror:8 row_mask:0xf bank_mask:0xf
    v_add_f32_dpp v105, v105, v105 row_ror:8 row_mask:0xf bank_mask:0xf
    s_nop 0
    v_add_f32_dpp v104, v104, v104 row_ror:4 row_mask:0xf bank_mask:0xf
    v_add_f32_dpp v105, v105, v105 row_ror:4 row_mask:0xf bank_mask:0xf
    v_cvt_pk_bf16_f32 v104, v104, v105
    global_store_dword v119, v104, s[44:45]
    s_mov_b64 exec, -1
    s_add_u32 s20, s20, 1
    s_branch Lc_step
s_nop 0
s_nop 0
Lc_pb:
    global_load_dwordx4 v[8:11], v113, s[38:39] sc1
    global_load_dwordx4 v[12:15], v113, s[38:39] offset:1024 sc1
    s_add_u32 s21, s21, 1
    s_cmp_gt_u32 s21, 200000
    s_cbranch_scc1 Lc_end
    s_waitcnt vmcnt(3)
    v_mfma_f32_16x16x32_bf16 v[104:107], v[100:103], v[56:59], 0
    s_waitcnt vmcnt(2)
    v_mfma_f32_16x16x32_bf16 v[104:107], v[100:103], v[60:63], v[104:107]
    v_max_u32 v96, v56, v60
    v_cmp_eq_u32 vcc, -1, v96
    s_cbranch_vccnz Lc_pa
Lc_qb:
    s_nop 4
    v_add_f32_dpp v104, v104, v104 row_ror:8 row_mask:0xf bank_mask:0xf
    v_add_f32_dpp v105, v105, v105 row_ror:8 row_mask:0xf bank_mask:0xf
    s_nop 0
    v_add_f32_dpp v104, v104, v104 row_ror:4 row_mask:0xf bank_mask:0xf
    v_add_f32_dpp v105, v105, v105 row_ror:4 row_mask:0xf bank_mask:0xf
    v_cvt_pk_bf16_f32 v104, v104, v105
    global_store_dword v119, v104, s[44:45]
    s_mov_b64 exec, -1
    s_add_u32 s20, s20, 1
    s_branch Lc_step
Lc_rp:
    global_load_dword v102, v101, s[84:85] sc1
    s_add_u32 s21, s21, 1
    s_cmp_gt_u32 s21, 200000
    s_cbranch_scc1 Lc_end
    s_waitcnt vmcnt(0)
    v_cmp_eq_u32 vcc, 0x01010101, v102
    s_or_b32 s22, vcc_lo, 0xaaaaaaaa
    s_or_b32 s23, vcc_hi, 0xaaaaaaaa
    s_ff0_i32_b64 s86, s[22:23]
    s_min_u32 s86, s86, 100
    s_cmp_lt_u32 s25, s86
    s_cbranch_scc1 Lc_rk
    s_sleep 2
    s_branch Lc_rp
Lc_last:
    s_nop 7
    v_add_f32 v32, v32, v34
    v_add_f32 v33, v33, v35
    v_cvt_pk_bf16_f32 v126, v32, v33
    v_add_f32 v36, v36, v38
    v_add_f32 v37, v37, v39
    v_cvt_pk_bf16_f32 v127, v36, v37
    s_branch Lc_end
Lc_s_retry:
    s_add_u32 s21, s21, 1
    s_cmp_gt_u32 s21, 200000
    s_cbranch_scc1 Lc_end
    s_waitcnt vmcnt(0)
    v_mov_b64 v[0:1], v[56:57]
    v_mov_b64 v[2:3], v[58:59]
    v_mov_b64 v[4:5], v[60:61]
    v_mov_b64 v[6:7], v[62:63]
    global_load_dwordx4 v[56:59], v113, s[42:43] sc1
    global_load_dwordx4 v[60:63], v113, s[42:43] offset:1024 sc1
    v_mov_b64 v[104:105], 0
    v_mov_b64 v[106:107], 0
    v_mov_b64 v[108:109], 0
    v_mov_b64 v[110:111], 0
    s_branch Lc_s_try
s_nop 0
s_nop 0
s_nop 0
s_nop 0
s_nop 0
s_nop 0
s_nop 0
s_nop 0
s_nop 0
s_nop 0
s_nop 0
s_nop 0
s_nop 0
s_nop 0
Lc_s_step:
    v_lshrrev_b32 v101, 2, v113
    v_add_u32 v102, m0, v101
    ds_read_b32 v102, v102 offset:2048
    s_and_b32 s25, s20, 1
    s_lshl_b32 s27, s25, 13
    s_add_u32 s42, s50, s27
    s_addc_u32 s43, s51, 0
    s_xor_b32 s26, s25, 1
    ds_read_b128 v[16:19], v120 offset:8192
    ds_read_b128 v[20:23], v120 offset:9216
    ds_read_b128 v[24:27], v120 offset:10240
    ds_read_b128 v[28:31], v120 offset:11264
    v_mov_b64 v[32:33], 0
    v_mov_b64 v[34:35], 0
    v_mov_b64 v[36:37], 0
    v_mov_b64 v[38:39], 0
    v_mov_b64 v[40:41], 0
    v_mov_b64 v[42:43], 0
    v_mov_b64 v[44:45], 0
    v_mov_b64 v[46:47], 0
    v_mov_b64 v[104:105], 0
    v_mov_b64 v[106:107], 0
    v_mov_b64 v[108:109], 0
    v_mov_b64 v[110:111], 0
    s_nop 14
    s_cmp_eq_u32 s19, 3
    s_cbranch_scc1 Lc_s_p1
    s_nop 1
    s_cmp_eq_u32 s19, 2
    s_cbranch_scc1 Lc_s_p1
    s_nop 1
    s_cmp_eq_u32 s19, 1
    s_cbranch_scc1 Lc_s_p1
    s_nop 7
Lc_s_p1:
    global_load_dwordx4 v[0:3], v113, s[42:43] sc1
    global_load_dwordx4 v[4:7], v113, s[42:43] offset:1024 sc1
    s_mov_b32 exec_hi, 0
    v_add_u32 v115, 262144, v115
    s_mov_b32 exec_hi, -1
    s_lshl_b32 s27, s26, 13
    s_add_u32 s44, s52, s27
    s_addc_u32 s45, s53, 0
    s_lshl_b32 s27, s26, 18
    s_add_u32 s40, s48, s27
    s_addc_u32 s41, s49, 0
    s_lshl_b32 s27, s25, 18
    s_add_u32 s34, s46, s27
    s_addc_u32 s35, s47, 0
    s_add_u32 s36, s34, 32768
    s_addc_u32 s37, s35, 0
    s_add_u32 s38, s48, s27
    s_addc_u32 s39, s49, 0
    s_add_u32 s30, s12, 16777216
    s_addc_u32 s31, s13, 0
    s_add_u32 s12, s12, 262144
    s_addc_u32 s13, s13, 0
    s_add_u32 s32, s32, 131072
    s_addc_u32 s33, s33, 0
    s_mul_i32 s27, s26, 9216
    s_add_u32 m0, s27, s68
    s_mul_i32 s27, s25, 9216
    s_add_u32 s27, s27, 139264
    v_add_u32 v114, s27, v113
    s_lshl_b32 s27, s19, 11
    s_add_u32 s27, s27, 131072
    v_add_u32 v99, s27, v113
    s_add_u32 s27, s20, 0
    v_mov_b32 v100, s27
    v_xor_b32 v96, 2048, v99
    v_xor_b32 v97, 4096, v99
    v_xor_b32 v98, 6144, v99
    s_waitcnt lgkmcnt(0)
    v_cmp_eq_u32 vcc, 0x01010101, v102
    s_add_u32 s25, s20, 1
    s_ff0_i32_b32 s86, vcc_hi
    s_lshl_b32 s86, s86, 1
    s_cmp_lt_u32 s25, s86
    s_cbranch_scc0 Lc_s_rp
Lc_s_rk:
    global_load_dwordx4 v[56:59], v113, s[42:43] sc1
    global_load_dwordx4 v[60:63], v113, s[42:43] offset:1024 sc1
    s_waitcnt vmcnt(3) lgkmcnt(0)
Lc_s_try:
    v_smfmac_f32_16x16x64_bf16 v[104:107], v[0:3], v[64:71], v112
    ds_write_b128 v99, v[0:3]
    v_smfmac_f32_16x16x64_bf16 v[108:111], v[0:3], v[72:79], v112
    s_waitcnt vmcnt(2)
    ds_write_b128 v99, v[4:7] offset:1024
    v_max3_u32 v8, v0, v2, v4
    v_max_u32 v8, v8, v6
    v_max3_u32 v8, v8, v1, v3
    v_max3_u32 v8, v8, v5, v7
    v_smfmac_f32_16x16x64_bf16 v[104:107], v[4:7], v[80:87], v112
    v_cmp_eq_u32 vcc, -1, v8
    v_smfmac_f32_16x16x64_bf16 v[108:111], v[4:7], v[88:95], v112
    s_cbranch_vccnz Lc_s_retry
    v_smfmac_f32_16x16x64_bf16 v[40:43], v[0:3], v[16:23], v112
    global_store_dwordx4 v113, v[124:127], s[32:33] sc1
    s_waitcnt lgkmcnt(0)
    s_barrier
    ds_read_b128 v[8:11], v96 offset:0
    ds_read_b128 v[12:15], v96 offset:1024
    v_smfmac_f32_16x16x64_bf16 v[44:47], v[0:3], v[24:31], v112
    ds_read_b128 v[16:19], v97 offset:0
    v_smfmac_f32_16x16x64_bf16 v[40:43], v[4:7], a[96:103], v112
    ds_read_b128 v[20:23], v97 offset:1024
    v_smfmac_f32_16x16x64_bf16 v[44:47], v[4:7], a[104:111], v112
    ds_read_b128 v[24:27], v98 offset:0
    global_load_dwordx4 v[56:59], v113, s[30:31] offset:0 sc1
    v_smfmac_f32_16x16x64_bf16 v[32:35], v[0:3], a[176:183], v112
    ds_read_b128 v[28:31], v98 offset:1024
    v_smfmac_f32_16x16x64_bf16 v[36:39], v[0:3], a[184:191], v112
    ds_read_b128 v[64:67], v120 offset:12288
    global_load_dwordx4 v[60:63], v113, s[30:31] offset:1024 sc1
    v_smfmac_f32_16x16x64_bf16 v[32:35], v[4:7], a[192:199], v112
    ds_read_b128 v[68:71], v120 offset:13312
    v_smfmac_f32_16x16x64_bf16 v[36:39], v[4:7], a[200:207], v112
    ds_read_b128 v[72:75], v120 offset:14336
    s_waitcnt lgkmcnt(8)
    v_smfmac_f32_16x16x64_bf16 v[104:107], v[8:11], a[0:7], v112
    s_waitcnt lgkmcnt(7)
    ds_read_b128 v[76:79], v120 offset:15360
    v_mov_b32 v4, -1
    v_smfmac_f32_16x16x64_bf16 v[104:107], v[12:15], a[16:23], v112
    s_waitcnt lgkmcnt(7)
    ds_read_b128 v[80:83], v120 offset:16384
    global_store_dword v119, v4, s[44:45] sc1
    v_mov_b32 v5, -1
    v_smfmac_f32_16x16x64_bf16 v[104:107], v[16:19], a[32:39], v112
    s_waitcnt lgkmcnt(7)
    ds_read_b128 v[84:87], v120 offset:17408
    v_mov_b32 v6, -1
    v_smfmac_f32_16x16x64_bf16 v[104:107], v[20:23], a[48:55], v112
    s_waitcnt lgkmcnt(7)
    ds_read_b128 v[88:91], v120 offset:18432
    global_load_lds_dwordx4 v113, s[12:13] offset:0 sc1
    v_mov_b32 v7, -1
    v_smfmac_f32_16x16x64_bf16 v[104:107], v[24:27], a[64:71], v112
    s_waitcnt lgkmcnt(7)
    ds_read_b128 v[92:95], v120 offset:19456
    v_mov_b64 v[0:1], 0
    v_smfmac_f32_16x16x64_bf16 v[104:107], v[28:31], a[80:87], v112
    s_mov_b64 exec, s[100:101]
    global_store_dword v113, v100, s[28:29] sc1
    s_mov_b64 exec, -1
    v_mov_b64 v[2:3], 0
    v_smfmac_f32_16x16x64_bf16 v[108:111], v[8:11], a[8:15], v112
    v_smfmac_f32_16x16x64_bf16 v[108:111], v[12:15], a[24:31], v112
    s_waitcnt lgkmcnt(6)
    v_add_f32 v104, v104, v106
    v_smfmac_f32_16x16x64_bf16 v[40:43], v[24:27], v[64:71], v112
    s_waitcnt lgkmcnt(4)
    global_load_lds_dwordx4 v113, s[12:13] offset:1024 sc1
    v_add_f32 v105, v105, v107
    v_smfmac_f32_16x16x64_bf16 v[44:47], v[24:27], v[72:79], v112
    s_waitcnt lgkmcnt(2)
    v_cvt_pk_bf16_f32 v102, v104, v105
    v_smfmac_f32_16x16x64_bf16 v[40:43], v[28:31], v[80:87], v112
    s_waitcnt lgkmcnt(0)
    ds_write_b32 v116, v102 offset:0
    v_smfmac_f32_16x16x64_bf16 v[44:47], v[28:31], v[88:95], v112
    global_load_lds_dword v115, s[16:17] offset:2048 sc1
    v_smfmac_f32_16x16x64_bf16 v[108:111], v[16:19], a[40:47], v112
    ds_read_b128 v[64:67], v114 offset:0
    v_smfmac_f32_16x16x64_bf16 v[108:111], v[20:23], a[56:63], v112
    ds_read_b128 v[68:71], v114 offset:1024
    v_smfmac_f32_16x16x64_bf16 v[108:111], v[24:27], a[72:79], v112
    ds_read_b128 v[72:75], v114 offset:2304
    v_smfmac_f32_16x16x64_bf16 v[108:111], v[28:31], a[88:95], v112
    ds_read_b128 v[76:79], v114 offset:3328
    global_store_dwordx4 v113, v[4:7], s[40:41] offset:0 sc1
    v_smfmac_f32_16x16x64_bf16 v[40:43], v[8:11], a[112:119], v112
    ds_read_b128 v[80:83], v114 offset:4608
    v_smfmac_f32_16x16x64_bf16 v[40:43], v[12:15], a[128:135], v112
    ds_read_b128 v[84:87], v114 offset:5632
    v_add_f32 v108, v108, v110
    v_smfmac_f32_16x16x64_bf16 v[40:43], v[16:19], a[144:151], v112
    ds_read_b128 v[88:91], v114 offset:6912
    v_add_f32 v109, v109, v111
    v_smfmac_f32_16x16x64_bf16 v[40:43], v[20:23], a[160:167], v112
    ds_read_b128 v[92:95], v114 offset:7936
    global_store_dwordx4 v113, v[4:7], s[40:41] offset:1024 sc1
    v_cvt_pk_bf16_f32 v103, v108, v109
    v_smfmac_f32_16x16x64_bf16 v[44:47], v[8:11], a[120:127], v112
    ds_write_b32 v116, v103 offset:512
    v_smfmac_f32_16x16x64_bf16 v[44:47], v[12:15], a[136:143], v112
    v_add_f32 v40, v40, v42
    v_smfmac_f32_16x16x64_bf16 v[44:47], v[16:19], a[152:159], v112
    v_add_f32 v41, v41, v43
    v_smfmac_f32_16x16x64_bf16 v[44:47], v[20:23], a[168:175], v112
    v_cvt_pk_bf16_f32 v124, v40, v41
    v_smfmac_f32_16x16x64_bf16 v[32:35], v[16:19], a[240:247], v112
    ds_write_b32 v116, v124 offset:4
    v_smfmac_f32_16x16x64_bf16 v[36:39], v[16:19], a[248:255], v112
    v_add_f32 v44, v44, v46
    v_add_f32 v45, v45, v47
    v_cvt_pk_bf16_f32 v125, v44, v45
    ds_write_b32 v116, v125 offset:516
    v_smfmac_f32_16x16x64_bf16 v[32:35], v[20:23], v[128:135], v112
    s_mov_b64 vcc, s[4:5]
    s_cmp_eq_u32 s20, 63
    v_mov_b64 v[108:109], s[8:9]
    v_smfmac_f32_16x16x64_bf16 v[36:39], v[20:23], v[136:143], v112
    v_mov_b64 v[110:111], s[10:11]
    v_smfmac_f32_16x16x64_bf16 v[32:35], v[24:27], v[144:151], v112
    v_mov_b32 v103, s69
    v_smfmac_f32_16x16x64_bf16 v[36:39], v[24:27], v[152:159], v112
    s_waitcnt lgkmcnt(0)
    s_barrier
    ds_read_b64_tr_b16 v[40:41], v117 offset:0
    ds_read_b64_tr_b16 v[42:43], v117 offset:512
    v_smfmac_f32_16x16x64_bf16 v[32:35], v[28:31], v[160:167], v112
    ds_read_b64_tr_b16 v[44:45], v117 offset:1024
    ds_read_b64_tr_b16 v[46:47], v117 offset:1536
    v_mov_b64 v[6:7], 0
    v_smfmac_f32_16x16x64_bf16 v[36:39], v[28:31], v[168:175], v112
    ds_read_b64_tr_b16 v[48:49], v117 offset:2048
    ds_read_b64_tr_b16 v[50:51], v117 offset:2560
    v_mov_b64 v[4:5], 0
    v_smfmac_f32_16x16x64_bf16 v[32:35], v[8:11], a[208:215], v112
    ds_read_b64_tr_b16 v[52:53], v117 offset:3072
    ds_read_b64_tr_b16 v[54:55], v117 offset:3584
    v_smfmac_f32_16x16x64_bf16 v[36:39], v[8:11], a[216:223], v112
    ds_read_b128 v[16:19], v120 offset:28672
    v_smfmac_f32_16x16x64_bf16 v[32:35], v[12:15], a[224:231], v112
    ds_read_b128 v[20:23], v120 offset:29696
    v_smfmac_f32_16x16x64_bf16 v[36:39], v[12:15], a[232:239], v112
    ds_read_b128 v[24:27], v120 offset:30720
    s_cbranch_scc1 Lc_s_last
    s_waitcnt lgkmcnt(7)
    v_mfma_f32_16x16x32_bf16 v[96:99], v[64:67], v[40:43], 0
    ds_read_b128 v[28:31], v120 offset:31744
    v_mfma_f32_16x16x32_bf16 v[104:107], v[68:71], v[40:43], 0
    v_add_f32 v32, v32, v34
    v_add_f32 v33, v33, v35
    v_mfma_f32_16x16x32_bf16 v[96:99], v[72:75], v[44:47], v[96:99]
    v_cvt_pk_bf16_f32 v126, v32, v33
    v_add_f32 v36, v36, v38
    v_mfma_f32_16x16x32_bf16 v[104:107], v[76:79], v[44:47], v[104:107]
    s_waitcnt lgkmcnt(4)
    v_add_f32 v37, v37, v39
    v_mfma_f32_16x16x32_bf16 v[96:99], v[80:83], v[48:51], v[96:99]
    ds_read_b128 v[64:67], v120 offset:20480
    v_cvt_pk_bf16_f32 v127, v36, v37
    v_mfma_f32_16x16x32_bf16 v[104:107], v[84:87], v[48:51], v[104:107]
    ds_read_b128 v[68:71], v120 offset:21504
    v_mfma_f32_16x16x32_bf16 v[96:99], v[88:91], v[52:55], v[96:99]
    ds_read_b128 v[72:75], v120 offset:22528
    ds_read_b128 v[80:83], v120 offset:24576
    v_mfma_f32_16x16x32_bf16 v[104:107], v[92:95], v[52:55], v[104:107]
    ds_read_b128 v[76:79], v120 offset:23552
    ds_read_b128 v[84:87], v120 offset:25600
    v_mfma_f32_16x16x32_bf16 v[32:35], v[40:43], v[40:43], 0
    ds_read_b128 v[88:91], v120 offset:26624
    ds_read_b128 v[92:95], v120 offset:27648
    v_mfma_f32_16x16x32_bf16 v[32:35], v[44:47], v[44:47], v[32:35]
    v_cndmask_b32_dpp v96, v104, v96, vcc quad_perm:[0,1,0,1] row_mask:0xf bank_mask:0xf
    v_cndmask_b32_dpp v97, v105, v97, vcc quad_perm:[0,1,0,1] row_mask:0xf bank_mask:0xf
    v_mfma_f32_16x16x32_bf16 v[32:35], v[48:51], v[48:51], v[32:35]
    v_cndmask_b32_dpp v98, v106, v98, vcc quad_perm:[0,1,0,1] row_mask:0xf bank_mask:0xf
    v_cndmask_b32_dpp v99, v107, v99, vcc quad_perm:[0,1,0,1] row_mask:0xf bank_mask:0xf
    v_mfma_f32_16x16x32_bf16 v[32:35], v[52:55], v[52:55], v[32:35]
    v_max3_f32 v100, v96, v97, v98
    v_max_f32 v100, v100, v99
    s_nop 1
    v_max_f32_dpp v100, v100, v100 quad_perm:[2,3,0,1] row_mask:0xf bank_mask:0xf
    v_mul_f32 v100, v100, v103
    s_nop 1
    v_mul_f32_dpp v32, v34, v103 quad_perm:[0,1,0,1] row_mask:0xf bank_mask:0xf
    v_mul_f32_dpp v33, v35, v103 quad_perm:[0,1,0,1] row_mask:0xf bank_mask:0xf
    v_max3_f32 v101, v100, v32, v33
    v_max3_f32 v100, v100, v32, v33
    v_mov_b64 v[14:15], 0
    v_mov_b64 v[12:13], 0
    v_permlane16_swap_b32 v100, v101
    v_max_f32 v102, v100, v101
    v_max_f32 v100, v100, v101
    v_mov_b64 v[10:11], 0
    v_mov_b64 v[8:9], 0
    v_permlane32_swap_b32 v100, v102
    v_max_f32 v100, v100, v102
    v_pk_add_f32 v[32:33], v[32:33], v[100:101] op_sel_hi:[1,0] neg_lo:[0,1] neg_hi:[0,1]
    v_pk_fma_f32 v[96:97], v[96:97], v[102:103], v[100:101] op_sel:[0,1,0] op_sel_hi:[1,1,0] neg_lo:[0,0,1] neg_hi:[0,0,1]
    v_pk_fma_f32 v[98:99], v[98:99], v[102:103], v[100:101] op_sel:[0,1,0] op_sel_hi:[1,1,0] neg_lo:[0,0,1] neg_hi:[0,0,1]
    v_exp_f32 v32, v32
    v_exp_f32 v33, v33
    v_exp_f32 v96, v96
    v_exp_f32 v97, v97
    v_cvt_pk_bf16_f32 v32, v32, v33
    v_exp_f32 v98, v98
    v_exp_f32 v99, v99
    v_cvt_pk_bf16_f32 v104, v96, v97
    v_and_b32 v106, v32, v122
    v_and_b32 v107, v32, v123
    v_cvt_pk_bf16_f32 v105, v98, v99
    v_and_b32 v40, v104, v122
    v_mfma_f32_16x16x16_bf16 v[48:51], v[126:127], v[106:107], 0
    v_and_b32_dpp v42, v104, v122 quad_perm:[2,3,0,1] row_mask:0xf bank_mask:0xf
    v_and_b32 v41, v105, v122
    v_mfma_f32_16x16x32_bf16 v[52:55], v[108:111], v[104:107], 0
    v_and_b32_dpp v43, v105, v122 quad_perm:[2,3,0,1] row_mask:0xf bank_mask:0xf
    v_and_b32_dpp v44, v104, v123 quad_perm:[2,3,0,1] row_mask:0xf bank_mask:0xf
    v_and_b32_dpp v45, v105, v123 quad_perm:[2,3,0,1] row_mask:0xf bank_mask:0xf
    s_waitcnt vmcnt(8)
    v_mfma_f32_16x16x32_bf16 v[48:51], v[56:59], v[40:43], v[48:51]
    v_and_b32 v46, v104, v123
    v_and_b32 v47, v105, v123
    v_and_b32 v100, -9, v121
    s_waitcnt vmcnt(7)
    v_mfma_f32_16x16x32_bf16 v[48:51], v[60:63], v[44:47], v[48:51]
    v_add_f32_dpp v52, v52, v52 quad_perm:[2,3,0,1] row_mask:0xf bank_mask:0xf
    v_rcp_f32 v52, v52
    v_xor_b32 v102, 1024, v100
    v_xor_b32 v103, 1536, v100
    v_xor_b32 v101, 512, v100
    s_nop 2
    v_pk_mul_f32 v[48:49], v[48:49], v[52:53] op_sel_hi:[1,0]
    v_pk_mul_f32 v[50:51], v[50:51], v[52:53] op_sel_hi:[1,0]
    v_cvt_pk_bf16_f32 v48, v48, v49
    v_cvt_pk_bf16_f32 v49, v50, v51
    ds_write_b64 v121, v[48:49]
    ds_read_b128 v[40:43], v100
    s_waitcnt lgkmcnt(1)
    s_barrier
    ds_read_b128 v[44:47], v101
    ds_read_b128 v[48:51], v102
    ds_read_b128 v[52:55], v103
    s_waitcnt lgkmcnt(3)
    v_smfmac_f32_16x16x64_bf16 v[0:3], v[40:43], v[176:183], v112
    v_smfmac_f32_16x16x64_bf16 v[4:7], v[40:43], v[184:191], v112
    v_smfmac_f32_16x16x64_bf16 v[8:11], v[40:43], v[192:199], v112
    s_waitcnt vmcnt(6)
    v_smfmac_f32_16x16x64_bf16 v[12:15], v[40:43], v[200:207], v112
    s_waitcnt lgkmcnt(2)
    v_smfmac_f32_16x16x64_bf16 v[0:3], v[44:47], v[208:215], v112
    s_waitcnt lgkmcnt(1)
    v_smfmac_f32_16x16x64_bf16 v[0:3], v[48:51], v[240:247], v112
    s_waitcnt lgkmcnt(0)
    v_smfmac_f32_16x16x64_bf16 v[0:3], v[52:55], v[80:87], v112
    v_smfmac_f32_16x16x64_bf16 v[4:7], v[44:47], v[216:223], v112
    v_mov_b32 v98, 0x3f80
    v_smfmac_f32_16x16x64_bf16 v[4:7], v[48:51], v[248:255], v112
    v_cvt_pk_bf16_f32 v32, v0, v1
    v_smfmac_f32_16x16x64_bf16 v[4:7], v[52:55], v[88:95], v112
    global_store_dword v118, v32, s[34:35] offset:-4096 sc1
    v_cvt_pk_bf16_f32 v33, v2, v3
    v_smfmac_f32_16x16x64_bf16 v[8:11], v[44:47], v[224:231], v112
    global_store_dword v118, v33, s[36:37] offset:-4096 sc1
    v_mov_b32 v99, 0x3f800000
    v_smfmac_f32_16x16x64_bf16 v[8:11], v[48:51], v[64:71], v112
    v_cvt_pk_bf16_f32 v34, v4, v5
    v_smfmac_f32_16x16x64_bf16 v[8:11], v[52:55], v[16:23], v112
    global_store_dword v118, v34, s[34:35] offset:-2048 sc1
    v_cvt_pk_bf16_f32 v35, v6, v7
    v_smfmac_f32_16x16x64_bf16 v[12:15], v[44:47], v[232:239], v112
    global_store_dword v118, v35, s[36:37] offset:-2048 sc1
    v_cndmask_b32 v98, v98, v99, s[64:65]
    v_smfmac_f32_16x16x64_bf16 v[12:15], v[48:51], v[72:79], v112
    v_cvt_pk_bf16_f32 v36, v8, v9
    v_smfmac_f32_16x16x64_bf16 v[12:15], v[52:55], v[24:31], v112
    global_store_dword v118, v36, s[34:35] offset:0 sc1
    v_cvt_pk_bf16_f32 v37, v10, v11
    v_cndmask_b32 v100, 0, v98, s[56:57]
    global_store_dword v118, v37, s[36:37] offset:0 sc1
    v_cndmask_b32 v101, 0, v98, s[58:59]
    v_cndmask_b32 v102, 0, v98, s[60:61]
    v_cndmask_b32 v103, 0, v98, s[62:63]
    s_nop 0
    v_cvt_pk_bf16_f32 v38, v12, v13
    v_cvt_pk_bf16_f32 v39, v14, v15
    global_store_dword v118, v38, s[34:35] offset:2048 sc1
    global_store_dword v118, v39, s[36:37] offset:2048 sc1
    ds_read_b128 v[64:67], v120 offset:0
    ds_read_b128 v[68:71], v120 offset:1024
    ds_read_b128 v[72:75], v120 offset:2048
    ds_read_b128 v[76:79], v120 offset:3072
    ds_read_b128 v[80:83], v120 offset:4096
    ds_read_b128 v[84:87], v120 offset:5120
    ds_read_b128 v[88:91], v120 offset:6144
    ds_read_b128 v[92:95], v120 offset:7168
    s_nop 15
    s_nop 7
    s_cmp_eq_u32 s19, 0
    s_cbranch_scc1 Lc_s_p0
    s_nop 5
    s_cmp_eq_u32 s19, 1
    s_cbranch_scc1 Lc_s_p0
    s_nop 3
    s_cmp_eq_u32 s19, 2
    s_cbranch_scc1 Lc_s_p0
    s_nop 5
Lc_s_p0:
    global_load_dwordx4 v[8:11], v113, s[38:39] sc1
    global_load_dwordx4 v[12:15], v113, s[38:39] offset:1024 sc1
    s_nop 15
    s_nop 15
    s_nop 5
Lc_s_pa:
    global_load_dwordx4 v[56:59], v113, s[38:39] sc1
    global_load_dwordx4 v[60:63], v113, s[38:39] offset:1024 sc1
    s_waitcnt vmcnt(3)
    v_mfma_f32_16x16x32_bf16 v[104:107], v[100:103], v[8:11], 0
    v_max3_u32 v96, v8, v9, v10
    s_waitcnt vmcnt(2)
    v_mfma_f32_16x16x32_bf16 v[104:107], v[100:103], v[12:15], v[104:107]
    v_max3_u32 v96, v96, v11, v12
    v_max3_u32 v96, v96, v13, v14
    v_max_u32 v96, v96, v15
    v_cmp_eq_u32 vcc, -1, v96
    s_cbranch_vccnz Lc_s_pb
Lc_s_qa:
    s_nop 2
    v_add_f32_dpp v104, v104, v104 row_ror:8 row_mask:0xf bank_mask:0xf
    v_add_f32_dpp v105, v105, v105 row_ror:8 row_mask:0xf bank_mask:0xf
    s_nop 0
    v_add_f32_dpp v104, v104, v104 row_ror:4 row_mask:0xf bank_mask:0xf
    v_add_f32_dpp v105, v105, v105 row_ror:4 row_mask:0xf bank_mask:0xf
    v_cvt_pk_bf16_f32 v104, v104, v105
    global_store_dword v119, v104, s[44:45] sc1
    s_mov_b64 exec, -1
    s_add_u32 s20, s20, 1
    s_branch Lc_s_step
Lc_s_pb:
    global_load_dwordx4 v[8:11], v113, s[38:39] sc1
    global_load_dwordx4 v[12:15], v113, s[38:39] offset:1024 sc1
    s_add_u32 s21, s21, 1
    s_cmp_gt_u32 s21, 200000
    s_cbranch_scc1 Lc_end
    s_waitcnt vmcnt(3)
    v_mfma_f32_16x16x32_bf16 v[104:107], v[100:103], v[56:59], 0
    v_max3_u32 v96, v56, v57, v58
    s_waitcnt vmcnt(2)
    v_mfma_f32_16x16x32_bf16 v[104:107], v[100:103], v[60:63], v[104:107]
    v_max3_u32 v96, v96, v59, v60
    v_max3_u32 v96, v96, v61, v62
    v_max_u32 v96, v96, v63
    v_cmp_eq_u32 vcc, -1, v96
    s_cbranch_vccnz Lc_s_pa
Lc_s_qb:
    s_nop 2
    v_add_f32_dpp v104, v104, v104 row_ror:8 row_mask:0xf bank_mask:0xf
    v_add_f32_dpp v105, v105, v105 row_ror:8 row_mask:0xf bank_mask:0xf
    s_nop 0
    v_add_f32_dpp v104, v104, v104 row_ror:4 row_mask:0xf bank_mask:0xf
    v_add_f32_dpp v105, v105, v105 row_ror:4 row_mask:0xf bank_mask:0xf
    v_cvt_pk_bf16_f32 v104, v104, v105
    global_store_dword v119, v104, s[44:45] sc1
    s_mov_b64 exec, -1
    s_add_u32 s20, s20, 1
    s_branch Lc_s_step
Lc_s_rp:
    global_load_dword v102, v101, s[84:85] sc1
    s_add_u32 s21, s21, 1
    s_cmp_gt_u32 s21, 200000
    s_cbranch_scc1 Lc_end
    s_waitcnt vmcnt(0)
    v_cmp_eq_u32 vcc, 0x01010101, v102
    s_or_b32 s22, vcc_lo, 0xaaaaaaaa
    s_or_b32 s23, vcc_hi, 0xaaaaaaaa
    s_ff0_i32_b64 s86, s[22:23]
    s_min_u32 s86, s86, 100
    s_cmp_lt_u32 s25, s86
    s_cbranch_scc1 Lc_s_rk
    s_sleep 2
    s_branch Lc_s_rp
Lc_s_last:
    s_nop 7
    v_add_f32 v32, v32, v34
    v_add_f32 v33, v33, v35
    v_cvt_pk_bf16_f32 v126, v32, v33
    v_add_f32 v36, v36, v38
    v_add_f32 v37, v37, v39
    v_cvt_pk_bf16_f32 v127, v36, v37
    s_branch Lc_end
Lc_end:
    s_mov_b64 exec, -1
    s_nop 7
    s_add_u32 s32, s32, 131072
    s_addc_u32 s33, s33, 0
    global_store_dwordx4 v113, v[124:127], s[32:33] sc1
    v_mov_b32 v96, 0x41
    s_waitcnt vmcnt(0)
    s_barrier
    s_mov_b64 exec, s[100:101]
    global_store_dword v113, v96, s[28:29] sc1
    s_mov_b64 exec, -1
    s_waitcnt vmcnt(0) lgkmcnt(0)
    s_endpgm
L_work:
    s_add_u32 s62, s16, 66060288
    s_addc_u32 s63, s17, 0
    v_mov_b32 v14, 1
    s_cmp_lg_u32 s20, 7
    s_cbranch_scc1 Lt1_nz
    s_cmp_gt_u32 s18, 16
    s_cbranch_scc1 Lt1_nz
    s_cmp_eq_u32 s18, 16
    s_cselect_b32 s22, 0, -1
    v_mov_b32 v112, s22
    v_mov_b32 v113, s22
    v_mov_b32 v114, s22
    v_mov_b32 v115, s22
    s_lshl_b32 s22, s18, 15
    s_add_u32 s22, s22, 62914560
    s_cmp_eq_u32 s18, 16
    s_cselect_b32 s22, 66060288, s22
    v_lshl_add_u32 v1, v0, 4, s22
    global_store_dwordx4 v1, v[112:115], s[16:17] sc1
    v_add_u32 v1, 4096, v1
    global_store_dwordx4 v1, v[112:115], s[16:17] sc1
    v_add_u32 v1, 4096, v1
    global_store_dwordx4 v1, v[112:115], s[16:17] sc1
    v_add_u32 v1, 4096, v1
    global_store_dwordx4 v1, v[112:115], s[16:17] sc1
    v_add_u32 v1, 4096, v1
    global_store_dwordx4 v1, v[112:115], s[16:17] sc1
    v_add_u32 v1, 4096, v1
    global_store_dwordx4 v1, v[112:115], s[16:17] sc1
    v_add_u32 v1, 4096, v1
    global_store_dwordx4 v1, v[112:115], s[16:17] sc1
    v_add_u32 v1, 4096, v1
    global_store_dwordx4 v1, v[112:115], s[16:17] sc1
    s_lshl_b32 s22, s18, 10
    s_add_u32 s22, s22, 63963136
    v_lshl_add_u32 v1, v0, 2, s22
    global_store_dword v1, v112, s[16:17] sc1
    s_lshl_b32 s22, s18, 2
    s_add_u32 s22, s22, 32
    s_cmp_eq_u32 s18, 16
    s_cselect_b32 s22, 160, s22
    s_add_u32 s22, s22, s19
    v_mov_b32 v1, s22
    s_waitcnt vmcnt(0)
    s_mov_b64 exec, 1
    global_store_byte v1, v14, s[14:15] sc1
    s_mov_b64 exec, -1
Lt1_nz:
    v_and_b32 v3, 63, v0
    v_and_b32 v4, 15, v0
    v_lshrrev_b32 v5, 4, v3
    v_lshlrev_b32 v6, 4, v3
    s_sub_u32 s23, s20, 5
    s_sub_u32 s22, s18, 16
    s_and_b32 s56, s22, 1
    s_add_u32 s56, s56, 2
    s_lshr_b32 s22, s22, 1
    s_cmp_lt_u32 s18, 16
    s_cselect_b32 s56, 1, s56
    s_cselect_b32 s22, s18, s22
    s_cselect_b32 s47, 16, 8
    s_mul_i32 s44, s23, s47
    s_add_u32 s44, s44, s22
    s_mul_i32 s47, s47, 3
    s_lshl_b32 s22, s20, 5
    s_add_u32 s22, s22, s18
    s_sub_u32 s22, s22, 32
    s_cmp_lt_u32 s20, 5
    s_cselect_b32 s56, 0, s56
    s_cselect_b32 s44, s22, s44
    s_cselect_b32 s47, 128, s47
    s_lshl_b32 s22, s56, 2
    s_add_u32 s22, s22, s19
    s_and_b32 s22, s22, 7
    s_lshl_b32 s22, s22, 6
    v_add_u32 v128, s22, v3
    v_lshrrev_b32 v10, 2, v3
    s_lshl_b32 s22, s19, 7
    v_add_u32 v10, s22, v10
    v_lshrrev_b32 v11, 4, v3
    v_and_b32 v11, 2, v11
    v_xor_b32 v11, v11, v3
    v_and_b32 v11, 3, v11
    v_lshlrev_b32 v11, 4, v11
    s_mov_b32 s45, 0
Lt1_job:
    s_cmp_ge_u32 s44, 192
    s_cbranch_scc1 Lt1_p_gu
    s_lshr_b32 s22, s44, 6
    s_cmp_eq_u32 s22, 0
    s_cselect_b64 s[48:49], s[8:9], s[10:11]
    s_cmp_eq_u32 s22, 2
    s_cselect_b64 s[48:49], s[6:7], s[48:49]
    s_and_b32 s22, s44, 63
    s_lshl_b32 s22, s22, 7
    s_add_u32 s48, s48, s22
    s_addc_u32 s49, s49, 0
    s_add_u32 s50, s48, 64
    s_addc_u32 s51, s49, 0
    s_mov_b32 s46, 8192
    s_branch Lt1_p_e
Lt1_p_gu:
    s_min_u32 s22, s44, 234
    s_sub_u32 s22, s22, 192
    s_lshl_b32 s22, s22, 6
    s_add_u32 s48, s32, s22
    s_addc_u32 s49, s33, 0
    s_add_u32 s50, s34, s22
    s_addc_u32 s51, s35, 0
    s_mov_b32 s46, 2752
Lt1_p_e:
    v_mad_u32_u24 v12, v10, s46, v11
    s_lshl_b32 s46, s46, 4
    s_lshl_b32 s57, s19, 13
    s_add_u32 m0, s57, 0
    s_nop 0
    global_load_lds_dwordx4 v12, s[48:49]
    s_add_u32 m0, s57, 32768
    s_nop 0
    global_load_lds_dwordx4 v12, s[50:51]
    v_add_u32 v12, s46, v12
    s_add_u32 m0, s57, 1024
    s_nop 0
    global_load_lds_dwordx4 v12, s[48:49]
    s_add_u32 m0, s57, 33792
    s_nop 0
    global_load_lds_dwordx4 v12, s[50:51]
    v_add_u32 v12, s46, v12
    s_add_u32 m0, s57, 2048
    s_nop 0
    global_load_lds_dwordx4 v12, s[48:49]
    s_add_u32 m0, s57, 34816
    s_nop 0
    global_load_lds_dwordx4 v12, s[50:51]
    v_add_u32 v12, s46, v12
    s_add_u32 m0, s57, 3072
    s_nop 0
    global_load_lds_dwordx4 v12, s[48:49]
    s_add_u32 m0, s57, 35840
    s_nop 0
    global_load_lds_dwordx4 v12, s[50:51]
    v_add_u32 v12, s46, v12
    s_add_u32 m0, s57, 4096
    s_nop 0
    global_load_lds_dwordx4 v12, s[48:49]
    s_add_u32 m0, s57, 36864
    s_nop 0
    global_load_lds_dwordx4 v12, s[50:51]
    v_add_u32 v12, s46, v12
    s_add_u32 m0, s57, 5120
    s_nop 0
    global_load_lds_dwordx4 v12, s[48:49]
    s_add_u32 m0, s57, 37888
    s_nop 0
    global_load_lds_dwordx4 v12, s[50:51]
    v_add_u32 v12, s46, v12
    s_add_u32 m0, s57, 6144
    s_nop 0
    global_load_lds_dwordx4 v12, s[48:49]
    s_add_u32 m0, s57, 38912
    s_nop 0
    global_load_lds_dwordx4 v12, s[50:51]
    v_add_u32 v12, s46, v12
    s_add_u32 m0, s57, 7168
    s_nop 0
    global_load_lds_dwordx4 v12, s[48:49]
    s_add_u32 m0, s57, 39936
    s_nop 0
    global_load_lds_dwordx4 v12, s[50:51]
    s_lshl_b32 s22, s56, 18
    s_lshl_b32 s23, s19, 16
    s_add_u32 s22, s22, s23
    s_add_u32 s58, s30, s22
    s_addc_u32 s59, s31, 0
    s_mul_i32 s25, s19, 23920
    s_add_u32 s25, s25, 65536
    v_mov_b32 v13, v6
    v_mul_u32_u24 v131, 1040, v4
    v_lshl_add_u32 v131, v5, 4, v131
    v_add_u32 v131, s25, v131
    s_add_u32 m0, s25, 0
    s_nop 0
    global_load_lds_dwordx4 v13, s[58:59] offset:0
    s_add_u32 m0, s25, 16
    s_nop 0
    global_load_lds_dwordx4 v13, s[58:59] offset:1024
    s_add_u32 m0, s25, 32
    s_nop 0
    global_load_lds_dwordx4 v13, s[58:59] offset:2048
    s_add_u32 m0, s25, 48
    s_nop 0
    global_load_lds_dwordx4 v13, s[58:59] offset:3072
    v_add_u32 v13, 4096, v13
    s_add_u32 m0, s25, 4160
    s_nop 0
    global_load_lds_dwordx4 v13, s[58:59] offset:0
    s_add_u32 m0, s25, 4176
    s_nop 0
    global_load_lds_dwordx4 v13, s[58:59] offset:1024
    s_add_u32 m0, s25, 4192
    s_nop 0
    global_load_lds_dwordx4 v13, s[58:59] offset:2048
    s_add_u32 m0, s25, 4208
    s_nop 0
    global_load_lds_dwordx4 v13, s[58:59] offset:3072
    v_add_u32 v13, 4096, v13
    s_add_u32 m0, s25, 8320
    s_nop 0
    global_load_lds_dwordx4 v13, s[58:59] offset:0
    s_add_u32 m0, s25, 8336
    s_nop 0
    global_load_lds_dwordx4 v13, s[58:59] offset:1024
    s_add_u32 m0, s25, 8352
    s_nop 0
    global_load_lds_dwordx4 v13, s[58:59] offset:2048
    s_add_u32 m0, s25, 8368
    s_nop 0
    global_load_lds_dwordx4 v13, s[58:59] offset:3072
    v_add_u32 v13, 4096, v13
    s_add_u32 m0, s25, 12480
    s_nop 0
    global_load_lds_dwordx4 v13, s[58:59] offset:0
    s_add_u32 m0, s25, 12496
    s_nop 0
    global_load_lds_dwordx4 v13, s[58:59] offset:1024
    s_add_u32 m0, s25, 12512
    s_nop 0
    global_load_lds_dwordx4 v13, s[58:59] offset:2048
    s_add_u32 m0, s25, 12528
    s_nop 0
    global_load_lds_dwordx4 v13, s[58:59] offset:3072
    v_add_u32 v13, 4096, v13
    s_add_u32 m0, s25, 16640
    s_nop 0
    global_load_lds_dwordx4 v13, s[58:59] offset:0
    s_add_u32 m0, s25, 16656
    s_nop 0
    global_load_lds_dwordx4 v13, s[58:59] offset:1024
    s_add_u32 m0, s25, 16672
    s_nop 0
    global_load_lds_dwordx4 v13, s[58:59] offset:2048
    s_add_u32 m0, s25, 16688
    s_nop 0
    global_load_lds_dwordx4 v13, s[58:59] offset:3072
    v_add_u32 v13, 4096, v13
    s_add_u32 m0, s25, 20800
    s_nop 0
    global_load_lds_dwordx4 v13, s[58:59] offset:0
    s_add_u32 m0, s25, 20816
    s_nop 0
    global_load_lds_dwordx4 v13, s[58:59] offset:1024
    s_add_u32 m0, s25, 20832
    s_nop 0
    global_load_lds_dwordx4 v13, s[58:59] offset:2048
    s_sub_u32 s22, s20, 5
    s_lshl_b32 s22, s22, 7
    s_lshl_b32 s23, s18, 2
    s_add_u32 s22, s22, s23
    s_add_u32 s22, s22, s19
    v_and_b32 v1, 63, v0
    v_lshlrev_b32 v1, 7, v1
    v_mov_b32 v2, 0
    s_cmp_lt_u32 s20, 5
    s_cselect_b64 exec, 0, -1
    v_and_b32 v2, 3, v0
    v_lshlrev_b32 v2, 6, v2
    v_bfe_u32 v3, v0, 2, 4
    v_lshl_add_u32 v2, v3, 10, v2
    v_add_u32 v2, 256, v2
    s_min_u32 s23, s22, 255
    s_lshl_b32 s23, s23, 14
    s_add_u32 s52, s6, s23
    s_addc_u32 s53, s7, 0
    global_load_dword v7, v2, s[52:53]
    v_and_b32 v3, 63, v0
    s_add_u32 s23, s22, 0
    s_min_u32 s23, s23, 511
    s_lshl_b32 s23, s23, 13
    s_add_u32 s52, s12, s23
    s_addc_u32 s53, s13, 0
    global_load_dword v7, v1, s[52:53]
    s_add_u32 s23, s22, 384
    s_min_u32 s23, s23, 511
    s_lshl_b32 s23, s23, 13
    s_add_u32 s52, s12, s23
    s_addc_u32 s53, s13, 0
    global_load_dword v7, v1, s[52:53]
    s_mov_b64 exec, -1
    v_add_u32 v1, 0, v131
    s_waitcnt vmcnt(10)
    ds_read_b128 a[0:3], v1 offset:0
    ds_read_b128 a[4:7], v1 offset:64
    ds_read_b128 a[8:11], v1 offset:128
    ds_read_b128 a[12:15], v1 offset:192
    ds_read_b128 a[16:19], v1 offset:256
    ds_read_b128 a[20:23], v1 offset:320
    ds_read_b128 a[24:27], v1 offset:384
    ds_read_b128 a[28:31], v1 offset:448
    ds_read_b128 a[32:35], v1 offset:512
    ds_read_b128 a[36:39], v1 offset:576
    ds_read_b128 a[40:43], v1 offset:640
    ds_read_b128 a[44:47], v1 offset:704
    ds_read_b128 a[48:51], v1 offset:768
    ds_read_b128 a[52:55], v1 offset:832
    ds_read_b128 a[56:59], v1 offset:896
    ds_read_b128 a[60:63], v1 offset:960
    s_waitcnt lgkmcnt(0)
    s_add_u32 m0, s25, -3072
    s_nop 0
    global_load_lds_dwordx4 v13, s[58:59] offset:3072
    v_add_u32 v13, 4096, v13
    s_add_u32 m0, s25, 1040
    s_nop 0
    global_load_lds_dwordx4 v13, s[58:59] offset:0
    s_add_u32 m0, s25, 1056
    s_nop 0
    global_load_lds_dwordx4 v13, s[58:59] offset:1024
    s_add_u32 m0, s25, 1072
    s_nop 0
    global_load_lds_dwordx4 v13, s[58:59] offset:2048
    s_add_u32 m0, s25, 1088
    s_nop 0
    global_load_lds_dwordx4 v13, s[58:59] offset:3072
    v_add_u32 v13, 4096, v13
    s_add_u32 m0, s25, 5200
    s_nop 0
    global_load_lds_dwordx4 v13, s[58:59] offset:0
    s_add_u32 m0, s25, 5216
    s_nop 0
    global_load_lds_dwordx4 v13, s[58:59] offset:1024
    s_add_u32 m0, s25, 5232
    s_nop 0
    global_load_lds_dwordx4 v13, s[58:59] offset:2048
    s_add_u32 m0, s25, 5248
    s_nop 0
    global_load_lds_dwordx4 v13, s[58:59] offset:3072
    v_add_u32 v13, 4096, v13
    s_add_u32 m0, s25, 9360
    s_nop 0
    global_load_lds_dwordx4 v13, s[58:59] offset:0
    s_add_u32 m0, s25, 9376
    s_nop 0
    global_load_lds_dwordx4 v13, s[58:59] offset:1024
    s_add_u32 m0, s25, 9392
    s_nop 0
    global_load_lds_dwordx4 v13, s[58:59] offset:2048
    s_add_u32 m0, s25, 9408
    s_nop 0
    global_load_lds_dwordx4 v13, s[58:59] offset:3072
    v_add_u32 v13, 4096, v13
    s_add_u32 m0, s25, 13520
    s_nop 0
    global_load_lds_dwordx4 v13, s[58:59] offset:0
    s_add_u32 m0, s25, 13536
    s_nop 0
    global_load_lds_dwordx4 v13, s[58:59] offset:1024
    s_add_u32 m0, s25, 13552
    s_nop 0
    global_load_lds_dwordx4 v13, s[58:59] offset:2048
    v_add_u32 v1, 16640, v131
    v_cmp_le_u32 vcc, 7, v4
    v_subrev_u32 v2, 23920, v1
    s_nop 0
    v_cndmask_b32 v1, v1, v2, vcc
    s_waitcnt vmcnt(7)
    ds_read_b128 a[64:67], v1 offset:0
    ds_read_b128 a[68:71], v1 offset:64
    ds_read_b128 a[72:75], v1 offset:128
    ds_read_b128 a[76:79], v1 offset:192
    ds_read_b128 a[80:83], v1 offset:256
    ds_read_b128 a[84:87], v1 offset:320
    ds_read_b128 a[88:91], v1 offset:384
    ds_read_b128 a[92:95], v1 offset:448
    ds_read_b128 a[96:99], v1 offset:512
    ds_read_b128 a[100:103], v1 offset:576
    ds_read_b128 a[104:107], v1 offset:640
    ds_read_b128 a[108:111], v1 offset:704
    ds_read_b128 a[112:115], v1 offset:768
    ds_read_b128 a[116:119], v1 offset:832
    ds_read_b128 a[120:123], v1 offset:896
    ds_read_b128 a[124:127], v1 offset:960
    s_waitcnt lgkmcnt(0)
    s_add_u32 m0, s25, 13568
    s_nop 0
    global_load_lds_dwordx4 v13, s[58:59] offset:3072
    v_add_u32 v13, 4096, v13
    s_add_u32 m0, s25, 17680
    s_nop 0
    global_load_lds_dwordx4 v13, s[58:59] offset:0
    s_add_u32 m0, s25, 17696
    s_nop 0
    global_load_lds_dwordx4 v13, s[58:59] offset:1024
    s_add_u32 m0, s25, 17712
    s_nop 0
    global_load_lds_dwordx4 v13, s[58:59] offset:2048
    s_add_u32 m0, s25, 17728
    s_nop 0
    global_load_lds_dwordx4 v13, s[58:59] offset:3072
    v_add_u32 v13, 4096, v13
    s_add_u32 m0, s25, 21840
    s_nop 0
    global_load_lds_dwordx4 v13, s[58:59] offset:0
    s_add_u32 m0, s25, 21856
    s_nop 0
    global_load_lds_dwordx4 v13, s[58:59] offset:1024
    s_add_u32 m0, s25, -2048
    s_nop 0
    global_load_lds_dwordx4 v13, s[58:59] offset:2048
    s_add_u32 m0, s25, -2032
    s_nop 0
    global_load_lds_dwordx4 v13, s[58:59] offset:3072
    v_add_u32 v13, 4096, v13
    s_add_u32 m0, s25, 2080
    s_nop 0
    global_load_lds_dwordx4 v13, s[58:59] offset:0
    s_add_u32 m0, s25, 2096
    s_nop 0
    global_load_lds_dwordx4 v13, s[58:59] offset:1024
    s_add_u32 m0, s25, 2112
    s_nop 0
    global_load_lds_dwordx4 v13, s[58:59] offset:2048
    s_add_u32 m0, s25, 2128
    s_nop 0
    global_load_lds_dwordx4 v13, s[58:59] offset:3072
    v_add_u32 v13, 4096, v13
    s_add_u32 m0, s25, 6240
    s_nop 0
    global_load_lds_dwordx4 v13, s[58:59] offset:0
    s_add_u32 m0, s25, 6256
    s_nop 0
    global_load_lds_dwordx4 v13, s[58:59] offset:1024
    s_add_u32 m0, s25, 6272
    s_nop 0
    global_load_lds_dwordx4 v13, s[58:59] offset:2048
    v_add_u32 v1, 9360, v131
    v_cmp_le_u32 vcc, 14, v4
    v_subrev_u32 v2, 23920, v1
    s_nop 0
    v_cndmask_b32 v1, v1, v2, vcc
    s_waitcnt vmcnt(7)
    ds_read_b128 a[128:131], v1 offset:0
    ds_read_b128 a[132:135], v1 offset:64
    ds_read_b128 a[136:139], v1 offset:128
    ds_read_b128 a[140:143], v1 offset:192
    ds_read_b128 a[144:147], v1 offset:256
    ds_read_b128 a[148:151], v1 offset:320
    ds_read_b128 a[152:155], v1 offset:384
    ds_read_b128 a[156:159], v1 offset:448
    ds_read_b128 a[160:163], v1 offset:512
    ds_read_b128 a[164:167], v1 offset:576
    ds_read_b128 a[168:171], v1 offset:640
    ds_read_b128 a[172:175], v1 offset:704
    ds_read_b128 a[176:179], v1 offset:768
    ds_read_b128 a[180:183], v1 offset:832
    ds_read_b128 a[184:187], v1 offset:896
    ds_read_b128 a[188:191], v1 offset:960
    s_waitcnt lgkmcnt(0)
    s_add_u32 m0, s25, 6288
    s_nop 0
    global_load_lds_dwordx4 v13, s[58:59] offset:3072
    v_add_u32 v13, 4096, v13
    s_add_u32 m0, s25, 10400
    s_nop 0
    global_load_lds_dwordx4 v13, s[58:59] offset:0
    s_add_u32 m0, s25, 10416
    s_nop 0
    global_load_lds_dwordx4 v13, s[58:59] offset:1024
    s_add_u32 m0, s25, 10432
    s_nop 0
    global_load_lds_dwordx4 v13, s[58:59] offset:2048
    s_add_u32 m0, s25, 10448
    s_nop 0
    global_load_lds_dwordx4 v13, s[58:59] offset:3072
    v_add_u32 v13, 4096, v13
    s_add_u32 m0, s25, 14560
    s_nop 0
    global_load_lds_dwordx4 v13, s[58:59] offset:0
    s_add_u32 m0, s25, 14576
    s_nop 0
    global_load_lds_dwordx4 v13, s[58:59] offset:1024
    s_add_u32 m0, s25, 14592
    s_nop 0
    global_load_lds_dwordx4 v13, s[58:59] offset:2048
    s_add_u32 m0, s25, 14608
    s_nop 0
    global_load_lds_dwordx4 v13, s[58:59] offset:3072
    v_add_u32 v13, 4096, v13
    v_add_u32 v1, 2080, v131
    s_waitcnt vmcnt(0)
    ds_read_b128 a[192:195], v1 offset:0
    ds_read_b128 a[196:199], v1 offset:64
    ds_read_b128 a[200:203], v1 offset:128
    ds_read_b128 a[204:207], v1 offset:192
    ds_read_b128 a[208:211], v1 offset:256
    ds_read_b128 a[212:215], v1 offset:320
    ds_read_b128 a[216:219], v1 offset:384
    ds_read_b128 a[220:223], v1 offset:448
    ds_read_b128 a[224:227], v1 offset:512
    ds_read_b128 a[228:231], v1 offset:576
    ds_read_b128 a[232:235], v1 offset:640
    ds_read_b128 a[236:239], v1 offset:704
    ds_read_b128 a[240:243], v1 offset:768
    ds_read_b128 a[244:247], v1 offset:832
    ds_read_b128 a[248:251], v1 offset:896
    ds_read_b128 a[252:255], v1 offset:960
    v_lshlrev_b32 v8, 9, v5
    v_and_b32 v1, 12, v3
    v_lshl_add_u32 v8, v1, 4, v8
    v_and_b32 v1, 3, v3
    v_lshl_add_u32 v8, v1, 3, v8
    v_and_b32 v1, 1, v5
    v_lshl_add_u32 v8, v1, 5, v8
    v_xor_b32 v9, 32, v8
    v_mov_b32 v15, 17920
    s_mov_b64 s[60:61], 0
    v_mov_b32 v129, 160
    v_mov_b32 v130, 0x01010101
    s_cmp_lg_u32 s19, 0
    s_cbranch_scc1 Lt1_n0
    global_load_dword v130, v129, s[14:15] sc1
Lt1_n0:
    s_waitcnt lgkmcnt(0)
    s_barrier
Lt1_tile:
    s_add_u32 s25, s44, s47
    s_cmp_ge_u32 s25, 192
    s_cbranch_scc1 Lt1_n_gu
    s_lshr_b32 s22, s25, 6
    s_cmp_eq_u32 s22, 0
    s_cselect_b64 s[48:49], s[8:9], s[10:11]
    s_cmp_eq_u32 s22, 2
    s_cselect_b64 s[48:49], s[6:7], s[48:49]
    s_and_b32 s22, s25, 63
    s_lshl_b32 s22, s22, 7
    s_add_u32 s48, s48, s22
    s_addc_u32 s49, s49, 0
    s_add_u32 s50, s48, 64
    s_addc_u32 s51, s49, 0
    s_mov_b32 s46, 8192
    s_branch Lt1_n_e
Lt1_n_gu:
    s_min_u32 s22, s25, 234
    s_sub_u32 s22, s22, 192
    s_lshl_b32 s22, s22, 6
    s_add_u32 s48, s32, s22
    s_addc_u32 s49, s33, 0
    s_add_u32 s50, s34, s22
    s_addc_u32 s51, s35, 0
    s_mov_b32 s46, 2752
Lt1_n_e:
    v_mad_u32_u24 v12, v10, s46, v11
    s_lshl_b32 s46, s46, 4
    s_xor_b32 s57, s57, 65536
    s_lshr_b32 s22, s44, 6
    s_cmp_eq_u32 s22, 1
    s_cbranch_scc1 Lt1_mv
    ds_read_b64_tr_b16 v[80:81], v8 offset:0
    ds_read_b64_tr_b16 v[82:83], v8 offset:256
    ds_read_b64_tr_b16 v[84:85], v9 offset:0
    ds_read_b64_tr_b16 v[86:87], v9 offset:256
    ds_read_b64_tr_b16 v[88:89], v8 offset:32768
    ds_read_b64_tr_b16 v[90:91], v8 offset:33024
    ds_read_b64_tr_b16 v[92:93], v9 offset:32768
    ds_read_b64_tr_b16 v[94:95], v9 offset:33024
    s_waitcnt lgkmcnt(0)
    v_mfma_f32_16x16x32_bf16 v[16:19], v[80:83], a[0:3], 0
    ds_read_b64_tr_b16 v[96:97], v8 offset:2048
    v_mfma_f32_16x16x32_bf16 v[32:35], v[80:83], a[64:67], 0
    ds_read_b64_tr_b16 v[98:99], v8 offset:2304
    v_mfma_f32_16x16x32_bf16 v[48:51], v[80:83], a[128:131], 0
    ds_read_b64_tr_b16 v[100:101], v9 offset:2048
    v_mfma_f32_16x16x32_bf16 v[64:67], v[80:83], a[192:195], 0
    ds_read_b64_tr_b16 v[102:103], v9 offset:2304
    v_mfma_f32_16x16x32_bf16 v[20:23], v[84:87], a[0:3], 0
    ds_read_b64_tr_b16 v[104:105], v8 offset:34816
    v_mfma_f32_16x16x32_bf16 v[36:39], v[84:87], a[64:67], 0
    ds_read_b64_tr_b16 v[106:107], v8 offset:35072
    v_mfma_f32_16x16x32_bf16 v[52:55], v[84:87], a[128:131], 0
    ds_read_b64_tr_b16 v[108:109], v9 offset:34816
    v_mfma_f32_16x16x32_bf16 v[68:71], v[84:87], a[192:195], 0
    ds_read_b64_tr_b16 v[110:111], v9 offset:35072
    v_mfma_f32_16x16x32_bf16 v[24:27], v[88:91], a[0:3], 0
    s_add_u32 m0, s57, 0
    s_nop 0
    global_load_lds_dwordx4 v12, s[48:49]
    v_mfma_f32_16x16x32_bf16 v[40:43], v[88:91], a[64:67], 0
    s_add_u32 m0, s57, 32768
    s_nop 0
    global_load_lds_dwordx4 v12, s[50:51]
    v_mfma_f32_16x16x32_bf16 v[56:59], v[88:91], a[128:131], 0
    v_add_u32 v12, s46, v12
    v_mfma_f32_16x16x32_bf16 v[72:75], v[88:91], a[192:195], 0
    s_add_u32 m0, s57, 1024
    s_nop 0
    global_load_lds_dwordx4 v12, s[48:49]
    v_mfma_f32_16x16x32_bf16 v[28:31], v[92:95], a[0:3], 0
    s_add_u32 m0, s57, 33792
    s_nop 0
    global_load_lds_dwordx4 v12, s[50:51]
    v_mfma_f32_16x16x32_bf16 v[44:47], v[92:95], a[64:67], 0
    v_add_u32 v12, s46, v12
    v_mfma_f32_16x16x32_bf16 v[60:63], v[92:95], a[128:131], 0
    v_mfma_f32_16x16x32_bf16 v[76:79], v[92:95], a[192:195], 0
    s_waitcnt lgkmcnt(0)
    v_mfma_f32_16x16x32_bf16 v[16:19], v[96:99], a[4:7], v[16:19]
    ds_read_b64_tr_b16 v[80:81], v8 offset:4096
    v_mfma_f32_16x16x32_bf16 v[32:35], v[96:99], a[68:71], v[32:35]
    ds_read_b64_tr_b16 v[82:83], v8 offset:4352
    v_mfma_f32_16x16x32_bf16 v[48:51], v[96:99], a[132:135], v[48:51]
    ds_read_b64_tr_b16 v[84:85], v9 offset:4096
    v_mfma_f32_16x16x32_bf16 v[64:67], v[96:99], a[196:199], v[64:67]
    ds_read_b64_tr_b16 v[86:87], v9 offset:4352
    v_mfma_f32_16x16x32_bf16 v[20:23], v[100:103], a[4:7], v[20:23]
    ds_read_b64_tr_b16 v[88:89], v8 offset:36864
    v_mfma_f32_16x16x32_bf16 v[36:39], v[100:103], a[68:71], v[36:39]
    ds_read_b64_tr_b16 v[90:91], v8 offset:37120
    v_mfma_f32_16x16x32_bf16 v[52:55], v[100:103], a[132:135], v[52:55]
    ds_read_b64_tr_b16 v[92:93], v9 offset:36864
    v_mfma_f32_16x16x32_bf16 v[68:71], v[100:103], a[196:199], v[68:71]
    ds_read_b64_tr_b16 v[94:95], v9 offset:37120
    v_mfma_f32_16x16x32_bf16 v[24:27], v[104:107], a[4:7], v[24:27]
    s_add_u32 m0, s57, 2048
    s_nop 0
    global_load_lds_dwordx4 v12, s[48:49]
    v_mfma_f32_16x16x32_bf16 v[40:43], v[104:107], a[68:71], v[40:43]
    s_add_u32 m0, s57, 34816
    s_nop 0
    global_load_lds_dwordx4 v12, s[50:51]
    v_mfma_f32_16x16x32_bf16 v[56:59], v[104:107], a[132:135], v[56:59]
    v_add_u32 v12, s46, v12
    v_mfma_f32_16x16x32_bf16 v[72:75], v[104:107], a[196:199], v[72:75]
    s_add_u32 m0, s57, 3072
    s_nop 0
    global_load_lds_dwordx4 v12, s[48:49]
    v_mfma_f32_16x16x32_bf16 v[28:31], v[108:111], a[4:7], v[28:31]
    s_add_u32 m0, s57, 35840
    s_nop 0
    global_load_lds_dwordx4 v12, s[50:51]
    v_mfma_f32_16x16x32_bf16 v[44:47], v[108:111], a[68:71], v[44:47]
    v_add_u32 v12, s46, v12
    v_mfma_f32_16x16x32_bf16 v[60:63], v[108:111], a[132:135], v[60:63]
    v_mfma_f32_16x16x32_bf16 v[76:79], v[108:111], a[196:199], v[76:79]
    s_waitcnt lgkmcnt(0)
    v_mfma_f32_16x16x32_bf16 v[16:19], v[80:83], a[8:11], v[16:19]
    ds_read_b64_tr_b16 v[96:97], v8 offset:6144
    v_mfma_f32_16x16x32_bf16 v[32:35], v[80:83], a[72:75], v[32:35]
    ds_read_b64_tr_b16 v[98:99], v8 offset:6400
    v_mfma_f32_16x16x32_bf16 v[48:51], v[80:83], a[136:139], v[48:51]
    ds_read_b64_tr_b16 v[100:101], v9 offset:6144
    v_mfma_f32_16x16x32_bf16 v[64:67], v[80:83], a[200:203], v[64:67]
    ds_read_b64_tr_b16 v[102:103], v9 offset:6400
    v_mfma_f32_16x16x32_bf16 v[20:23], v[84:87], a[8:11], v[20:23]
    ds_read_b64_tr_b16 v[104:105], v8 offset:38912
    v_mfma_f32_16x16x32_bf16 v[36:39], v[84:87], a[72:75], v[36:39]
    ds_read_b64_tr_b16 v[106:107], v8 offset:39168
    v_mfma_f32_16x16x32_bf16 v[52:55], v[84:87], a[136:139], v[52:55]
    ds_read_b64_tr_b16 v[108:109], v9 offset:38912
    v_mfma_f32_16x16x32_bf16 v[68:71], v[84:87], a[200:203], v[68:71]
    ds_read_b64_tr_b16 v[110:111], v9 offset:39168
    v_mfma_f32_16x16x32_bf16 v[24:27], v[88:91], a[8:11], v[24:27]
    s_add_u32 m0, s57, 4096
    s_nop 0
    global_load_lds_dwordx4 v12, s[48:49]
    v_mfma_f32_16x16x32_bf16 v[40:43], v[88:91], a[72:75], v[40:43]
    s_add_u32 m0, s57, 36864
    s_nop 0
    global_load_lds_dwordx4 v12, s[50:51]
    v_mfma_f32_16x16x32_bf16 v[56:59], v[88:91], a[136:139], v[56:59]
    v_add_u32 v12, s46, v12
    v_mfma_f32_16x16x32_bf16 v[72:75], v[88:91], a[200:203], v[72:75]
    s_add_u32 m0, s57, 5120
    s_nop 0
    global_load_lds_dwordx4 v12, s[48:49]
    v_mfma_f32_16x16x32_bf16 v[28:31], v[92:95], a[8:11], v[28:31]
    s_add_u32 m0, s57, 37888
    s_nop 0
    global_load_lds_dwordx4 v12, s[50:51]
    v_mfma_f32_16x16x32_bf16 v[44:47], v[92:95], a[72:75], v[44:47]
    v_add_u32 v12, s46, v12
    v_mfma_f32_16x16x32_bf16 v[60:63], v[92:95], a[136:139], v[60:63]
    v_mfma_f32_16x16x32_bf16 v[76:79], v[92:95], a[200:203], v[76:79]
    s_waitcnt lgkmcnt(0)
    v_mfma_f32_16x16x32_bf16 v[16:19], v[96:99], a[12:15], v[16:19]
    ds_read_b64_tr_b16 v[80:81], v8 offset:8192
    v_mfma_f32_16x16x32_bf16 v[32:35], v[96:99], a[76:79], v[32:35]
    ds_read_b64_tr_b16 v[82:83], v8 offset:8448
    v_mfma_f32_16x16x32_bf16 v[48:51], v[96:99], a[140:143], v[48:51]
    ds_read_b64_tr_b16 v[84:85], v9 offset:8192
    v_mfma_f32_16x16x32_bf16 v[64:67], v[96:99], a[204:207], v[64:67]
    ds_read_b64_tr_b16 v[86:87], v9 offset:8448
    v_mfma_f32_16x16x32_bf16 v[20:23], v[100:103], a[12:15], v[20:23]
    ds_read_b64_tr_b16 v[88:89], v8 offset:40960
    v_mfma_f32_16x16x32_bf16 v[36:39], v[100:103], a[76:79], v[36:39]
    ds_read_b64_tr_b16 v[90:91], v8 offset:41216
    v_mfma_f32_16x16x32_bf16 v[52:55], v[100:103], a[140:143], v[52:55]
    ds_read_b64_tr_b16 v[92:93], v9 offset:40960
    v_mfma_f32_16x16x32_bf16 v[68:71], v[100:103], a[204:207], v[68:71]
    ds_read_b64_tr_b16 v[94:95], v9 offset:41216
    v_mfma_f32_16x16x32_bf16 v[24:27], v[104:107], a[12:15], v[24:27]
    s_add_u32 m0, s57, 6144
    s_nop 0
    global_load_lds_dwordx4 v12, s[48:49]
    v_mfma_f32_16x16x32_bf16 v[40:43], v[104:107], a[76:79], v[40:43]
    s_add_u32 m0, s57, 38912
    s_nop 0
    global_load_lds_dwordx4 v12, s[50:51]
    v_mfma_f32_16x16x32_bf16 v[56:59], v[104:107], a[140:143], v[56:59]
    v_add_u32 v12, s46, v12
    v_mfma_f32_16x16x32_bf16 v[72:75], v[104:107], a[204:207], v[72:75]
    s_add_u32 m0, s57, 7168
    s_nop 0
    global_load_lds_dwordx4 v12, s[48:49]
    v_mfma_f32_16x16x32_bf16 v[28:31], v[108:111], a[12:15], v[28:31]
    s_add_u32 m0, s57, 39936
    s_nop 0
    global_load_lds_dwordx4 v12, s[50:51]
    v_mfma_f32_16x16x32_bf16 v[44:47], v[108:111], a[76:79], v[44:47]
    v_mfma_f32_16x16x32_bf16 v[60:63], v[108:111], a[140:143], v[60:63]
    v_mfma_f32_16x16x32_bf16 v[76:79], v[108:111], a[204:207], v[76:79]
    s_waitcnt lgkmcnt(0)
    v_mfma_f32_16x16x32_bf16 v[16:19], v[80:83], a[16:19], v[16:19]
    ds_read_b64_tr_b16 v[96:97], v8 offset:10240
    v_mfma_f32_16x16x32_bf16 v[32:35], v[80:83], a[80:83], v[32:35]
    ds_read_b64_tr_b16 v[98:99], v8 offset:10496
    v_mfma_f32_16x16x32_bf16 v[48:51], v[80:83], a[144:147], v[48:51]
    ds_read_b64_tr_b16 v[100:101], v9 offset:10240
    v_mfma_f32_16x16x32_bf16 v[64:67], v[80:83], a[208:211], v[64:67]
    ds_read_b64_tr_b16 v[102:103], v9 offset:10496
    v_mfma_f32_16x16x32_bf16 v[20:23], v[84:87], a[16:19], v[20:23]
    ds_read_b64_tr_b16 v[104:105], v8 offset:43008
    v_mfma_f32_16x16x32_bf16 v[36:39], v[84:87], a[80:83], v[36:39]
    ds_read_b64_tr_b16 v[106:107], v8 offset:43264
    v_mfma_f32_16x16x32_bf16 v[52:55], v[84:87], a[144:147], v[52:55]
    ds_read_b64_tr_b16 v[108:109], v9 offset:43008
    v_mfma_f32_16x16x32_bf16 v[68:71], v[84:87], a[208:211], v[68:71]
    ds_read_b64_tr_b16 v[110:111], v9 offset:43264
    v_mfma_f32_16x16x32_bf16 v[24:27], v[88:91], a[16:19], v[24:27]
    v_mfma_f32_16x16x32_bf16 v[40:43], v[88:91], a[80:83], v[40:43]
    v_mfma_f32_16x16x32_bf16 v[56:59], v[88:91], a[144:147], v[56:59]
    v_mfma_f32_16x16x32_bf16 v[72:75], v[88:91], a[208:211], v[72:75]
    v_mfma_f32_16x16x32_bf16 v[28:31], v[92:95], a[16:19], v[28:31]
    v_mfma_f32_16x16x32_bf16 v[44:47], v[92:95], a[80:83], v[44:47]
    v_mfma_f32_16x16x32_bf16 v[60:63], v[92:95], a[144:147], v[60:63]
    v_mfma_f32_16x16x32_bf16 v[76:79], v[92:95], a[208:211], v[76:79]
    s_waitcnt lgkmcnt(0)
    v_mfma_f32_16x16x32_bf16 v[16:19], v[96:99], a[20:23], v[16:19]
    ds_read_b64_tr_b16 v[80:81], v8 offset:12288
    v_mfma_f32_16x16x32_bf16 v[32:35], v[96:99], a[84:87], v[32:35]
    ds_read_b64_tr_b16 v[82:83], v8 offset:12544
    v_mfma_f32_16x16x32_bf16 v[48:51], v[96:99], a[148:151], v[48:51]
    ds_read_b64_tr_b16 v[84:85], v9 offset:12288
    v_mfma_f32_16x16x32_bf16 v[64:67], v[96:99], a[212:215], v[64:67]
    ds_read_b64_tr_b16 v[86:87], v9 offset:12544
    v_mfma_f32_16x16x32_bf16 v[20:23], v[100:103], a[20:23], v[20:23]
    ds_read_b64_tr_b16 v[88:89], v8 offset:45056
    v_mfma_f32_16x16x32_bf16 v[36:39], v[100:103], a[84:87], v[36:39]
    ds_read_b64_tr_b16 v[90:91], v8 offset:45312
    v_mfma_f32_16x16x32_bf16 v[52:55], v[100:103], a[148:151], v[52:55]
    ds_read_b64_tr_b16 v[92:93], v9 offset:45056
    v_mfma_f32_16x16x32_bf16 v[68:71], v[100:103], a[212:215], v[68:71]
    ds_read_b64_tr_b16 v[94:95], v9 offset:45312
    v_mfma_f32_16x16x32_bf16 v[24:27], v[104:107], a[20:23], v[24:27]
    v_mfma_f32_16x16x32_bf16 v[40:43], v[104:107], a[84:87], v[40:43]
    v_mfma_f32_16x16x32_bf16 v[56:59], v[104:107], a[148:151], v[56:59]
    v_mfma_f32_16x16x32_bf16 v[72:75], v[104:107], a[212:215], v[72:75]
    v_mfma_f32_16x16x32_bf16 v[28:31], v[108:111], a[20:23], v[28:31]
    v_mfma_f32_16x16x32_bf16 v[44:47], v[108:111], a[84:87], v[44:47]
    v_mfma_f32_16x16x32_bf16 v[60:63], v[108:111], a[148:151], v[60:63]
    v_mfma_f32_16x16x32_bf16 v[76:79], v[108:111], a[212:215], v[76:79]
    s_waitcnt lgkmcnt(0)
    v_mfma_f32_16x16x32_bf16 v[16:19], v[80:83], a[24:27], v[16:19]
    ds_read_b64_tr_b16 v[96:97], v8 offset:14336
    v_mfma_f32_16x16x32_bf16 v[32:35], v[80:83], a[88:91], v[32:35]
    ds_read_b64_tr_b16 v[98:99], v8 offset:14592
    v_mfma_f32_16x16x32_bf16 v[48:51], v[80:83], a[152:155], v[48:51]
    ds_read_b64_tr_b16 v[100:101], v9 offset:14336
    v_mfma_f32_16x16x32_bf16 v[64:67], v[80:83], a[216:219], v[64:67]
    ds_read_b64_tr_b16 v[102:103], v9 offset:14592
    v_mfma_f32_16x16x32_bf16 v[20:23], v[84:87], a[24:27], v[20:23]
    ds_read_b64_tr_b16 v[104:105], v8 offset:47104
    v_mfma_f32_16x16x32_bf16 v[36:39], v[84:87], a[88:91], v[36:39]
    ds_read_b64_tr_b16 v[106:107], v8 offset:47360
    v_mfma_f32_16x16x32_bf16 v[52:55], v[84:87], a[152:155], v[52:55]
    ds_read_b64_tr_b16 v[108:109], v9 offset:47104
    v_mfma_f32_16x16x32_bf16 v[68:71], v[84:87], a[216:219], v[68:71]
    ds_read_b64_tr_b16 v[110:111], v9 offset:47360
    v_mfma_f32_16x16x32_bf16 v[24:27], v[88:91], a[24:27], v[24:27]
    v_mfma_f32_16x16x32_bf16 v[40:43], v[88:91], a[88:91], v[40:43]
    v_mfma_f32_16x16x32_bf16 v[56:59], v[88:91], a[152:155], v[56:59]
    v_mfma_f32_16x16x32_bf16 v[72:75], v[88:91], a[216:219], v[72:75]
    v_mfma_f32_16x16x32_bf16 v[28:31], v[92:95], a[24:27], v[28:31]
    v_mfma_f32_16x16x32_bf16 v[44:47], v[92:95], a[88:91], v[44:47]
    v_mfma_f32_16x16x32_bf16 v[60:63], v[92:95], a[152:155], v[60:63]
    v_mfma_f32_16x16x32_bf16 v[76:79], v[92:95], a[216:219], v[76:79]
    s_waitcnt lgkmcnt(0)
    v_mfma_f32_16x16x32_bf16 v[16:19], v[96:99], a[28:31], v[16:19]
    ds_read_b64_tr_b16 v[80:81], v8 offset:16384
    v_mfma_f32_16x16x32_bf16 v[32:35], v[96:99], a[92:95], v[32:35]
    ds_read_b64_tr_b16 v[82:83], v8 offset:16640
    v_mfma_f32_16x16x32_bf16 v[48:51], v[96:99], a[156:159], v[48:51]
    ds_read_b64_tr_b16 v[84:85], v9 offset:16384
    v_mfma_f32_16x16x32_bf16 v[64:67], v[96:99], a[220:223], v[64:67]
    ds_read_b64_tr_b16 v[86:87], v9 offset:16640
    v_mfma_f32_16x16x32_bf16 v[20:23], v[100:103], a[28:31], v[20:23]
    ds_read_b64_tr_b16 v[88:89], v8 offset:49152
    v_mfma_f32_16x16x32_bf16 v[36:39], v[100:103], a[92:95], v[36:39]
    ds_read_b64_tr_b16 v[90:91], v8 offset:49408
    v_mfma_f32_16x16x32_bf16 v[52:55], v[100:103], a[156:159], v[52:55]
    ds_read_b64_tr_b16 v[92:93], v9 offset:49152
    v_mfma_f32_16x16x32_bf16 v[68:71], v[100:103], a[220:223], v[68:71]
    ds_read_b64_tr_b16 v[94:95], v9 offset:49408
    v_mfma_f32_16x16x32_bf16 v[24:27], v[104:107], a[28:31], v[24:27]
    v_mfma_f32_16x16x32_bf16 v[40:43], v[104:107], a[92:95], v[40:43]
    v_mfma_f32_16x16x32_bf16 v[56:59], v[104:107], a[156:159], v[56:59]
    v_mfma_f32_16x16x32_bf16 v[72:75], v[104:107], a[220:223], v[72:75]
    v_mfma_f32_16x16x32_bf16 v[28:31], v[108:111], a[28:31], v[28:31]
    v_mfma_f32_16x16x32_bf16 v[44:47], v[108:111], a[92:95], v[44:47]
    v_mfma_f32_16x16x32_bf16 v[60:63], v[108:111], a[156:159], v[60:63]
    v_mfma_f32_16x16x32_bf16 v[76:79], v[108:111], a[220:223], v[76:79]
    s_waitcnt lgkmcnt(0)
    s_waitcnt vmcnt(16)
    s_mov_b64 exec, s[60:61]
    global_store_byte v15, v14, s[62:63] sc1
    s_mov_b64 exec, -1
    v_mfma_f32_16x16x32_bf16 v[16:19], v[80:83], a[32:35], v[16:19]
    ds_read_b64_tr_b16 v[96:97], v8 offset:18432
    v_mfma_f32_16x16x32_bf16 v[32:35], v[80:83], a[96:99], v[32:35]
    ds_read_b64_tr_b16 v[98:99], v8 offset:18688
    v_mfma_f32_16x16x32_bf16 v[48:51], v[80:83], a[160:163], v[48:51]
    ds_read_b64_tr_b16 v[100:101], v9 offset:18432
    v_mfma_f32_16x16x32_bf16 v[64:67], v[80:83], a[224:227], v[64:67]
    ds_read_b64_tr_b16 v[102:103], v9 offset:18688
    v_mfma_f32_16x16x32_bf16 v[20:23], v[84:87], a[32:35], v[20:23]
    ds_read_b64_tr_b16 v[104:105], v8 offset:51200
    v_mfma_f32_16x16x32_bf16 v[36:39], v[84:87], a[96:99], v[36:39]
    ds_read_b64_tr_b16 v[106:107], v8 offset:51456
    v_mfma_f32_16x16x32_bf16 v[52:55], v[84:87], a[160:163], v[52:55]
    ds_read_b64_tr_b16 v[108:109], v9 offset:51200
    v_mfma_f32_16x16x32_bf16 v[68:71], v[84:87], a[224:227], v[68:71]
    ds_read_b64_tr_b16 v[110:111], v9 offset:51456
    v_mfma_f32_16x16x32_bf16 v[24:27], v[88:91], a[32:35], v[24:27]
    v_mfma_f32_16x16x32_bf16 v[40:43], v[88:91], a[96:99], v[40:43]
    v_mfma_f32_16x16x32_bf16 v[56:59], v[88:91], a[160:163], v[56:59]
    v_mfma_f32_16x16x32_bf16 v[72:75], v[88:91], a[224:227], v[72:75]
    v_mfma_f32_16x16x32_bf16 v[28:31], v[92:95], a[32:35], v[28:31]
    v_mfma_f32_16x16x32_bf16 v[44:47], v[92:95], a[96:99], v[44:47]
    v_mfma_f32_16x16x32_bf16 v[60:63], v[92:95], a[160:163], v[60:63]
    v_mfma_f32_16x16x32_bf16 v[76:79], v[92:95], a[224:227], v[76:79]
    s_waitcnt lgkmcnt(0)
    v_mfma_f32_16x16x32_bf16 v[16:19], v[96:99], a[36:39], v[16:19]
    ds_read_b64_tr_b16 v[80:81], v8 offset:20480
    v_mfma_f32_16x16x32_bf16 v[32:35], v[96:99], a[100:103], v[32:35]
    ds_read_b64_tr_b16 v[82:83], v8 offset:20736
    v_mfma_f32_16x16x32_bf16 v[48:51], v[96:99], a[164:167], v[48:51]
    ds_read_b64_tr_b16 v[84:85], v9 offset:20480
    v_mfma_f32_16x16x32_bf16 v[64:67], v[96:99], a[228:231], v[64:67]
    ds_read_b64_tr_b16 v[86:87], v9 offset:20736
    v_mfma_f32_16x16x32_bf16 v[20:23], v[100:103], a[36:39], v[20:23]
    ds_read_b64_tr_b16 v[88:89], v8 offset:53248
    v_mfma_f32_16x16x32_bf16 v[36:39], v[100:103], a[100:103], v[36:39]
    ds_read_b64_tr_b16 v[90:91], v8 offset:53504
    v_mfma_f32_16x16x32_bf16 v[52:55], v[100:103], a[164:167], v[52:55]
    ds_read_b64_tr_b16 v[92:93], v9 offset:53248
    v_mfma_f32_16x16x32_bf16 v[68:71], v[100:103], a[228:231], v[68:71]
    ds_read_b64_tr_b16 v[94:95], v9 offset:53504
    v_mfma_f32_16x16x32_bf16 v[24:27], v[104:107], a[36:39], v[24:27]
    v_mfma_f32_16x16x32_bf16 v[40:43], v[104:107], a[100:103], v[40:43]
    v_mfma_f32_16x16x32_bf16 v[56:59], v[104:107], a[164:167], v[56:59]
    v_mfma_f32_16x16x32_bf16 v[72:75], v[104:107], a[228:231], v[72:75]
    v_mfma_f32_16x16x32_bf16 v[28:31], v[108:111], a[36:39], v[28:31]
    v_mfma_f32_16x16x32_bf16 v[44:47], v[108:111], a[100:103], v[44:47]
    v_mfma_f32_16x16x32_bf16 v[60:63], v[108:111], a[164:167], v[60:63]
    v_mfma_f32_16x16x32_bf16 v[76:79], v[108:111], a[228:231], v[76:79]
    s_waitcnt lgkmcnt(0)
    v_mfma_f32_16x16x32_bf16 v[16:19], v[80:83], a[40:43], v[16:19]
    ds_read_b64_tr_b16 v[96:97], v8 offset:22528
    v_mfma_f32_16x16x32_bf16 v[32:35], v[80:83], a[104:107], v[32:35]
    ds_read_b64_tr_b16 v[98:99], v8 offset:22784
    v_mfma_f32_16x16x32_bf16 v[48:51], v[80:83], a[168:171], v[48:51]
    ds_read_b64_tr_b16 v[100:101], v9 offset:22528
    v_mfma_f32_16x16x32_bf16 v[64:67], v[80:83], a[232:235], v[64:67]
    ds_read_b64_tr_b16 v[102:103], v9 offset:22784
    v_mfma_f32_16x16x32_bf16 v[20:23], v[84:87], a[40:43], v[20:23]
    ds_read_b64_tr_b16 v[104:105], v8 offset:55296
    v_mfma_f32_16x16x32_bf16 v[36:39], v[84:87], a[104:107], v[36:39]
    ds_read_b64_tr_b16 v[106:107], v8 offset:55552
    v_mfma_f32_16x16x32_bf16 v[52:55], v[84:87], a[168:171], v[52:55]
    ds_read_b64_tr_b16 v[108:109], v9 offset:55296
    v_mfma_f32_16x16x32_bf16 v[68:71], v[84:87], a[232:235], v[68:71]
    ds_read_b64_tr_b16 v[110:111], v9 offset:55552
    v_mfma_f32_16x16x32_bf16 v[24:27], v[88:91], a[40:43], v[24:27]
    v_mfma_f32_16x16x32_bf16 v[40:43], v[88:91], a[104:107], v[40:43]
    v_mfma_f32_16x16x32_bf16 v[56:59], v[88:91], a[168:171], v[56:59]
    v_mfma_f32_16x16x32_bf16 v[72:75], v[88:91], a[232:235], v[72:75]
    v_mfma_f32_16x16x32_bf16 v[28:31], v[92:95], a[40:43], v[28:31]
    v_mfma_f32_16x16x32_bf16 v[44:47], v[92:95], a[104:107], v[44:47]
    v_mfma_f32_16x16x32_bf16 v[60:63], v[92:95], a[168:171], v[60:63]
    v_mfma_f32_16x16x32_bf16 v[76:79], v[92:95], a[232:235], v[76:79]
    s_waitcnt lgkmcnt(0)
    v_mfma_f32_16x16x32_bf16 v[16:19], v[96:99], a[44:47], v[16:19]
    ds_read_b64_tr_b16 v[80:81], v8 offset:24576
    v_mfma_f32_16x16x32_bf16 v[32:35], v[96:99], a[108:111], v[32:35]
    ds_read_b64_tr_b16 v[82:83], v8 offset:24832
    v_mfma_f32_16x16x32_bf16 v[48:51], v[96:99], a[172:175], v[48:51]
    ds_read_b64_tr_b16 v[84:85], v9 offset:24576
    v_mfma_f32_16x16x32_bf16 v[64:67], v[96:99], a[236:239], v[64:67]
    ds_read_b64_tr_b16 v[86:87], v9 offset:24832
    v_mfma_f32_16x16x32_bf16 v[20:23], v[100:103], a[44:47], v[20:23]
    ds_read_b64_tr_b16 v[88:89], v8 offset:57344
    v_mfma_f32_16x16x32_bf16 v[36:39], v[100:103], a[108:111], v[36:39]
    ds_read_b64_tr_b16 v[90:91], v8 offset:57600
    v_mfma_f32_16x16x32_bf16 v[52:55], v[100:103], a[172:175], v[52:55]
    ds_read_b64_tr_b16 v[92:93], v9 offset:57344
    v_mfma_f32_16x16x32_bf16 v[68:71], v[100:103], a[236:239], v[68:71]
    ds_read_b64_tr_b16 v[94:95], v9 offset:57600
    v_mfma_f32_16x16x32_bf16 v[24:27], v[104:107], a[44:47], v[24:27]
    v_mfma_f32_16x16x32_bf16 v[40:43], v[104:107], a[108:111], v[40:43]
    v_mfma_f32_16x16x32_bf16 v[56:59], v[104:107], a[172:175], v[56:59]
    v_mfma_f32_16x16x32_bf16 v[72:75], v[104:107], a[236:239], v[72:75]
    v_mfma_f32_16x16x32_bf16 v[28:31], v[108:111], a[44:47], v[28:31]
    v_mfma_f32_16x16x32_bf16 v[44:47], v[108:111], a[108:111], v[44:47]
    v_mfma_f32_16x16x32_bf16 v[60:63], v[108:111], a[172:175], v[60:63]
    v_mfma_f32_16x16x32_bf16 v[76:79], v[108:111], a[236:239], v[76:79]
    s_waitcnt lgkmcnt(0)
    v_mfma_f32_16x16x32_bf16 v[16:19], v[80:83], a[48:51], v[16:19]
    ds_read_b64_tr_b16 v[96:97], v8 offset:26624
    v_mfma_f32_16x16x32_bf16 v[32:35], v[80:83], a[112:115], v[32:35]
    ds_read_b64_tr_b16 v[98:99], v8 offset:26880
    v_mfma_f32_16x16x32_bf16 v[48:51], v[80:83], a[176:179], v[48:51]
    ds_read_b64_tr_b16 v[100:101], v9 offset:26624
    v_mfma_f32_16x16x32_bf16 v[64:67], v[80:83], a[240:243], v[64:67]
    ds_read_b64_tr_b16 v[102:103], v9 offset:26880
    v_mfma_f32_16x16x32_bf16 v[20:23], v[84:87], a[48:51], v[20:23]
    ds_read_b64_tr_b16 v[104:105], v8 offset:59392
    v_mfma_f32_16x16x32_bf16 v[36:39], v[84:87], a[112:115], v[36:39]
    ds_read_b64_tr_b16 v[106:107], v8 offset:59648
    v_mfma_f32_16x16x32_bf16 v[52:55], v[84:87], a[176:179], v[52:55]
    ds_read_b64_tr_b16 v[108:109], v9 offset:59392
    v_mfma_f32_16x16x32_bf16 v[68:71], v[84:87], a[240:243], v[68:71]
    ds_read_b64_tr_b16 v[110:111], v9 offset:59648
    v_mfma_f32_16x16x32_bf16 v[24:27], v[88:91], a[48:51], v[24:27]
    v_mfma_f32_16x16x32_bf16 v[40:43], v[88:91], a[112:115], v[40:43]
    v_mfma_f32_16x16x32_bf16 v[56:59], v[88:91], a[176:179], v[56:59]
    v_mfma_f32_16x16x32_bf16 v[72:75], v[88:91], a[240:243], v[72:75]
    v_mfma_f32_16x16x32_bf16 v[28:31], v[92:95], a[48:51], v[28:31]
    v_mfma_f32_16x16x32_bf16 v[44:47], v[92:95], a[112:115], v[44:47]
    v_mfma_f32_16x16x32_bf16 v[60:63], v[92:95], a[176:179], v[60:63]
    v_mfma_f32_16x16x32_bf16 v[76:79], v[92:95], a[240:243], v[76:79]
    s_waitcnt lgkmcnt(0)
    v_mfma_f32_16x16x32_bf16 v[16:19], v[96:99], a[52:55], v[16:19]
    ds_read_b64_tr_b16 v[80:81], v8 offset:28672
    v_mfma_f32_16x16x32_bf16 v[32:35], v[96:99], a[116:119], v[32:35]
    ds_read_b64_tr_b16 v[82:83], v8 offset:28928
    v_mfma_f32_16x16x32_bf16 v[48:51], v[96:99], a[180:183], v[48:51]
    ds_read_b64_tr_b16 v[84:85], v9 offset:28672
    v_mfma_f32_16x16x32_bf16 v[64:67], v[96:99], a[244:247], v[64:67]
    ds_read_b64_tr_b16 v[86:87], v9 offset:28928
    v_mfma_f32_16x16x32_bf16 v[20:23], v[100:103], a[52:55], v[20:23]
    ds_read_b64_tr_b16 v[88:89], v8 offset:61440
    v_mfma_f32_16x16x32_bf16 v[36:39], v[100:103], a[116:119], v[36:39]
    ds_read_b64_tr_b16 v[90:91], v8 offset:61696
    v_mfma_f32_16x16x32_bf16 v[52:55], v[100:103], a[180:183], v[52:55]
    ds_read_b64_tr_b16 v[92:93], v9 offset:61440
    v_mfma_f32_16x16x32_bf16 v[68:71], v[100:103], a[244:247], v[68:71]
    ds_read_b64_tr_b16 v[94:95], v9 offset:61696
    v_mfma_f32_16x16x32_bf16 v[24:27], v[104:107], a[52:55], v[24:27]
    v_mfma_f32_16x16x32_bf16 v[40:43], v[104:107], a[116:119], v[40:43]
    v_mfma_f32_16x16x32_bf16 v[56:59], v[104:107], a[180:183], v[56:59]
    v_mfma_f32_16x16x32_bf16 v[72:75], v[104:107], a[244:247], v[72:75]
    v_mfma_f32_16x16x32_bf16 v[28:31], v[108:111], a[52:55], v[28:31]
    v_mfma_f32_16x16x32_bf16 v[44:47], v[108:111], a[116:119], v[44:47]
    v_mfma_f32_16x16x32_bf16 v[60:63], v[108:111], a[180:183], v[60:63]
    v_mfma_f32_16x16x32_bf16 v[76:79], v[108:111], a[244:247], v[76:79]
    s_waitcnt lgkmcnt(0)
    v_mfma_f32_16x16x32_bf16 v[16:19], v[80:83], a[56:59], v[16:19]
    ds_read_b64_tr_b16 v[96:97], v8 offset:30720
    v_mfma_f32_16x16x32_bf16 v[32:35], v[80:83], a[120:123], v[32:35]
    ds_read_b64_tr_b16 v[98:99], v8 offset:30976
    v_mfma_f32_16x16x32_bf16 v[48:51], v[80:83], a[184:187], v[48:51]
    ds_read_b64_tr_b16 v[100:101], v9 offset:30720
    v_mfma_f32_16x16x32_bf16 v[64:67], v[80:83], a[248:251], v[64:67]
    ds_read_b64_tr_b16 v[102:103], v9 offset:30976
    v_mfma_f32_16x16x32_bf16 v[20:23], v[84:87], a[56:59], v[20:23]
    ds_read_b64_tr_b16 v[104:105], v8 offset:63488
    v_mfma_f32_16x16x32_bf16 v[36:39], v[84:87], a[120:123], v[36:39]
    ds_read_b64_tr_b16 v[106:107], v8 offset:63744
    v_mfma_f32_16x16x32_bf16 v[52:55], v[84:87], a[184:187], v[52:55]
    ds_read_b64_tr_b16 v[108:109], v9 offset:63488
    v_mfma_f32_16x16x32_bf16 v[68:71], v[84:87], a[248:251], v[68:71]
    ds_read_b64_tr_b16 v[110:111], v9 offset:63744
    v_mfma_f32_16x16x32_bf16 v[24:27], v[88:91], a[56:59], v[24:27]
    v_mfma_f32_16x16x32_bf16 v[40:43], v[88:91], a[120:123], v[40:43]
    v_mfma_f32_16x16x32_bf16 v[56:59], v[88:91], a[184:187], v[56:59]
    v_mfma_f32_16x16x32_bf16 v[72:75], v[88:91], a[248:251], v[72:75]
    v_mfma_f32_16x16x32_bf16 v[28:31], v[92:95], a[56:59], v[28:31]
    v_mfma_f32_16x16x32_bf16 v[44:47], v[92:95], a[120:123], v[44:47]
    v_mfma_f32_16x16x32_bf16 v[60:63], v[92:95], a[184:187], v[60:63]
    v_mfma_f32_16x16x32_bf16 v[76:79], v[92:95], a[248:251], v[76:79]
    s_waitcnt lgkmcnt(0)
    v_mfma_f32_16x16x32_bf16 v[16:19], v[96:99], a[60:63], v[16:19]
    v_mfma_f32_16x16x32_bf16 v[32:35], v[96:99], a[124:127], v[32:35]
    v_mfma_f32_16x16x32_bf16 v[48:51], v[96:99], a[188:191], v[48:51]
    v_mfma_f32_16x16x32_bf16 v[64:67], v[96:99], a[252:255], v[64:67]
    v_mfma_f32_16x16x32_bf16 v[20:23], v[100:103], a[60:63], v[20:23]
    v_mfma_f32_16x16x32_bf16 v[36:39], v[100:103], a[124:127], v[36:39]
    v_mfma_f32_16x16x32_bf16 v[52:55], v[100:103], a[188:191], v[52:55]
    v_mfma_f32_16x16x32_bf16 v[68:71], v[100:103], a[252:255], v[68:71]
    v_mfma_f32_16x16x32_bf16 v[24:27], v[104:107], a[60:63], v[24:27]
    v_mfma_f32_16x16x32_bf16 v[40:43], v[104:107], a[124:127], v[40:43]
    v_mfma_f32_16x16x32_bf16 v[56:59], v[104:107], a[188:191], v[56:59]
    v_mfma_f32_16x16x32_bf16 v[72:75], v[104:107], a[252:255], v[72:75]
    v_mfma_f32_16x16x32_bf16 v[28:31], v[108:111], a[60:63], v[28:31]
    v_mfma_f32_16x16x32_bf16 v[44:47], v[108:111], a[124:127], v[44:47]
    v_mfma_f32_16x16x32_bf16 v[60:63], v[108:111], a[188:191], v[60:63]
    v_mfma_f32_16x16x32_bf16 v[76:79], v[108:111], a[252:255], v[76:79]
    v_xor_b32 v8, 0x10000, v8
    v_xor_b32 v9, 0x10000, v9
    s_waitcnt vmcnt(0)
    v_cmp_ne_u32 vcc, 0x01010101, v130
    s_cbranch_vccz Lt1_rd1
    s_mov_b32 s21, 0
Lt1_r1_p:
    global_load_dword v130, v129, s[14:15] sc1
    s_add_u32 s21, s21, 1
    s_cmp_gt_u32 s21, 60000
    s_cbranch_scc1 Lt1_r1_b
    s_waitcnt vmcnt(0)
    v_cmp_ne_u32 vcc, 0x01010101, v130
    s_cbranch_vccz Lt1_r1_b
    s_sleep 8
    s_branch Lt1_r1_p
Lt1_r1_b:
    s_waitcnt vmcnt(0)
Lt1_rd1:
    s_barrier
    s_cmp_ge_u32 s44, 192
    s_cbranch_scc1 Lt1_eg
    s_mov_b32 s24, 0
    s_cmp_lt_u32 s44, 128
    s_cbranch_scc1 Lt1_ek
    s_mov_b32 s24, 1040356334
    v_mul_f32 v16, s24, v16
    v_mul_f32 v17, s24, v17
    v_mul_f32 v18, s24, v18
    v_mul_f32 v19, s24, v19
    v_mul_f32 v20, s24, v20
    v_mul_f32 v21, s24, v21
    v_mul_f32 v22, s24, v22
    v_mul_f32 v23, s24, v23
    v_mul_f32 v24, s24, v24
    v_mul_f32 v25, s24, v25
    v_mul_f32 v26, s24, v26
    v_mul_f32 v27, s24, v27
    v_mul_f32 v28, s24, v28
    v_mul_f32 v29, s24, v29
    v_mul_f32 v30, s24, v30
    v_mul_f32 v31, s24, v31
    v_mul_f32 v32, s24, v32
    v_mul_f32 v33, s24, v33
    v_mul_f32 v34, s24, v34
    v_mul_f32 v35, s24, v35
    v_mul_f32 v36, s24, v36
    v_mul_f32 v37, s24, v37
    v_mul_f32 v38, s24, v38
    v_mul_f32 v39, s24, v39
    v_mul_f32 v40, s24, v40
    v_mul_f32 v41, s24, v41
    v_mul_f32 v42, s24, v42
    v_mul_f32 v43, s24, v43
    v_mul_f32 v44, s24, v44
    v_mul_f32 v45, s24, v45
    v_mul_f32 v46, s24, v46
    v_mul_f32 v47, s24, v47
    v_mul_f32 v48, s24, v48
    v_mul_f32 v49, s24, v49
    v_mul_f32 v50, s24, v50
    v_mul_f32 v51, s24, v51
    v_mul_f32 v52, s24, v52
    v_mul_f32 v53, s24, v53
    v_mul_f32 v54, s24, v54
    v_mul_f32 v55, s24, v55
    v_mul_f32 v56, s24, v56
    v_mul_f32 v57, s24, v57
    v_mul_f32 v58, s24, v58
    v_mul_f32 v59, s24, v59
    v_mul_f32 v60, s24, v60
    v_mul_f32 v61, s24, v61
    v_mul_f32 v62, s24, v62
    v_mul_f32 v63, s24, v63
    v_mul_f32 v64, s24, v64
    v_mul_f32 v65, s24, v65
    v_mul_f32 v66, s24, v66
    v_mul_f32 v67, s24, v67
    v_mul_f32 v68, s24, v68
    v_mul_f32 v69, s24, v69
    v_mul_f32 v70, s24, v70
    v_mul_f32 v71, s24, v71
    v_mul_f32 v72, s24, v72
    v_mul_f32 v73, s24, v73
    v_mul_f32 v74, s24, v74
    v_mul_f32 v75, s24, v75
    v_mul_f32 v76, s24, v76
    v_mul_f32 v77, s24, v77
    v_mul_f32 v78, s24, v78
    v_mul_f32 v79, s24, v79
    s_mov_b32 s24, 67108864
Lt1_ek:
    s_lshl_b32 s22, s56, 21
    s_lshl_b32 s23, s19, 19
    s_add_u32 s22, s22, s23
    s_and_b32 s23, s44, 63
    s_lshl_b32 s23, s23, 12
    s_add_u32 s22, s22, s23
    s_add_u32 s22, s22, s24
    s_add_u32 s52, s16, s22
    s_addc_u32 s53, s17, 0
    s_add_u32 s54, s52, 262144
    s_addc_u32 s55, s53, 0
    v_cvt_pk_bf16_f32 v112, v16, v17
    v_cvt_pk_bf16_f32 v113, v18, v19
    v_cvt_pk_bf16_f32 v114, v20, v21
    v_cvt_pk_bf16_f32 v115, v22, v23
    global_store_dwordx4 v6, v[112:115], s[52:53] offset:0 sc1
    v_cvt_pk_bf16_f32 v116, v24, v25
    v_cvt_pk_bf16_f32 v117, v26, v27
    v_cvt_pk_bf16_f32 v118, v28, v29
    v_cvt_pk_bf16_f32 v119, v30, v31
    global_store_dwordx4 v6, v[116:119], s[52:53] offset:2048 sc1
    v_cvt_pk_bf16_f32 v120, v32, v33
    v_cvt_pk_bf16_f32 v121, v34, v35
    v_cvt_pk_bf16_f32 v122, v36, v37
    v_cvt_pk_bf16_f32 v123, v38, v39
    global_store_dwordx4 v6, v[120:123], s[52:53] offset:1024 sc1
    v_cvt_pk_bf16_f32 v124, v40, v41
    v_cvt_pk_bf16_f32 v125, v42, v43
    v_cvt_pk_bf16_f32 v126, v44, v45
    v_cvt_pk_bf16_f32 v127, v46, v47
    global_store_dwordx4 v6, v[124:127], s[52:53] offset:3072 sc1
    v_cvt_pk_bf16_f32 v112, v48, v49
    v_cvt_pk_bf16_f32 v113, v50, v51
    v_cvt_pk_bf16_f32 v114, v52, v53
    v_cvt_pk_bf16_f32 v115, v54, v55
    global_store_dwordx4 v6, v[112:115], s[54:55] offset:0 sc1
    v_cvt_pk_bf16_f32 v116, v56, v57
    v_cvt_pk_bf16_f32 v117, v58, v59
    v_cvt_pk_bf16_f32 v118, v60, v61
    v_cvt_pk_bf16_f32 v119, v62, v63
    global_store_dwordx4 v6, v[116:119], s[54:55] offset:2048 sc1
    v_cvt_pk_bf16_f32 v120, v64, v65
    v_cvt_pk_bf16_f32 v121, v66, v67
    v_cvt_pk_bf16_f32 v122, v68, v69
    v_cvt_pk_bf16_f32 v123, v70, v71
    global_store_dwordx4 v6, v[120:123], s[54:55] offset:1024 sc1
    v_cvt_pk_bf16_f32 v124, v72, v73
    v_cvt_pk_bf16_f32 v125, v74, v75
    v_cvt_pk_bf16_f32 v126, v76, v77
    v_cvt_pk_bf16_f32 v127, v78, v79
    global_store_dwordx4 v6, v[124:127], s[54:55] offset:3072 sc1
    s_cmp_lg_u32 s56, 7
    s_cbranch_scc1 Lt1_next
    s_cmp_ge_u32 s44, 64
    s_cbranch_scc1 Lt1_next
    s_lshl_b32 s22, s19, 18
    s_lshl_b32 s23, s44, 11
    s_add_u32 s22, s22, s23
    s_add_u32 s22, s22, 57671680
    s_add_u32 s52, s16, s22
    s_addc_u32 s53, s17, 0
    s_add_u32 s54, s52, 131072
    s_addc_u32 s55, s53, 0
    v_mov_b64 v[80:81], -1
    v_mov_b64 v[82:83], -1
    global_store_dwordx4 v6, v[80:83], s[52:53] offset:0 sc1
    global_store_dwordx4 v6, v[80:83], s[52:53] offset:1024 sc1
    global_store_dwordx4 v6, v[80:83], s[54:55] offset:0 sc1
    global_store_dwordx4 v6, v[80:83], s[54:55] offset:1024 sc1
    s_branch Lt1_next
Lt1_eg:
    s_lshl_b32 s22, s56, 4
    s_lshl_b32 s23, s19, 2
    s_add_u32 s22, s22, s23
    s_mul_i32 s22, s22, 180224
    s_sub_u32 s23, s44, 64
    s_lshl_b32 s23, s23, 10
    s_add_u32 s22, s22, s23
    s_add_u32 s22, s22, 134217728
    s_add_u32 s52, s16, s22
    s_addc_u32 s53, s17, 0
    v_mul_f32 v16, v16, v24
    v_mul_f32 v17, v17, v25
    v_mul_f32 v18, v18, v26
    v_mul_f32 v19, v19, v27
    v_mul_f32 v20, v20, v28
    v_mul_f32 v21, v21, v29
    v_mul_f32 v22, v22, v30
    v_mul_f32 v23, v23, v31
    v_cvt_pk_bf16_f32 v112, v16, v17
    v_cvt_pk_bf16_f32 v113, v18, v19
    v_cvt_pk_bf16_f32 v114, v20, v21
    v_cvt_pk_bf16_f32 v115, v22, v23
    global_store_dwordx4 v6, v[112:115], s[52:53] sc1
    s_add_u32 s52, s52, 180224
    s_addc_u32 s53, s53, 0
    v_mul_f32 v32, v32, v40
    v_mul_f32 v33, v33, v41
    v_mul_f32 v34, v34, v42
    v_mul_f32 v35, v35, v43
    v_mul_f32 v36, v36, v44
    v_mul_f32 v37, v37, v45
    v_mul_f32 v38, v38, v46
    v_mul_f32 v39, v39, v47
    v_cvt_pk_bf16_f32 v116, v32, v33
    v_cvt_pk_bf16_f32 v117, v34, v35
    v_cvt_pk_bf16_f32 v118, v36, v37
    v_cvt_pk_bf16_f32 v119, v38, v39
    global_store_dwordx4 v6, v[116:119], s[52:53] sc1
    s_add_u32 s52, s52, 180224
    s_addc_u32 s53, s53, 0
    v_mul_f32 v48, v48, v56
    v_mul_f32 v49, v49, v57
    v_mul_f32 v50, v50, v58
    v_mul_f32 v51, v51, v59
    v_mul_f32 v52, v52, v60
    v_mul_f32 v53, v53, v61
    v_mul_f32 v54, v54, v62
    v_mul_f32 v55, v55, v63
    v_cvt_pk_bf16_f32 v120, v48, v49
    v_cvt_pk_bf16_f32 v121, v50, v51
    v_cvt_pk_bf16_f32 v122, v52, v53
    v_cvt_pk_bf16_f32 v123, v54, v55
    global_store_dwordx4 v6, v[120:123], s[52:53] sc1
    s_add_u32 s52, s52, 180224
    s_addc_u32 s53, s53, 0
    v_mul_f32 v64, v64, v72
    v_mul_f32 v65, v65, v73
    v_mul_f32 v66, v66, v74
    v_mul_f32 v67, v67, v75
    v_mul_f32 v68, v68, v76
    v_mul_f32 v69, v69, v77
    v_mul_f32 v70, v70, v78
    v_mul_f32 v71, v71, v79
    v_cvt_pk_bf16_f32 v124, v64, v65
    v_cvt_pk_bf16_f32 v125, v66, v67
    v_cvt_pk_bf16_f32 v126, v68, v69
    v_cvt_pk_bf16_f32 v127, v70, v71
    global_store_dwordx4 v6, v[124:127], s[52:53] sc1
    s_branch Lt1_next
Lt1_mv:
    ds_read_b64_tr_b16 v[80:81], v8 offset:0
    ds_read_b64_tr_b16 v[82:83], v8 offset:256
    ds_read_b64_tr_b16 v[84:85], v9 offset:0
    ds_read_b64_tr_b16 v[86:87], v9 offset:256
    ds_read_b64_tr_b16 v[88:89], v8 offset:32768
    ds_read_b64_tr_b16 v[90:91], v8 offset:33024
    ds_read_b64_tr_b16 v[92:93], v9 offset:32768
    ds_read_b64_tr_b16 v[94:95], v9 offset:33024
    s_waitcnt lgkmcnt(0)
    v_mfma_f32_16x16x32_bf16 v[16:19], a[0:3], v[80:83], 0
    ds_read_b64_tr_b16 v[96:97], v8 offset:2048
    v_mfma_f32_16x16x32_bf16 v[32:35], a[64:67], v[80:83], 0
    ds_read_b64_tr_b16 v[98:99], v8 offset:2304
    v_mfma_f32_16x16x32_bf16 v[48:51], a[128:131], v[80:83], 0
    ds_read_b64_tr_b16 v[100:101], v9 offset:2048
    v_mfma_f32_16x16x32_bf16 v[64:67], a[192:195], v[80:83], 0
    ds_read_b64_tr_b16 v[102:103], v9 offset:2304
    v_mfma_f32_16x16x32_bf16 v[20:23], a[0:3], v[84:87], 0
    ds_read_b64_tr_b16 v[104:105], v8 offset:34816
    v_mfma_f32_16x16x32_bf16 v[36:39], a[64:67], v[84:87], 0
    ds_read_b64_tr_b16 v[106:107], v8 offset:35072
    v_mfma_f32_16x16x32_bf16 v[52:55], a[128:131], v[84:87], 0
    ds_read_b64_tr_b16 v[108:109], v9 offset:34816
    v_mfma_f32_16x16x32_bf16 v[68:71], a[192:195], v[84:87], 0
    ds_read_b64_tr_b16 v[110:111], v9 offset:35072
    v_mfma_f32_16x16x32_bf16 v[24:27], a[0:3], v[88:91], 0
    s_add_u32 m0, s57, 0
    s_nop 0
    global_load_lds_dwordx4 v12, s[48:49]
    v_mfma_f32_16x16x32_bf16 v[40:43], a[64:67], v[88:91], 0
    s_add_u32 m0, s57, 32768
    s_nop 0
    global_load_lds_dwordx4 v12, s[50:51]
    v_mfma_f32_16x16x32_bf16 v[56:59], a[128:131], v[88:91], 0
    v_add_u32 v12, s46, v12
    v_mfma_f32_16x16x32_bf16 v[72:75], a[192:195], v[88:91], 0
    s_add_u32 m0, s57, 1024
    s_nop 0
    global_load_lds_dwordx4 v12, s[48:49]
    v_mfma_f32_16x16x32_bf16 v[28:31], a[0:3], v[92:95], 0
    s_add_u32 m0, s57, 33792
    s_nop 0
    global_load_lds_dwordx4 v12, s[50:51]
    v_mfma_f32_16x16x32_bf16 v[44:47], a[64:67], v[92:95], 0
    v_add_u32 v12, s46, v12
    v_mfma_f32_16x16x32_bf16 v[60:63], a[128:131], v[92:95], 0
    v_mfma_f32_16x16x32_bf16 v[76:79], a[192:195], v[92:95], 0
    s_waitcnt lgkmcnt(0)
    v_mfma_f32_16x16x32_bf16 v[16:19], a[4:7], v[96:99], v[16:19]
    ds_read_b64_tr_b16 v[80:81], v8 offset:4096
    v_mfma_f32_16x16x32_bf16 v[32:35], a[68:71], v[96:99], v[32:35]
    ds_read_b64_tr_b16 v[82:83], v8 offset:4352
    v_mfma_f32_16x16x32_bf16 v[48:51], a[132:135], v[96:99], v[48:51]
    ds_read_b64_tr_b16 v[84:85], v9 offset:4096
    v_mfma_f32_16x16x32_bf16 v[64:67], a[196:199], v[96:99], v[64:67]
    ds_read_b64_tr_b16 v[86:87], v9 offset:4352
    v_mfma_f32_16x16x32_bf16 v[20:23], a[4:7], v[100:103], v[20:23]
    ds_read_b64_tr_b16 v[88:89], v8 offset:36864
    v_mfma_f32_16x16x32_bf16 v[36:39], a[68:71], v[100:103], v[36:39]
    ds_read_b64_tr_b16 v[90:91], v8 offset:37120
    v_mfma_f32_16x16x32_bf16 v[52:55], a[132:135], v[100:103], v[52:55]
    ds_read_b64_tr_b16 v[92:93], v9 offset:36864
    v_mfma_f32_16x16x32_bf16 v[68:71], a[196:199], v[100:103], v[68:71]
    ds_read_b64_tr_b16 v[94:95], v9 offset:37120
    v_mfma_f32_16x16x32_bf16 v[24:27], a[4:7], v[104:107], v[24:27]
    s_add_u32 m0, s57, 2048
    s_nop 0
    global_load_lds_dwordx4 v12, s[48:49]
    v_mfma_f32_16x16x32_bf16 v[40:43], a[68:71], v[104:107], v[40:43]
    s_add_u32 m0, s57, 34816
    s_nop 0
    global_load_lds_dwordx4 v12, s[50:51]
    v_mfma_f32_16x16x32_bf16 v[56:59], a[132:135], v[104:107], v[56:59]
    v_add_u32 v12, s46, v12
    v_mfma_f32_16x16x32_bf16 v[72:75], a[196:199], v[104:107], v[72:75]
    s_add_u32 m0, s57, 3072
    s_nop 0
    global_load_lds_dwordx4 v12, s[48:49]
    v_mfma_f32_16x16x32_bf16 v[28:31], a[4:7], v[108:111], v[28:31]
    s_add_u32 m0, s57, 35840
    s_nop 0
    global_load_lds_dwordx4 v12, s[50:51]
    v_mfma_f32_16x16x32_bf16 v[44:47], a[68:71], v[108:111], v[44:47]
    v_add_u32 v12, s46, v12
    v_mfma_f32_16x16x32_bf16 v[60:63], a[132:135], v[108:111], v[60:63]
    v_mfma_f32_16x16x32_bf16 v[76:79], a[196:199], v[108:111], v[76:79]
    s_waitcnt lgkmcnt(0)
    v_mfma_f32_16x16x32_bf16 v[16:19], a[8:11], v[80:83], v[16:19]
    ds_read_b64_tr_b16 v[96:97], v8 offset:6144
    v_mfma_f32_16x16x32_bf16 v[32:35], a[72:75], v[80:83], v[32:35]
    ds_read_b64_tr_b16 v[98:99], v8 offset:6400
    v_mfma_f32_16x16x32_bf16 v[48:51], a[136:139], v[80:83], v[48:51]
    ds_read_b64_tr_b16 v[100:101], v9 offset:6144
    v_mfma_f32_16x16x32_bf16 v[64:67], a[200:203], v[80:83], v[64:67]
    ds_read_b64_tr_b16 v[102:103], v9 offset:6400
    v_mfma_f32_16x16x32_bf16 v[20:23], a[8:11], v[84:87], v[20:23]
    ds_read_b64_tr_b16 v[104:105], v8 offset:38912
    v_mfma_f32_16x16x32_bf16 v[36:39], a[72:75], v[84:87], v[36:39]
    ds_read_b64_tr_b16 v[106:107], v8 offset:39168
    v_mfma_f32_16x16x32_bf16 v[52:55], a[136:139], v[84:87], v[52:55]
    ds_read_b64_tr_b16 v[108:109], v9 offset:38912
    v_mfma_f32_16x16x32_bf16 v[68:71], a[200:203], v[84:87], v[68:71]
    ds_read_b64_tr_b16 v[110:111], v9 offset:39168
    v_mfma_f32_16x16x32_bf16 v[24:27], a[8:11], v[88:91], v[24:27]
    s_add_u32 m0, s57, 4096
    s_nop 0
    global_load_lds_dwordx4 v12, s[48:49]
    v_mfma_f32_16x16x32_bf16 v[40:43], a[72:75], v[88:91], v[40:43]
    s_add_u32 m0, s57, 36864
    s_nop 0
    global_load_lds_dwordx4 v12, s[50:51]
    v_mfma_f32_16x16x32_bf16 v[56:59], a[136:139], v[88:91], v[56:59]
    v_add_u32 v12, s46, v12
    v_mfma_f32_16x16x32_bf16 v[72:75], a[200:203], v[88:91], v[72:75]
    s_add_u32 m0, s57, 5120
    s_nop 0
    global_load_lds_dwordx4 v12, s[48:49]
    v_mfma_f32_16x16x32_bf16 v[28:31], a[8:11], v[92:95], v[28:31]
    s_add_u32 m0, s57, 37888
    s_nop 0
    global_load_lds_dwordx4 v12, s[50:51]
    v_mfma_f32_16x16x32_bf16 v[44:47], a[72:75], v[92:95], v[44:47]
    v_add_u32 v12, s46, v12
    v_mfma_f32_16x16x32_bf16 v[60:63], a[136:139], v[92:95], v[60:63]
    v_mfma_f32_16x16x32_bf16 v[76:79], a[200:203], v[92:95], v[76:79]
    s_waitcnt lgkmcnt(0)
    v_mfma_f32_16x16x32_bf16 v[16:19], a[12:15], v[96:99], v[16:19]
    ds_read_b64_tr_b16 v[80:81], v8 offset:8192
    v_mfma_f32_16x16x32_bf16 v[32:35], a[76:79], v[96:99], v[32:35]
    ds_read_b64_tr_b16 v[82:83], v8 offset:8448
    v_mfma_f32_16x16x32_bf16 v[48:51], a[140:143], v[96:99], v[48:51]
    ds_read_b64_tr_b16 v[84:85], v9 offset:8192
    v_mfma_f32_16x16x32_bf16 v[64:67], a[204:207], v[96:99], v[64:67]
    ds_read_b64_tr_b16 v[86:87], v9 offset:8448
    v_mfma_f32_16x16x32_bf16 v[20:23], a[12:15], v[100:103], v[20:23]
    ds_read_b64_tr_b16 v[88:89], v8 offset:40960
    v_mfma_f32_16x16x32_bf16 v[36:39], a[76:79], v[100:103], v[36:39]
    ds_read_b64_tr_b16 v[90:91], v8 offset:41216
    v_mfma_f32_16x16x32_bf16 v[52:55], a[140:143], v[100:103], v[52:55]
    ds_read_b64_tr_b16 v[92:93], v9 offset:40960
    v_mfma_f32_16x16x32_bf16 v[68:71], a[204:207], v[100:103], v[68:71]
    ds_read_b64_tr_b16 v[94:95], v9 offset:41216
    v_mfma_f32_16x16x32_bf16 v[24:27], a[12:15], v[104:107], v[24:27]
    s_add_u32 m0, s57, 6144
    s_nop 0
    global_load_lds_dwordx4 v12, s[48:49]
    v_mfma_f32_16x16x32_bf16 v[40:43], a[76:79], v[104:107], v[40:43]
    s_add_u32 m0, s57, 38912
    s_nop 0
    global_load_lds_dwordx4 v12, s[50:51]
    v_mfma_f32_16x16x32_bf16 v[56:59], a[140:143], v[104:107], v[56:59]
    v_add_u32 v12, s46, v12
    v_mfma_f32_16x16x32_bf16 v[72:75], a[204:207], v[104:107], v[72:75]
    s_add_u32 m0, s57, 7168
    s_nop 0
    global_load_lds_dwordx4 v12, s[48:49]
    v_mfma_f32_16x16x32_bf16 v[28:31], a[12:15], v[108:111], v[28:31]
    s_add_u32 m0, s57, 39936
    s_nop 0
    global_load_lds_dwordx4 v12, s[50:51]
    v_mfma_f32_16x16x32_bf16 v[44:47], a[76:79], v[108:111], v[44:47]
    v_mfma_f32_16x16x32_bf16 v[60:63], a[140:143], v[108:111], v[60:63]
    v_mfma_f32_16x16x32_bf16 v[76:79], a[204:207], v[108:111], v[76:79]
    s_waitcnt lgkmcnt(0)
    v_mfma_f32_16x16x32_bf16 v[16:19], a[16:19], v[80:83], v[16:19]
    ds_read_b64_tr_b16 v[96:97], v8 offset:10240
    v_mfma_f32_16x16x32_bf16 v[32:35], a[80:83], v[80:83], v[32:35]
    ds_read_b64_tr_b16 v[98:99], v8 offset:10496
    v_mfma_f32_16x16x32_bf16 v[48:51], a[144:147], v[80:83], v[48:51]
    ds_read_b64_tr_b16 v[100:101], v9 offset:10240
    v_mfma_f32_16x16x32_bf16 v[64:67], a[208:211], v[80:83], v[64:67]
    ds_read_b64_tr_b16 v[102:103], v9 offset:10496
    v_mfma_f32_16x16x32_bf16 v[20:23], a[16:19], v[84:87], v[20:23]
    ds_read_b64_tr_b16 v[104:105], v8 offset:43008
    v_mfma_f32_16x16x32_bf16 v[36:39], a[80:83], v[84:87], v[36:39]
    ds_read_b64_tr_b16 v[106:107], v8 offset:43264
    v_mfma_f32_16x16x32_bf16 v[52:55], a[144:147], v[84:87], v[52:55]
    ds_read_b64_tr_b16 v[108:109], v9 offset:43008
    v_mfma_f32_16x16x32_bf16 v[68:71], a[208:211], v[84:87], v[68:71]
    ds_read_b64_tr_b16 v[110:111], v9 offset:43264
    v_mfma_f32_16x16x32_bf16 v[24:27], a[16:19], v[88:91], v[24:27]
    v_mfma_f32_16x16x32_bf16 v[40:43], a[80:83], v[88:91], v[40:43]
    v_mfma_f32_16x16x32_bf16 v[56:59], a[144:147], v[88:91], v[56:59]
    v_mfma_f32_16x16x32_bf16 v[72:75], a[208:211], v[88:91], v[72:75]
    v_mfma_f32_16x16x32_bf16 v[28:31], a[16:19], v[92:95], v[28:31]
    v_mfma_f32_16x16x32_bf16 v[44:47], a[80:83], v[92:95], v[44:47]
    v_mfma_f32_16x16x32_bf16 v[60:63], a[144:147], v[92:95], v[60:63]
    v_mfma_f32_16x16x32_bf16 v[76:79], a[208:211], v[92:95], v[76:79]
    s_waitcnt lgkmcnt(0)
    v_mfma_f32_16x16x32_bf16 v[16:19], a[20:23], v[96:99], v[16:19]
    ds_read_b64_tr_b16 v[80:81], v8 offset:12288
    v_mfma_f32_16x16x32_bf16 v[32:35], a[84:87], v[96:99], v[32:35]
    ds_read_b64_tr_b16 v[82:83], v8 offset:12544
    v_mfma_f32_16x16x32_bf16 v[48:51], a[148:151], v[96:99], v[48:51]
    ds_read_b64_tr_b16 v[84:85], v9 offset:12288
    v_mfma_f32_16x16x32_bf16 v[64:67], a[212:215], v[96:99], v[64:67]
    ds_read_b64_tr_b16 v[86:87], v9 offset:12544
    v_mfma_f32_16x16x32_bf16 v[20:23], a[20:23], v[100:103], v[20:23]
    ds_read_b64_tr_b16 v[88:89], v8 offset:45056
    v_mfma_f32_16x16x32_bf16 v[36:39], a[84:87], v[100:103], v[36:39]
    ds_read_b64_tr_b16 v[90:91], v8 offset:45312
    v_mfma_f32_16x16x32_bf16 v[52:55], a[148:151], v[100:103], v[52:55]
    ds_read_b64_tr_b16 v[92:93], v9 offset:45056
    v_mfma_f32_16x16x32_bf16 v[68:71], a[212:215], v[100:103], v[68:71]
    ds_read_b64_tr_b16 v[94:95], v9 offset:45312
    v_mfma_f32_16x16x32_bf16 v[24:27], a[20:23], v[104:107], v[24:27]
    v_mfma_f32_16x16x32_bf16 v[40:43], a[84:87], v[104:107], v[40:43]
    v_mfma_f32_16x16x32_bf16 v[56:59], a[148:151], v[104:107], v[56:59]
    v_mfma_f32_16x16x32_bf16 v[72:75], a[212:215], v[104:107], v[72:75]
    v_mfma_f32_16x16x32_bf16 v[28:31], a[20:23], v[108:111], v[28:31]
    v_mfma_f32_16x16x32_bf16 v[44:47], a[84:87], v[108:111], v[44:47]
    v_mfma_f32_16x16x32_bf16 v[60:63], a[148:151], v[108:111], v[60:63]
    v_mfma_f32_16x16x32_bf16 v[76:79], a[212:215], v[108:111], v[76:79]
    s_waitcnt lgkmcnt(0)
    v_mfma_f32_16x16x32_bf16 v[16:19], a[24:27], v[80:83], v[16:19]
    ds_read_b64_tr_b16 v[96:97], v8 offset:14336
    v_mfma_f32_16x16x32_bf16 v[32:35], a[88:91], v[80:83], v[32:35]
    ds_read_b64_tr_b16 v[98:99], v8 offset:14592
    v_mfma_f32_16x16x32_bf16 v[48:51], a[152:155], v[80:83], v[48:51]
    ds_read_b64_tr_b16 v[100:101], v9 offset:14336
    v_mfma_f32_16x16x32_bf16 v[64:67], a[216:219], v[80:83], v[64:67]
    ds_read_b64_tr_b16 v[102:103], v9 offset:14592
    v_mfma_f32_16x16x32_bf16 v[20:23], a[24:27], v[84:87], v[20:23]
    ds_read_b64_tr_b16 v[104:105], v8 offset:47104
    v_mfma_f32_16x16x32_bf16 v[36:39], a[88:91], v[84:87], v[36:39]
    ds_read_b64_tr_b16 v[106:107], v8 offset:47360
    v_mfma_f32_16x16x32_bf16 v[52:55], a[152:155], v[84:87], v[52:55]
    ds_read_b64_tr_b16 v[108:109], v9 offset:47104
    v_mfma_f32_16x16x32_bf16 v[68:71], a[216:219], v[84:87], v[68:71]
    ds_read_b64_tr_b16 v[110:111], v9 offset:47360
    v_mfma_f32_16x16x32_bf16 v[24:27], a[24:27], v[88:91], v[24:27]
    v_mfma_f32_16x16x32_bf16 v[40:43], a[88:91], v[88:91], v[40:43]
    v_mfma_f32_16x16x32_bf16 v[56:59], a[152:155], v[88:91], v[56:59]
    v_mfma_f32_16x16x32_bf16 v[72:75], a[216:219], v[88:91], v[72:75]
    v_mfma_f32_16x16x32_bf16 v[28:31], a[24:27], v[92:95], v[28:31]
    v_mfma_f32_16x16x32_bf16 v[44:47], a[88:91], v[92:95], v[44:47]
    v_mfma_f32_16x16x32_bf16 v[60:63], a[152:155], v[92:95], v[60:63]
    v_mfma_f32_16x16x32_bf16 v[76:79], a[216:219], v[92:95], v[76:79]
    s_waitcnt lgkmcnt(0)
    v_mfma_f32_16x16x32_bf16 v[16:19], a[28:31], v[96:99], v[16:19]
    ds_read_b64_tr_b16 v[80:81], v8 offset:16384
    v_mfma_f32_16x16x32_bf16 v[32:35], a[92:95], v[96:99], v[32:35]
    ds_read_b64_tr_b16 v[82:83], v8 offset:16640
    v_mfma_f32_16x16x32_bf16 v[48:51], a[156:159], v[96:99], v[48:51]
    ds_read_b64_tr_b16 v[84:85], v9 offset:16384
    v_mfma_f32_16x16x32_bf16 v[64:67], a[220:223], v[96:99], v[64:67]
    ds_read_b64_tr_b16 v[86:87], v9 offset:16640
    v_mfma_f32_16x16x32_bf16 v[20:23], a[28:31], v[100:103], v[20:23]
    ds_read_b64_tr_b16 v[88:89], v8 offset:49152
    v_mfma_f32_16x16x32_bf16 v[36:39], a[92:95], v[100:103], v[36:39]
    ds_read_b64_tr_b16 v[90:91], v8 offset:49408
    v_mfma_f32_16x16x32_bf16 v[52:55], a[156:159], v[100:103], v[52:55]
    ds_read_b64_tr_b16 v[92:93], v9 offset:49152
    v_mfma_f32_16x16x32_bf16 v[68:71], a[220:223], v[100:103], v[68:71]
    ds_read_b64_tr_b16 v[94:95], v9 offset:49408
    v_mfma_f32_16x16x32_bf16 v[24:27], a[28:31], v[104:107], v[24:27]
    v_mfma_f32_16x16x32_bf16 v[40:43], a[92:95], v[104:107], v[40:43]
    v_mfma_f32_16x16x32_bf16 v[56:59], a[156:159], v[104:107], v[56:59]
    v_mfma_f32_16x16x32_bf16 v[72:75], a[220:223], v[104:107], v[72:75]
    v_mfma_f32_16x16x32_bf16 v[28:31], a[28:31], v[108:111], v[28:31]
    v_mfma_f32_16x16x32_bf16 v[44:47], a[92:95], v[108:111], v[44:47]
    v_mfma_f32_16x16x32_bf16 v[60:63], a[156:159], v[108:111], v[60:63]
    v_mfma_f32_16x16x32_bf16 v[76:79], a[220:223], v[108:111], v[76:79]
    s_waitcnt lgkmcnt(0)
    s_waitcnt vmcnt(16)
    s_mov_b64 exec, s[60:61]
    global_store_byte v15, v14, s[62:63] sc1
    s_mov_b64 exec, -1
    v_mfma_f32_16x16x32_bf16 v[16:19], a[32:35], v[80:83], v[16:19]
    ds_read_b64_tr_b16 v[96:97], v8 offset:18432
    v_mfma_f32_16x16x32_bf16 v[32:35], a[96:99], v[80:83], v[32:35]
    ds_read_b64_tr_b16 v[98:99], v8 offset:18688
    v_mfma_f32_16x16x32_bf16 v[48:51], a[160:163], v[80:83], v[48:51]
    ds_read_b64_tr_b16 v[100:101], v9 offset:18432
    v_mfma_f32_16x16x32_bf16 v[64:67], a[224:227], v[80:83], v[64:67]
    ds_read_b64_tr_b16 v[102:103], v9 offset:18688
    v_mfma_f32_16x16x32_bf16 v[20:23], a[32:35], v[84:87], v[20:23]
    ds_read_b64_tr_b16 v[104:105], v8 offset:51200
    v_mfma_f32_16x16x32_bf16 v[36:39], a[96:99], v[84:87], v[36:39]
    ds_read_b64_tr_b16 v[106:107], v8 offset:51456
    v_mfma_f32_16x16x32_bf16 v[52:55], a[160:163], v[84:87], v[52:55]
    ds_read_b64_tr_b16 v[108:109], v9 offset:51200
    v_mfma_f32_16x16x32_bf16 v[68:71], a[224:227], v[84:87], v[68:71]
    ds_read_b64_tr_b16 v[110:111], v9 offset:51456
    v_mfma_f32_16x16x32_bf16 v[24:27], a[32:35], v[88:91], v[24:27]
    v_mfma_f32_16x16x32_bf16 v[40:43], a[96:99], v[88:91], v[40:43]
    v_mfma_f32_16x16x32_bf16 v[56:59], a[160:163], v[88:91], v[56:59]
    v_mfma_f32_16x16x32_bf16 v[72:75], a[224:227], v[88:91], v[72:75]
    v_mfma_f32_16x16x32_bf16 v[28:31], a[32:35], v[92:95], v[28:31]
    v_mfma_f32_16x16x32_bf16 v[44:47], a[96:99], v[92:95], v[44:47]
    v_mfma_f32_16x16x32_bf16 v[60:63], a[160:163], v[92:95], v[60:63]
    v_mfma_f32_16x16x32_bf16 v[76:79], a[224:227], v[92:95], v[76:79]
    s_waitcnt lgkmcnt(0)
    v_mfma_f32_16x16x32_bf16 v[16:19], a[36:39], v[96:99], v[16:19]
    ds_read_b64_tr_b16 v[80:81], v8 offset:20480
    v_mfma_f32_16x16x32_bf16 v[32:35], a[100:103], v[96:99], v[32:35]
    ds_read_b64_tr_b16 v[82:83], v8 offset:20736
    v_mfma_f32_16x16x32_bf16 v[48:51], a[164:167], v[96:99], v[48:51]
    ds_read_b64_tr_b16 v[84:85], v9 offset:20480
    v_mfma_f32_16x16x32_bf16 v[64:67], a[228:231], v[96:99], v[64:67]
    ds_read_b64_tr_b16 v[86:87], v9 offset:20736
    v_mfma_f32_16x16x32_bf16 v[20:23], a[36:39], v[100:103], v[20:23]
    ds_read_b64_tr_b16 v[88:89], v8 offset:53248
    v_mfma_f32_16x16x32_bf16 v[36:39], a[100:103], v[100:103], v[36:39]
    ds_read_b64_tr_b16 v[90:91], v8 offset:53504
    v_mfma_f32_16x16x32_bf16 v[52:55], a[164:167], v[100:103], v[52:55]
    ds_read_b64_tr_b16 v[92:93], v9 offset:53248
    v_mfma_f32_16x16x32_bf16 v[68:71], a[228:231], v[100:103], v[68:71]
    ds_read_b64_tr_b16 v[94:95], v9 offset:53504
    v_mfma_f32_16x16x32_bf16 v[24:27], a[36:39], v[104:107], v[24:27]
    v_mfma_f32_16x16x32_bf16 v[40:43], a[100:103], v[104:107], v[40:43]
    v_mfma_f32_16x16x32_bf16 v[56:59], a[164:167], v[104:107], v[56:59]
    v_mfma_f32_16x16x32_bf16 v[72:75], a[228:231], v[104:107], v[72:75]
    v_mfma_f32_16x16x32_bf16 v[28:31], a[36:39], v[108:111], v[28:31]
    v_mfma_f32_16x16x32_bf16 v[44:47], a[100:103], v[108:111], v[44:47]
    v_mfma_f32_16x16x32_bf16 v[60:63], a[164:167], v[108:111], v[60:63]
    v_mfma_f32_16x16x32_bf16 v[76:79], a[228:231], v[108:111], v[76:79]
    s_waitcnt lgkmcnt(0)
    v_mfma_f32_16x16x32_bf16 v[16:19], a[40:43], v[80:83], v[16:19]
    ds_read_b64_tr_b16 v[96:97], v8 offset:22528
    v_mfma_f32_16x16x32_bf16 v[32:35], a[104:107], v[80:83], v[32:35]
    ds_read_b64_tr_b16 v[98:99], v8 offset:22784
    v_mfma_f32_16x16x32_bf16 v[48:51], a[168:171], v[80:83], v[48:51]
    ds_read_b64_tr_b16 v[100:101], v9 offset:22528
    v_mfma_f32_16x16x32_bf16 v[64:67], a[232:235], v[80:83], v[64:67]
    ds_read_b64_tr_b16 v[102:103], v9 offset:22784
    v_mfma_f32_16x16x32_bf16 v[20:23], a[40:43], v[84:87], v[20:23]
    ds_read_b64_tr_b16 v[104:105], v8 offset:55296
    v_mfma_f32_16x16x32_bf16 v[36:39], a[104:107], v[84:87], v[36:39]
    ds_read_b64_tr_b16 v[106:107], v8 offset:55552
    v_mfma_f32_16x16x32_bf16 v[52:55], a[168:171], v[84:87], v[52:55]
    ds_read_b64_tr_b16 v[108:109], v9 offset:55296
    v_mfma_f32_16x16x32_bf16 v[68:71], a[232:235], v[84:87], v[68:71]
    ds_read_b64_tr_b16 v[110:111], v9 offset:55552
    v_mfma_f32_16x16x32_bf16 v[24:27], a[40:43], v[88:91], v[24:27]
    v_mfma_f32_16x16x32_bf16 v[40:43], a[104:107], v[88:91], v[40:43]
    v_mfma_f32_16x16x32_bf16 v[56:59], a[168:171], v[88:91], v[56:59]
    v_mfma_f32_16x16x32_bf16 v[72:75], a[232:235], v[88:91], v[72:75]
    v_mfma_f32_16x16x32_bf16 v[28:31], a[40:43], v[92:95], v[28:31]
    v_mfma_f32_16x16x32_bf16 v[44:47], a[104:107], v[92:95], v[44:47]
    v_mfma_f32_16x16x32_bf16 v[60:63], a[168:171], v[92:95], v[60:63]
    v_mfma_f32_16x16x32_bf16 v[76:79], a[232:235], v[92:95], v[76:79]
    s_waitcnt lgkmcnt(0)
    v_mfma_f32_16x16x32_bf16 v[16:19], a[44:47], v[96:99], v[16:19]
    ds_read_b64_tr_b16 v[80:81], v8 offset:24576
    v_mfma_f32_16x16x32_bf16 v[32:35], a[108:111], v[96:99], v[32:35]
    ds_read_b64_tr_b16 v[82:83], v8 offset:24832
    v_mfma_f32_16x16x32_bf16 v[48:51], a[172:175], v[96:99], v[48:51]
    ds_read_b64_tr_b16 v[84:85], v9 offset:24576
    v_mfma_f32_16x16x32_bf16 v[64:67], a[236:239], v[96:99], v[64:67]
    ds_read_b64_tr_b16 v[86:87], v9 offset:24832
    v_mfma_f32_16x16x32_bf16 v[20:23], a[44:47], v[100:103], v[20:23]
    ds_read_b64_tr_b16 v[88:89], v8 offset:57344
    v_mfma_f32_16x16x32_bf16 v[36:39], a[108:111], v[100:103], v[36:39]
    ds_read_b64_tr_b16 v[90:91], v8 offset:57600
    v_mfma_f32_16x16x32_bf16 v[52:55], a[172:175], v[100:103], v[52:55]
    ds_read_b64_tr_b16 v[92:93], v9 offset:57344
    v_mfma_f32_16x16x32_bf16 v[68:71], a[236:239], v[100:103], v[68:71]
    ds_read_b64_tr_b16 v[94:95], v9 offset:57600
    v_mfma_f32_16x16x32_bf16 v[24:27], a[44:47], v[104:107], v[24:27]
    v_mfma_f32_16x16x32_bf16 v[40:43], a[108:111], v[104:107], v[40:43]
    v_mfma_f32_16x16x32_bf16 v[56:59], a[172:175], v[104:107], v[56:59]
    v_mfma_f32_16x16x32_bf16 v[72:75], a[236:239], v[104:107], v[72:75]
    v_mfma_f32_16x16x32_bf16 v[28:31], a[44:47], v[108:111], v[28:31]
    v_mfma_f32_16x16x32_bf16 v[44:47], a[108:111], v[108:111], v[44:47]
    v_mfma_f32_16x16x32_bf16 v[60:63], a[172:175], v[108:111], v[60:63]
    v_mfma_f32_16x16x32_bf16 v[76:79], a[236:239], v[108:111], v[76:79]
    s_waitcnt lgkmcnt(0)
    v_mfma_f32_16x16x32_bf16 v[16:19], a[48:51], v[80:83], v[16:19]
    ds_read_b64_tr_b16 v[96:97], v8 offset:26624
    v_mfma_f32_16x16x32_bf16 v[32:35], a[112:115], v[80:83], v[32:35]
    ds_read_b64_tr_b16 v[98:99], v8 offset:26880
    v_mfma_f32_16x16x32_bf16 v[48:51], a[176:179], v[80:83], v[48:51]
    ds_read_b64_tr_b16 v[100:101], v9 offset:26624
    v_mfma_f32_16x16x32_bf16 v[64:67], a[240:243], v[80:83], v[64:67]
    ds_read_b64_tr_b16 v[102:103], v9 offset:26880
    v_mfma_f32_16x16x32_bf16 v[20:23], a[48:51], v[84:87], v[20:23]
    ds_read_b64_tr_b16 v[104:105], v8 offset:59392
    v_mfma_f32_16x16x32_bf16 v[36:39], a[112:115], v[84:87], v[36:39]
    ds_read_b64_tr_b16 v[106:107], v8 offset:59648
    v_mfma_f32_16x16x32_bf16 v[52:55], a[176:179], v[84:87], v[52:55]
    ds_read_b64_tr_b16 v[108:109], v9 offset:59392
    v_mfma_f32_16x16x32_bf16 v[68:71], a[240:243], v[84:87], v[68:71]
    ds_read_b64_tr_b16 v[110:111], v9 offset:59648
    v_mfma_f32_16x16x32_bf16 v[24:27], a[48:51], v[88:91], v[24:27]
    v_mfma_f32_16x16x32_bf16 v[40:43], a[112:115], v[88:91], v[40:43]
    v_mfma_f32_16x16x32_bf16 v[56:59], a[176:179], v[88:91], v[56:59]
    v_mfma_f32_16x16x32_bf16 v[72:75], a[240:243], v[88:91], v[72:75]
    v_mfma_f32_16x16x32_bf16 v[28:31], a[48:51], v[92:95], v[28:31]
    v_mfma_f32_16x16x32_bf16 v[44:47], a[112:115], v[92:95], v[44:47]
    v_mfma_f32_16x16x32_bf16 v[60:63], a[176:179], v[92:95], v[60:63]
    v_mfma_f32_16x16x32_bf16 v[76:79], a[240:243], v[92:95], v[76:79]
    s_waitcnt lgkmcnt(0)
    v_mfma_f32_16x16x32_bf16 v[16:19], a[52:55], v[96:99], v[16:19]
    ds_read_b64_tr_b16 v[80:81], v8 offset:28672
    v_mfma_f32_16x16x32_bf16 v[32:35], a[116:119], v[96:99], v[32:35]
    ds_read_b64_tr_b16 v[82:83], v8 offset:28928
    v_mfma_f32_16x16x32_bf16 v[48:51], a[180:183], v[96:99], v[48:51]
    ds_read_b64_tr_b16 v[84:85], v9 offset:28672
    v_mfma_f32_16x16x32_bf16 v[64:67], a[244:247], v[96:99], v[64:67]
    ds_read_b64_tr_b16 v[86:87], v9 offset:28928
    v_mfma_f32_16x16x32_bf16 v[20:23], a[52:55], v[100:103], v[20:23]
    ds_read_b64_tr_b16 v[88:89], v8 offset:61440
    v_mfma_f32_16x16x32_bf16 v[36:39], a[116:119], v[100:103], v[36:39]
    ds_read_b64_tr_b16 v[90:91], v8 offset:61696
    v_mfma_f32_16x16x32_bf16 v[52:55], a[180:183], v[100:103], v[52:55]
    ds_read_b64_tr_b16 v[92:93], v9 offset:61440
    v_mfma_f32_16x16x32_bf16 v[68:71], a[244:247], v[100:103], v[68:71]
    ds_read_b64_tr_b16 v[94:95], v9 offset:61696
    v_mfma_f32_16x16x32_bf16 v[24:27], a[52:55], v[104:107], v[24:27]
    v_mfma_f32_16x16x32_bf16 v[40:43], a[116:119], v[104:107], v[40:43]
    v_mfma_f32_16x16x32_bf16 v[56:59], a[180:183], v[104:107], v[56:59]
    v_mfma_f32_16x16x32_bf16 v[72:75], a[244:247], v[104:107], v[72:75]
    v_mfma_f32_16x16x32_bf16 v[28:31], a[52:55], v[108:111], v[28:31]
    v_mfma_f32_16x16x32_bf16 v[44:47], a[116:119], v[108:111], v[44:47]
    v_mfma_f32_16x16x32_bf16 v[60:63], a[180:183], v[108:111], v[60:63]
    v_mfma_f32_16x16x32_bf16 v[76:79], a[244:247], v[108:111], v[76:79]
    s_waitcnt lgkmcnt(0)
    v_mfma_f32_16x16x32_bf16 v[16:19], a[56:59], v[80:83], v[16:19]
    ds_read_b64_tr_b16 v[96:97], v8 offset:30720
    v_mfma_f32_16x16x32_bf16 v[32:35], a[120:123], v[80:83], v[32:35]
    ds_read_b64_tr_b16 v[98:99], v8 offset:30976
    v_mfma_f32_16x16x32_bf16 v[48:51], a[184:187], v[80:83], v[48:51]
    ds_read_b64_tr_b16 v[100:101], v9 offset:30720
    v_mfma_f32_16x16x32_bf16 v[64:67], a[248:251], v[80:83], v[64:67]
    ds_read_b64_tr_b16 v[102:103], v9 offset:30976
    v_mfma_f32_16x16x32_bf16 v[20:23], a[56:59], v[84:87], v[20:23]
    ds_read_b64_tr_b16 v[104:105], v8 offset:63488
    v_mfma_f32_16x16x32_bf16 v[36:39], a[120:123], v[84:87], v[36:39]
    ds_read_b64_tr_b16 v[106:107], v8 offset:63744
    v_mfma_f32_16x16x32_bf16 v[52:55], a[184:187], v[84:87], v[52:55]
    ds_read_b64_tr_b16 v[108:109], v9 offset:63488
    v_mfma_f32_16x16x32_bf16 v[68:71], a[248:251], v[84:87], v[68:71]
    ds_read_b64_tr_b16 v[110:111], v9 offset:63744
    v_mfma_f32_16x16x32_bf16 v[24:27], a[56:59], v[88:91], v[24:27]
    v_mfma_f32_16x16x32_bf16 v[40:43], a[120:123], v[88:91], v[40:43]
    v_mfma_f32_16x16x32_bf16 v[56:59], a[184:187], v[88:91], v[56:59]
    v_mfma_f32_16x16x32_bf16 v[72:75], a[248:251], v[88:91], v[72:75]
    v_mfma_f32_16x16x32_bf16 v[28:31], a[56:59], v[92:95], v[28:31]
    v_mfma_f32_16x16x32_bf16 v[44:47], a[120:123], v[92:95], v[44:47]
    v_mfma_f32_16x16x32_bf16 v[60:63], a[184:187], v[92:95], v[60:63]
    v_mfma_f32_16x16x32_bf16 v[76:79], a[248:251], v[92:95], v[76:79]
    s_waitcnt lgkmcnt(0)
    v_mfma_f32_16x16x32_bf16 v[16:19], a[60:63], v[96:99], v[16:19]
    v_mfma_f32_16x16x32_bf16 v[32:35], a[124:127], v[96:99], v[32:35]
    v_mfma_f32_16x16x32_bf16 v[48:51], a[188:191], v[96:99], v[48:51]
    v_mfma_f32_16x16x32_bf16 v[64:67], a[252:255], v[96:99], v[64:67]
    v_mfma_f32_16x16x32_bf16 v[20:23], a[60:63], v[100:103], v[20:23]
    v_mfma_f32_16x16x32_bf16 v[36:39], a[124:127], v[100:103], v[36:39]
    v_mfma_f32_16x16x32_bf16 v[52:55], a[188:191], v[100:103], v[52:55]
    v_mfma_f32_16x16x32_bf16 v[68:71], a[252:255], v[100:103], v[68:71]
    v_mfma_f32_16x16x32_bf16 v[24:27], a[60:63], v[104:107], v[24:27]
    v_mfma_f32_16x16x32_bf16 v[40:43], a[124:127], v[104:107], v[40:43]
    v_mfma_f32_16x16x32_bf16 v[56:59], a[188:191], v[104:107], v[56:59]
    v_mfma_f32_16x16x32_bf16 v[72:75], a[252:255], v[104:107], v[72:75]
    v_mfma_f32_16x16x32_bf16 v[28:31], a[60:63], v[108:111], v[28:31]
    v_mfma_f32_16x16x32_bf16 v[44:47], a[124:127], v[108:111], v[44:47]
    v_mfma_f32_16x16x32_bf16 v[60:63], a[188:191], v[108:111], v[60:63]
    v_mfma_f32_16x16x32_bf16 v[76:79], a[252:255], v[108:111], v[76:79]
    v_xor_b32 v8, 0x10000, v8
    v_xor_b32 v9, 0x10000, v9
    s_waitcnt vmcnt(0)
    v_cmp_ne_u32 vcc, 0x01010101, v130
    s_cbranch_vccz Lt1_rd0
    s_mov_b32 s21, 0
Lt1_r0_p:
    global_load_dword v130, v129, s[14:15] sc1
    s_add_u32 s21, s21, 1
    s_cmp_gt_u32 s21, 60000
    s_cbranch_scc1 Lt1_r0_b
    s_waitcnt vmcnt(0)
    v_cmp_ne_u32 vcc, 0x01010101, v130
    s_cbranch_vccz Lt1_r0_b
    s_sleep 8
    s_branch Lt1_r0_p
Lt1_r0_b:
    s_waitcnt vmcnt(0)
Lt1_rd0:
    s_barrier
    s_lshl_b32 s22, s56, 21
    s_lshl_b32 s23, s19, 19
    s_add_u32 s22, s22, s23
    s_and_b32 s23, s44, 63
    s_lshl_b32 s23, s23, 12
    s_add_u32 s22, s22, s23
    s_add_u32 s22, s22, 16777216
    s_add_u32 s52, s16, s22
    s_addc_u32 s53, s17, 0
    s_add_u32 s54, s52, 262144
    s_addc_u32 s55, s53, 0
    v_cvt_pk_bf16_f32 v112, v16, v17
    v_cvt_pk_bf16_f32 v113, v18, v19
    v_cvt_pk_bf16_f32 v114, v32, v33
    v_cvt_pk_bf16_f32 v115, v34, v35
    global_store_dwordx4 v6, v[112:115], s[52:53] offset:0 sc1
    v_cvt_pk_bf16_f32 v116, v20, v21
    v_cvt_pk_bf16_f32 v117, v22, v23
    v_cvt_pk_bf16_f32 v118, v36, v37
    v_cvt_pk_bf16_f32 v119, v38, v39
    global_store_dwordx4 v6, v[116:119], s[52:53] offset:1024 sc1
    v_cvt_pk_bf16_f32 v120, v24, v25
    v_cvt_pk_bf16_f32 v121, v26, v27
    v_cvt_pk_bf16_f32 v122, v40, v41
    v_cvt_pk_bf16_f32 v123, v42, v43
    global_store_dwordx4 v6, v[120:123], s[52:53] offset:2048 sc1
    v_cvt_pk_bf16_f32 v124, v28, v29
    v_cvt_pk_bf16_f32 v125, v30, v31
    v_cvt_pk_bf16_f32 v126, v44, v45
    v_cvt_pk_bf16_f32 v127, v46, v47
    global_store_dwordx4 v6, v[124:127], s[52:53] offset:3072 sc1
    v_cvt_pk_bf16_f32 v112, v48, v49
    v_cvt_pk_bf16_f32 v113, v50, v51
    v_cvt_pk_bf16_f32 v114, v64, v65
    v_cvt_pk_bf16_f32 v115, v66, v67
    global_store_dwordx4 v6, v[112:115], s[54:55] offset:0 sc1
    v_cvt_pk_bf16_f32 v116, v52, v53
    v_cvt_pk_bf16_f32 v117, v54, v55
    v_cvt_pk_bf16_f32 v118, v68, v69
    v_cvt_pk_bf16_f32 v119, v70, v71
    global_store_dwordx4 v6, v[116:119], s[54:55] offset:1024 sc1
    v_cvt_pk_bf16_f32 v120, v56, v57
    v_cvt_pk_bf16_f32 v121, v58, v59
    v_cvt_pk_bf16_f32 v122, v72, v73
    v_cvt_pk_bf16_f32 v123, v74, v75
    global_store_dwordx4 v6, v[120:123], s[54:55] offset:2048 sc1
    v_cvt_pk_bf16_f32 v124, v60, v61
    v_cvt_pk_bf16_f32 v125, v62, v63
    v_cvt_pk_bf16_f32 v126, v76, v77
    v_cvt_pk_bf16_f32 v127, v78, v79
    global_store_dwordx4 v6, v[124:127], s[54:55] offset:3072 sc1
Lt1_next:
    s_lshl_b32 s22, s56, 2
    s_add_u32 s22, s22, s19
    s_lshl_b32 s23, s44, 5
    s_add_u32 s23, s23, s22
    s_add_u32 s23, s23, 10240
    s_lshl_b32 s22, s22, 3
    s_bfe_u32 s24, s44, 0x50001
    s_lshl_b32 s24, s24, 8
    s_add_u32 s22, s22, s24
    s_lshr_b32 s24, s44, 6
    s_lshl_b32 s24, s24, 1
    s_add_u32 s22, s22, s24
    s_and_b32 s24, s44, 1
    s_add_u32 s22, s22, s24
    s_add_u32 s22, s22, 8192
    s_cmp_ge_u32 s44, 192
    s_cselect_b32 s22, s23, s22
    v_mov_b32 v15, s22
    s_mov_b64 s[60:61], 1
    s_cmp_ge_u32 s56, 2
    s_cbranch_scc1 Lt1_nef
    s_add_u32 s22, s44, s47
    s_sub_u32 s22, s22, 128
    s_cmp_ge_u32 s22, s47
    s_cbranch_scc1 Lt1_nef
    s_waitcnt vmcnt(0)
    s_mov_b64 exec, s[60:61]
    global_store_byte v15, v14, s[62:63] sc1
    s_mov_b64 exec, -1
    s_mov_b64 s[60:61], 0
Lt1_nef:
    s_add_u32 s44, s44, s47
    s_cmp_lt_u32 s44, 235
    s_cbranch_scc1 Lt1_tile
    s_waitcnt vmcnt(0)
    s_mov_b64 exec, s[60:61]
    global_store_byte v15, v14, s[62:63] sc1
    s_mov_b64 exec, -1
    s_cmp_lg_u32 s56, 0
    s_cbranch_scc1 Lt1_end
    s_and_b32 s56, s18, 3
    s_add_u32 s56, s56, 4
    s_lshl_b32 s44, s20, 3
    s_lshr_b32 s22, s18, 2
    s_add_u32 s44, s44, s22
    s_sub_u32 s44, s44, 8
    s_mov_b32 s47, 32
    s_branch Lt1_job
Lt1_end:
    s_cmp_le_u32 s20, 6
    s_cbranch_scc1 L_t3
    s_sub_u32 s44, s20, 7
    s_lshl_b32 s44, s44, 2
    s_lshr_b32 s22, s18, 3
    s_add_u32 s44, s44, s22
    s_and_b32 s45, s18, 7
    s_lshl_b32 s45, s45, 2
    s_add_u32 s45, s45, s19
    s_lshl_b32 s22, s19, 12
    v_lshlrev_b32 v7, 5, v4
    v_lshl_add_u32 v7, v5, 3, v7
    v_add_u32 v7, s22, v7
    v_lshlrev_b32 v8, 3, v3
    v_add_u32 v8, s22, v8
    v_mov_b32 v10, 0xff800000
    v_lshlrev_b32 v1, 2, v5
    s_lshl_b32 s22, s45, 7
    s_add_u32 s22, s22, 66080768
    s_add_u32 s54, s16, s22
    s_addc_u32 s55, s17, 0
    v_add_u32 v2, 0, v1
    v_cmp_le_u32 s[56:57], v2, v4
    v_add_u32 v2, 1, v1
    v_cmp_le_u32 s[58:59], v2, v4
    v_add_u32 v2, 2, v1
    v_cmp_le_u32 s[60:61], v2, v4
    v_add_u32 v2, 3, v1
    v_cmp_le_u32 s[62:63], v2, v4
    s_lshl_b32 s22, s45, 8
    s_add_u32 s22, s22, 66068480
    v_lshl_add_u32 v1, v3, 2, s22
    v_and_b32 v16, 1, v3
    v_mul_u32_u24 v16, 0x0101, v16
    v_lshlrev_b32 v16, 16, v16
    s_barrier
    s_mov_b32 s21, 0
Lt2_w_p:
    global_load_dword v2, v1, s[16:17] sc1
    s_add_u32 s21, s21, 1
    s_cmp_gt_u32 s21, 60000
    s_cbranch_scc1 Lt2_w_b
    s_waitcnt vmcnt(0)
    v_or_b32 v2, v2, v16
    v_cmp_ne_u32 vcc, 0x01010101, v2
    s_cbranch_vccz Lt2_w_b
    s_sleep 32
    s_branch Lt2_w_p
Lt2_w_b:
    s_waitcnt vmcnt(0)
Lt2_seg:
    s_lshl_b32 s22, s44, 5
    s_add_u32 s22, s22, s45
    s_lshl_b32 s23, s22, 13
    s_add_u32 s23, s23, 4096
    s_add_u32 s46, s16, s23
    s_addc_u32 s47, s17, 0
    s_add_u32 s48, s46, 67108864
    s_addc_u32 s49, s47, 0
    s_add_u32 s66, s46, 16777216
    s_addc_u32 s67, s47, 0
    s_lshl_b32 s23, s22, 12
    s_add_u32 s23, s23, 50331648
    s_add_u32 s50, s16, s23
    s_addc_u32 s51, s17, 0
    s_lshl_b32 s23, s22, 2
    s_add_u32 s23, s23, 66060288
    s_add_u32 s64, s16, s23
    s_addc_u32 s65, s17, 0
    s_mul_i32 s23, s44, 360448
    s_lshl_b32 s24, s45, 12
    s_add_u32 s23, s23, s24
    s_add_u32 s23, s23, 134217728
    s_add_u32 s52, s16, s23
    s_addc_u32 s53, s17, 0
    global_load_dwordx4 v[16:19], v6, s[48:49] offset:-4096 sc1
    global_load_dwordx4 v[48:51], v6, s[46:47] offset:-4096 sc1
    global_load_dwordx4 v[20:23], v6, s[48:49] offset:-3072 sc1
    global_load_dwordx4 v[52:55], v6, s[46:47] offset:-3072 sc1
    global_load_dwordx4 v[24:27], v6, s[48:49] offset:-2048 sc1
    global_load_dwordx4 v[56:59], v6, s[46:47] offset:-2048 sc1
    global_load_dwordx4 v[28:31], v6, s[48:49] offset:-1024 sc1
    global_load_dwordx4 v[60:63], v6, s[46:47] offset:-1024 sc1
    global_load_dwordx4 v[32:35], v6, s[48:49] offset:0 sc1
    global_load_dwordx4 v[64:67], v6, s[46:47] offset:0 sc1
    global_load_dwordx4 v[36:39], v6, s[48:49] offset:1024 sc1
    global_load_dwordx4 v[68:71], v6, s[46:47] offset:1024 sc1
    global_load_dwordx4 v[40:43], v6, s[48:49] offset:2048 sc1
    global_load_dwordx4 v[72:75], v6, s[46:47] offset:2048 sc1
    global_load_dwordx4 v[44:47], v6, s[48:49] offset:3072 sc1
    global_load_dwordx4 v[76:79], v6, s[46:47] offset:3072 sc1
    global_load_dwordx4 v[80:83], v6, s[66:67] offset:-4096 sc1
    global_load_dwordx4 v[84:87], v6, s[66:67] offset:-3072 sc1
    global_load_dwordx4 v[88:91], v6, s[66:67] offset:-2048 sc1
    global_load_dwordx4 v[92:95], v6, s[66:67] offset:-1024 sc1
    global_load_dwordx4 v[96:99], v6, s[66:67] offset:0 sc1
    global_load_dwordx4 v[100:103], v6, s[66:67] offset:1024 sc1
    global_load_dwordx4 v[104:107], v6, s[66:67] offset:2048 sc1
    global_load_dwordx4 v[108:111], v6, s[66:67] offset:3072 sc1
    s_waitcnt vmcnt(20)
    v_mfma_f32_16x16x32_bf16 v[144:147], v[48:51], v[16:19], 0
    v_mfma_f32_16x16x32_bf16 v[148:151], v[48:51], v[20:23], 0
    v_mfma_f32_16x16x32_bf16 v[152:155], v[52:55], v[20:23], 0
    s_waitcnt vmcnt(16)
    v_mfma_f32_16x16x32_bf16 v[144:147], v[56:59], v[24:27], v[144:147]
    v_mfma_f32_16x16x32_bf16 v[148:151], v[56:59], v[28:31], v[148:151]
    v_mfma_f32_16x16x32_bf16 v[152:155], v[60:63], v[28:31], v[152:155]
    s_waitcnt vmcnt(12)
    v_mfma_f32_16x16x32_bf16 v[144:147], v[64:67], v[32:35], v[144:147]
    v_mfma_f32_16x16x32_bf16 v[148:151], v[64:67], v[36:39], v[148:151]
    v_mfma_f32_16x16x32_bf16 v[152:155], v[68:71], v[36:39], v[152:155]
    s_waitcnt vmcnt(8)
    v_mfma_f32_16x16x32_bf16 v[144:147], v[72:75], v[40:43], v[144:147]
    v_mfma_f32_16x16x32_bf16 v[148:151], v[72:75], v[44:47], v[148:151]
    v_mfma_f32_16x16x32_bf16 v[152:155], v[76:79], v[44:47], v[152:155]
    v_cndmask_b32 v144, v10, v144, s[56:57]
    s_nop 6
    v_cndmask_b32 v152, v10, v152, s[56:57]
    v_cndmask_b32 v145, v10, v145, s[58:59]
    v_cndmask_b32 v153, v10, v153, s[58:59]
    v_cndmask_b32 v146, v10, v146, s[60:61]
    v_cndmask_b32 v154, v10, v154, s[60:61]
    v_cndmask_b32 v147, v10, v147, s[62:63]
    v_cndmask_b32 v155, v10, v155, s[62:63]
    v_max3_f32 v164, v144, v145, v146
    v_max_f32 v164, v164, v147
    v_max3_f32 v165, v148, v149, v150
    v_max3_f32 v165, v165, v151, v152
    v_max3_f32 v165, v165, v153, v154
    v_max_f32 v165, v165, v155
    s_add_u32 s22, s44, 2
    v_mov_b32 v1, 0
    s_mov_b32 s21, 0
Lt2_p:
    global_load_dword v2, v1, s[54:55] sc1
    s_add_u32 s21, s21, 1
    s_cmp_gt_u32 s21, 60000
    s_cbranch_scc1 Lt2_go
    s_waitcnt vmcnt(0)
    v_cmp_le_u32 vcc, s22, v2
    s_cbranch_vccnz Lt2_go
    s_sleep 4
    s_branch Lt2_p
Lt2_go:
    global_load_dwordx4 v[112:115], v6, s[50:51] offset:0 sc1
    global_load_dwordx4 v[116:119], v6, s[50:51] offset:1024 sc1
    global_load_dwordx4 v[120:123], v6, s[50:51] offset:2048 sc1
    global_load_dwordx4 v[124:127], v6, s[50:51] offset:3072 sc1
    s_waitcnt vmcnt(0)
    ds_write_b32 v7, v112 offset:0
    ds_write_b32 v7, v113 offset:512
    ds_write_b32 v7, v116 offset:1024
    ds_write_b32 v7, v117 offset:1536
    ds_write_b32 v7, v120 offset:2048
    ds_write_b32 v7, v121 offset:2560
    ds_write_b32 v7, v124 offset:3072
    ds_write_b32 v7, v125 offset:3584
    s_waitcnt lgkmcnt(0)
    ds_read_b64_tr_b16 v[128:129], v8 offset:0
    ds_read_b64_tr_b16 v[130:131], v8 offset:512
    ds_read_b64_tr_b16 v[132:133], v8 offset:1024
    ds_read_b64_tr_b16 v[134:135], v8 offset:1536
    ds_read_b64_tr_b16 v[136:137], v8 offset:2048
    ds_read_b64_tr_b16 v[138:139], v8 offset:2560
    ds_read_b64_tr_b16 v[140:141], v8 offset:3072
    ds_read_b64_tr_b16 v[142:143], v8 offset:3584
    s_waitcnt lgkmcnt(0)
    v_mfma_f32_16x16x32_bf16 v[156:159], v[128:131], v[16:19], 0
    v_mfma_f32_16x16x32_bf16 v[160:163], v[128:131], v[20:23], 0
    v_mfma_f32_16x16x32_bf16 v[156:159], v[132:135], v[24:27], v[156:159]
    v_mfma_f32_16x16x32_bf16 v[160:163], v[132:135], v[28:31], v[160:163]
    v_mfma_f32_16x16x32_bf16 v[156:159], v[136:139], v[32:35], v[156:159]
    v_mfma_f32_16x16x32_bf16 v[160:163], v[136:139], v[36:39], v[160:163]
    v_mfma_f32_16x16x32_bf16 v[156:159], v[140:143], v[40:43], v[156:159]
    v_mfma_f32_16x16x32_bf16 v[160:163], v[140:143], v[44:47], v[160:163]
    s_nop 3
    v_max3_f32 v164, v164, v156, v157
    s_nop 2
    v_max3_f32 v165, v165, v160, v161
    v_mov_b32 v166, v164
    v_mov_b32 v167, v165
    s_nop 0
    v_permlane16_swap_b32 v164, v166
    v_permlane16_swap_b32 v165, v167
    v_max_f32 v164, v164, v166
    v_max_f32 v165, v165, v167
    v_mov_b32 v166, v164
    v_mov_b32 v167, v165
    s_nop 0
    v_permlane32_swap_b32 v164, v166
    v_permlane32_swap_b32 v165, v167
    v_max_f32 v164, v164, v166
    v_max_f32 v165, v165, v167
    v_sub_f32 v144, v144, v164
    v_sub_f32 v145, v145, v164
    v_sub_f32 v146, v146, v164
    v_sub_f32 v147, v147, v164
    v_sub_f32 v156, v156, v164
    v_sub_f32 v157, v157, v164
    v_sub_f32 v148, v148, v165
    v_sub_f32 v149, v149, v165
    v_sub_f32 v150, v150, v165
    v_sub_f32 v151, v151, v165
    v_sub_f32 v152, v152, v165
    v_sub_f32 v153, v153, v165
    v_sub_f32 v154, v154, v165
    v_sub_f32 v155, v155, v165
    v_sub_f32 v160, v160, v165
    v_sub_f32 v161, v161, v165
    v_exp_f32 v144, v144
    v_exp_f32 v145, v145
    v_exp_f32 v146, v146
    v_exp_f32 v147, v147
    v_exp_f32 v156, v156
    v_exp_f32 v157, v157
    v_exp_f32 v148, v148
    v_exp_f32 v149, v149
    v_exp_f32 v150, v150
    v_exp_f32 v151, v151
    v_exp_f32 v152, v152
    v_exp_f32 v153, v153
    v_exp_f32 v154, v154
    v_exp_f32 v155, v155
    v_exp_f32 v160, v160
    v_exp_f32 v161, v161
    v_cvt_pk_bf16_f32 v240, v144, v145
    v_cvt_pk_bf16_f32 v241, v146, v147
    v_mov_b64 v[242:243], 0
    v_cvt_pk_bf16_f32 v244, v148, v149
    v_cvt_pk_bf16_f32 v245, v150, v151
    v_cvt_pk_bf16_f32 v246, v152, v153
    v_cvt_pk_bf16_f32 v247, v154, v155
    v_cvt_pk_bf16_f32 v248, v156, v157
    v_mov_b32 v249, 0
    v_mov_b32 v250, 0
    v_mov_b32 v251, v248
    v_cvt_pk_bf16_f32 v252, v160, v161
    v_mov_b32 v253, 0
    v_mov_b32 v254, 0
    v_mov_b32 v255, v252
    v_mfma_f32_16x16x32_bf16 v[176:179], v[80:83], v[240:243], 0
    v_mfma_f32_16x16x32_bf16 v[180:183], v[84:87], v[240:243], 0
    v_mfma_f32_16x16x32_bf16 v[184:187], v[88:91], v[240:243], 0
    v_mfma_f32_16x16x32_bf16 v[188:191], v[92:95], v[240:243], 0
    v_mfma_f32_16x16x32_bf16 v[192:195], v[96:99], v[240:243], 0
    v_mfma_f32_16x16x32_bf16 v[196:199], v[100:103], v[240:243], 0
    v_mfma_f32_16x16x32_bf16 v[200:203], v[104:107], v[240:243], 0
    v_mfma_f32_16x16x32_bf16 v[204:207], v[108:111], v[240:243], 0
    v_mfma_f32_16x16x32_bf16 v[208:211], v[80:83], v[244:247], 0
    v_mfma_f32_16x16x32_bf16 v[212:215], v[84:87], v[244:247], 0
    v_mfma_f32_16x16x32_bf16 v[216:219], v[88:91], v[244:247], 0
    v_mfma_f32_16x16x32_bf16 v[220:223], v[92:95], v[244:247], 0
    v_mfma_f32_16x16x32_bf16 v[224:227], v[96:99], v[244:247], 0
    v_mfma_f32_16x16x32_bf16 v[228:231], v[100:103], v[244:247], 0
    v_mfma_f32_16x16x32_bf16 v[232:235], v[104:107], v[244:247], 0
    v_mfma_f32_16x16x32_bf16 v[236:239], v[108:111], v[244:247], 0
    v_mfma_f32_16x16x16_bf16 v[176:179], v[114:115], v[248:249], v[176:179]
    v_mfma_f32_16x16x16_bf16 v[180:183], v[114:115], v[250:251], v[180:183]
    v_mfma_f32_16x16x16_bf16 v[184:187], v[118:119], v[248:249], v[184:187]
    v_mfma_f32_16x16x16_bf16 v[188:191], v[118:119], v[250:251], v[188:191]
    v_mfma_f32_16x16x16_bf16 v[192:195], v[122:123], v[248:249], v[192:195]
    v_mfma_f32_16x16x16_bf16 v[196:199], v[122:123], v[250:251], v[196:199]
    v_mfma_f32_16x16x16_bf16 v[200:203], v[126:127], v[248:249], v[200:203]
    v_mfma_f32_16x16x16_bf16 v[204:207], v[126:127], v[250:251], v[204:207]
    v_mfma_f32_16x16x16_bf16 v[208:211], v[114:115], v[252:253], v[208:211]
    v_mfma_f32_16x16x16_bf16 v[212:215], v[114:115], v[254:255], v[212:215]
    v_mfma_f32_16x16x16_bf16 v[216:219], v[118:119], v[252:253], v[216:219]
    v_mfma_f32_16x16x16_bf16 v[220:223], v[118:119], v[254:255], v[220:223]
    v_mfma_f32_16x16x16_bf16 v[224:227], v[122:123], v[252:253], v[224:227]
    v_mfma_f32_16x16x16_bf16 v[228:231], v[122:123], v[254:255], v[228:231]
    v_mfma_f32_16x16x16_bf16 v[232:235], v[126:127], v[252:253], v[232:235]
    v_mfma_f32_16x16x16_bf16 v[236:239], v[126:127], v[254:255], v[236:239]
    v_add_f32 v144, v144, v145
    v_add_f32 v144, v144, v146
    v_add_f32 v144, v144, v147
    v_add_f32 v144, v144, v156
    v_add_f32 v144, v144, v157
    v_add_f32 v148, v148, v149
    v_add_f32 v148, v148, v150
    v_add_f32 v148, v148, v151
    v_add_f32 v148, v148, v152
    v_add_f32 v148, v148, v153
    v_add_f32 v148, v148, v154
    v_add_f32 v148, v148, v155
    v_add_f32 v148, v148, v160
    v_add_f32 v148, v148, v161
    v_mov_b32 v166, v144
    v_mov_b32 v167, v148
    s_nop 0
    v_permlane16_swap_b32 v144, v166
    v_permlane16_swap_b32 v148, v167
    v_add_f32 v144, v144, v166
    v_add_f32 v148, v148, v167
    v_mov_b32 v166, v144
    v_mov_b32 v167, v148
    s_nop 0
    v_permlane32_swap_b32 v144, v166
    v_permlane32_swap_b32 v148, v167
    v_add_f32 v144, v144, v166
    v_add_f32 v148, v148, v167
    v_rcp_f32 v144, v144
    v_rcp_f32 v148, v148
    v_mul_f32 v176, v176, v144
    v_mul_f32 v177, v177, v144
    v_mul_f32 v178, v178, v144
    v_mul_f32 v179, v179, v144
    v_mul_f32 v180, v180, v144
    v_mul_f32 v181, v181, v144
    v_mul_f32 v182, v182, v144
    v_mul_f32 v183, v183, v144
    v_cvt_pk_bf16_f32 v176, v176, v177
    v_cvt_pk_bf16_f32 v177, v178, v179
    v_cvt_pk_bf16_f32 v178, v180, v181
    v_cvt_pk_bf16_f32 v179, v182, v183
    global_store_dwordx4 v6, v[176:179], s[52:53] offset:0 sc1
    v_mul_f32 v184, v184, v144
    v_mul_f32 v185, v185, v144
    v_mul_f32 v186, v186, v144
    v_mul_f32 v187, v187, v144
    v_mul_f32 v188, v188, v144
    v_mul_f32 v189, v189, v144
    v_mul_f32 v190, v190, v144
    v_mul_f32 v191, v191, v144
    v_cvt_pk_bf16_f32 v184, v184, v185
    v_cvt_pk_bf16_f32 v185, v186, v187
    v_cvt_pk_bf16_f32 v186, v188, v189
    v_cvt_pk_bf16_f32 v187, v190, v191
    global_store_dwordx4 v6, v[184:187], s[52:53] offset:1024 sc1
    v_mul_f32 v192, v192, v144
    v_mul_f32 v193, v193, v144
    v_mul_f32 v194, v194, v144
    v_mul_f32 v195, v195, v144
    v_mul_f32 v196, v196, v144
    v_mul_f32 v197, v197, v144
    v_mul_f32 v198, v198, v144
    v_mul_f32 v199, v199, v144
    v_cvt_pk_bf16_f32 v192, v192, v193
    v_cvt_pk_bf16_f32 v193, v194, v195
    v_cvt_pk_bf16_f32 v194, v196, v197
    v_cvt_pk_bf16_f32 v195, v198, v199
    global_store_dwordx4 v6, v[192:195], s[52:53] offset:2048 sc1
    v_mul_f32 v200, v200, v144
    v_mul_f32 v201, v201, v144
    v_mul_f32 v202, v202, v144
    v_mul_f32 v203, v203, v144
    v_mul_f32 v204, v204, v144
    v_mul_f32 v205, v205, v144
    v_mul_f32 v206, v206, v144
    v_mul_f32 v207, v207, v144
    v_cvt_pk_bf16_f32 v200, v200, v201
    v_cvt_pk_bf16_f32 v201, v202, v203
    v_cvt_pk_bf16_f32 v202, v204, v205
    v_cvt_pk_bf16_f32 v203, v206, v207
    global_store_dwordx4 v6, v[200:203], s[52:53] offset:3072 sc1
    s_add_u32 s52, s52, 180224
    s_addc_u32 s53, s53, 0
    v_mul_f32 v208, v208, v148
    v_mul_f32 v209, v209, v148
    v_mul_f32 v210, v210, v148
    v_mul_f32 v211, v211, v148
    v_mul_f32 v212, v212, v148
    v_mul_f32 v213, v213, v148
    v_mul_f32 v214, v214, v148
    v_mul_f32 v215, v215, v148
    v_cvt_pk_bf16_f32 v208, v208, v209
    v_cvt_pk_bf16_f32 v209, v210, v211
    v_cvt_pk_bf16_f32 v210, v212, v213
    v_cvt_pk_bf16_f32 v211, v214, v215
    global_store_dwordx4 v6, v[208:211], s[52:53] offset:0 sc1
    v_mul_f32 v216, v216, v148
    v_mul_f32 v217, v217, v148
    v_mul_f32 v218, v218, v148
    v_mul_f32 v219, v219, v148
    v_mul_f32 v220, v220, v148
    v_mul_f32 v221, v221, v148
    v_mul_f32 v222, v222, v148
    v_mul_f32 v223, v223, v148
    v_cvt_pk_bf16_f32 v216, v216, v217
    v_cvt_pk_bf16_f32 v217, v218, v219
    v_cvt_pk_bf16_f32 v218, v220, v221
    v_cvt_pk_bf16_f32 v219, v222, v223
    global_store_dwordx4 v6, v[216:219], s[52:53] offset:1024 sc1
    v_mul_f32 v224, v224, v148
    v_mul_f32 v225, v225, v148
    v_mul_f32 v226, v226, v148
    v_mul_f32 v227, v227, v148
    v_mul_f32 v228, v228, v148
    v_mul_f32 v229, v229, v148
    v_mul_f32 v230, v230, v148
    v_mul_f32 v231, v231, v148
    v_cvt_pk_bf16_f32 v224, v224, v225
    v_cvt_pk_bf16_f32 v225, v226, v227
    v_cvt_pk_bf16_f32 v226, v228, v229
    v_cvt_pk_bf16_f32 v227, v230, v231
    global_store_dwordx4 v6, v[224:227], s[52:53] offset:2048 sc1
    v_mul_f32 v232, v232, v148
    v_mul_f32 v233, v233, v148
    v_mul_f32 v234, v234, v148
    v_mul_f32 v235, v235, v148
    v_mul_f32 v236, v236, v148
    v_mul_f32 v237, v237, v148
    v_mul_f32 v238, v238, v148
    v_mul_f32 v239, v239, v148
    v_cvt_pk_bf16_f32 v232, v232, v233
    v_cvt_pk_bf16_f32 v233, v234, v235
    v_cvt_pk_bf16_f32 v234, v236, v237
    v_cvt_pk_bf16_f32 v235, v238, v239
    global_store_dwordx4 v6, v[232:235], s[52:53] offset:3072 sc1
    v_mov_b32 v2, 1
    s_waitcnt vmcnt(0)
    s_mov_b64 exec, 1
    global_store_dword v1, v2, s[64:65] sc1
    s_mov_b64 exec, -1
    s_add_u32 s44, s44, 4
    s_cmp_lt_u32 s44, 56
    s_cbranch_scc1 Lt2_seg
    s_endpgm
L_t3:
    s_lshl_b32 s56, s19, 15
    v_lshrrev_b32 v7, 1, v3
    v_lshlrev_b32 v7, 10, v7
    v_and_b32 v1, 1, v3
    v_lshl_add_u32 v7, v1, 4, v7
    s_lshl_b32 s22, s18, 5
    v_add_u32 v7, s22, v7
    v_lshlrev_b32 v8, 3, v3
    v_add_u32 v8, s56, v8
    s_lshl_b32 s22, s19, 20
    s_add_u32 s58, s12, s22
    s_addc_u32 s59, s13, 0
    s_barrier
    s_add_u32 m0, s56, 0
    s_nop 0
    global_load_lds_dwordx4 v7, s[58:59]
    s_add_u32 s58, s58, 32768
    s_addc_u32 s59, s59, 0
    s_add_u32 m0, s56, 1024
    s_nop 0
    global_load_lds_dwordx4 v7, s[58:59]
    s_add_u32 s58, s58, 32768
    s_addc_u32 s59, s59, 0
    s_add_u32 m0, s56, 2048
    s_nop 0
    global_load_lds_dwordx4 v7, s[58:59]
    s_add_u32 s58, s58, 32768
    s_addc_u32 s59, s59, 0
    s_add_u32 m0, s56, 3072
    s_nop 0
    global_load_lds_dwordx4 v7, s[58:59]
    s_add_u32 s58, s58, 32768
    s_addc_u32 s59, s59, 0
    s_add_u32 m0, s56, 4096
    s_nop 0
    global_load_lds_dwordx4 v7, s[58:59]
    s_add_u32 s58, s58, 32768
    s_addc_u32 s59, s59, 0
    s_add_u32 m0, s56, 5120
    s_nop 0
    global_load_lds_dwordx4 v7, s[58:59]
    s_add_u32 s58, s58, 32768
    s_addc_u32 s59, s59, 0
    s_add_u32 m0, s56, 6144
    s_nop 0
    global_load_lds_dwordx4 v7, s[58:59]
    s_add_u32 s58, s58, 32768
    s_addc_u32 s59, s59, 0
    s_add_u32 m0, s56, 7168
    s_nop 0
    global_load_lds_dwordx4 v7, s[58:59]
    s_add_u32 s58, s58, 32768
    s_addc_u32 s59, s59, 0
    s_add_u32 m0, s56, 8192
    s_nop 0
    global_load_lds_dwordx4 v7, s[58:59]
    s_add_u32 s58, s58, 32768
    s_addc_u32 s59, s59, 0
    s_add_u32 m0, s56, 9216
    s_nop 0
    global_load_lds_dwordx4 v7, s[58:59]
    s_add_u32 s58, s58, 32768
    s_addc_u32 s59, s59, 0
    s_add_u32 m0, s56, 10240
    s_nop 0
    global_load_lds_dwordx4 v7, s[58:59]
    s_add_u32 s58, s58, 32768
    s_addc_u32 s59, s59, 0
    s_add_u32 m0, s56, 11264
    s_nop 0
    global_load_lds_dwordx4 v7, s[58:59]
    s_add_u32 s58, s58, 32768
    s_addc_u32 s59, s59, 0
    s_add_u32 m0, s56, 12288
    s_nop 0
    global_load_lds_dwordx4 v7, s[58:59]
    s_add_u32 s58, s58, 32768
    s_addc_u32 s59, s59, 0
    s_add_u32 m0, s56, 13312
    s_nop 0
    global_load_lds_dwordx4 v7, s[58:59]
    s_add_u32 s58, s58, 32768
    s_addc_u32 s59, s59, 0
    s_add_u32 m0, s56, 14336
    s_nop 0
    global_load_lds_dwordx4 v7, s[58:59]
    s_add_u32 s58, s58, 32768
    s_addc_u32 s59, s59, 0
    s_add_u32 m0, s56, 15360
    s_nop 0
    global_load_lds_dwordx4 v7, s[58:59]
    s_add_u32 s58, s58, 32768
    s_addc_u32 s59, s59, 0
    s_add_u32 m0, s56, 16384
    s_nop 0
    global_load_lds_dwordx4 v7, s[58:59]
    s_add_u32 s58, s58, 32768
    s_addc_u32 s59, s59, 0
    s_add_u32 m0, s56, 17408
    s_nop 0
    global_load_lds_dwordx4 v7, s[58:59]
    s_add_u32 s58, s58, 32768
    s_addc_u32 s59, s59, 0
    s_add_u32 m0, s56, 18432
    s_nop 0
    global_load_lds_dwordx4 v7, s[58:59]
    s_add_u32 s58, s58, 32768
    s_addc_u32 s59, s59, 0
    s_add_u32 m0, s56, 19456
    s_nop 0
    global_load_lds_dwordx4 v7, s[58:59]
    s_add_u32 s58, s58, 32768
    s_addc_u32 s59, s59, 0
    s_add_u32 m0, s56, 20480
    s_nop 0
    global_load_lds_dwordx4 v7, s[58:59]
    s_add_u32 s58, s58, 32768
    s_addc_u32 s59, s59, 0
    s_add_u32 m0, s56, 21504
    s_nop 0
    global_load_lds_dwordx4 v7, s[58:59]
    s_add_u32 s58, s58, 32768
    s_addc_u32 s59, s59, 0
    s_add_u32 m0, s56, 22528
    s_nop 0
    global_load_lds_dwordx4 v7, s[58:59]
    s_add_u32 s58, s58, 32768
    s_addc_u32 s59, s59, 0
    s_add_u32 m0, s56, 23552
    s_nop 0
    global_load_lds_dwordx4 v7, s[58:59]
    s_add_u32 s58, s58, 32768
    s_addc_u32 s59, s59, 0
    s_add_u32 m0, s56, 24576
    s_nop 0
    global_load_lds_dwordx4 v7, s[58:59]
    s_add_u32 s58, s58, 32768
    s_addc_u32 s59, s59, 0
    s_add_u32 m0, s56, 25600
    s_nop 0
    global_load_lds_dwordx4 v7, s[58:59]
    s_add_u32 s58, s58, 32768
    s_addc_u32 s59, s59, 0
    s_add_u32 m0, s56, 26624
    s_nop 0
    global_load_lds_dwordx4 v7, s[58:59]
    s_add_u32 s58, s58, 32768
    s_addc_u32 s59, s59, 0
    s_add_u32 m0, s56, 27648
    s_nop 0
    global_load_lds_dwordx4 v7, s[58:59]
    s_add_u32 s58, s58, 32768
    s_addc_u32 s59, s59, 0
    s_add_u32 m0, s56, 28672
    s_nop 0
    global_load_lds_dwordx4 v7, s[58:59]
    s_add_u32 s58, s58, 32768
    s_addc_u32 s59, s59, 0
    s_add_u32 m0, s56, 29696
    s_nop 0
    global_load_lds_dwordx4 v7, s[58:59]
    s_add_u32 s58, s58, 32768
    s_addc_u32 s59, s59, 0
    s_add_u32 m0, s56, 30720
    s_nop 0
    global_load_lds_dwordx4 v7, s[58:59]
    s_add_u32 s58, s58, 32768
    s_addc_u32 s59, s59, 0
    s_add_u32 m0, s56, 31744
    s_nop 0
    global_load_lds_dwordx4 v7, s[58:59]
    s_add_u32 s58, s58, 32768
    s_addc_u32 s59, s59, 0
    v_lshlrev_b32 v1, 4, v5
    s_lshl_b32 s22, s19, 8
    v_add_u32 v1, s22, v1
    v_lshl_add_u32 v9, v4, 10, v1
    global_load_dwordx4 v[32:35], v1, s[38:39] offset:0
    global_load_dwordx4 v[36:39], v1, s[38:39] offset:64
    global_load_dwordx4 v[40:43], v1, s[38:39] offset:128
    global_load_dwordx4 v[44:47], v1, s[38:39] offset:192
    s_waitcnt vmcnt(0)
    ds_read_b64_tr_b16 a[0:1], v8 offset:0
    ds_read_b64_tr_b16 a[2:3], v8 offset:512
    ds_read_b64_tr_b16 a[4:5], v8 offset:1024
    ds_read_b64_tr_b16 a[6:7], v8 offset:1536
    ds_read_b64_tr_b16 a[8:9], v8 offset:2048
    ds_read_b64_tr_b16 a[10:11], v8 offset:2560
    ds_read_b64_tr_b16 a[12:13], v8 offset:3072
    ds_read_b64_tr_b16 a[14:15], v8 offset:3584
    ds_read_b64_tr_b16 a[16:17], v8 offset:4096
    ds_read_b64_tr_b16 a[18:19], v8 offset:4608
    ds_read_b64_tr_b16 a[20:21], v8 offset:5120
    ds_read_b64_tr_b16 a[22:23], v8 offset:5632
    ds_read_b64_tr_b16 a[24:25], v8 offset:6144
    ds_read_b64_tr_b16 a[26:27], v8 offset:6656
    ds_read_b64_tr_b16 a[28:29], v8 offset:7168
    ds_read_b64_tr_b16 a[30:31], v8 offset:7680
    ds_read_b64_tr_b16 a[32:33], v8 offset:8192
    ds_read_b64_tr_b16 a[34:35], v8 offset:8704
    ds_read_b64_tr_b16 a[36:37], v8 offset:9216
    ds_read_b64_tr_b16 a[38:39], v8 offset:9728
    ds_read_b64_tr_b16 a[40:41], v8 offset:10240
    ds_read_b64_tr_b16 a[42:43], v8 offset:10752
    ds_read_b64_tr_b16 a[44:45], v8 offset:11264
    ds_read_b64_tr_b16 a[46:47], v8 offset:11776
    ds_read_b64_tr_b16 a[48:49], v8 offset:12288
    ds_read_b64_tr_b16 a[50:51], v8 offset:12800
    ds_read_b64_tr_b16 a[52:53], v8 offset:13312
    ds_read_b64_tr_b16 a[54:55], v8 offset:13824
    ds_read_b64_tr_b16 a[56:57], v8 offset:14336
    ds_read_b64_tr_b16 a[58:59], v8 offset:14848
    ds_read_b64_tr_b16 a[60:61], v8 offset:15360
    ds_read_b64_tr_b16 a[62:63], v8 offset:15872
    ds_read_b64_tr_b16 a[64:65], v8 offset:16384
    ds_read_b64_tr_b16 a[66:67], v8 offset:16896
    ds_read_b64_tr_b16 a[68:69], v8 offset:17408
    ds_read_b64_tr_b16 a[70:71], v8 offset:17920
    ds_read_b64_tr_b16 a[72:73], v8 offset:18432
    ds_read_b64_tr_b16 a[74:75], v8 offset:18944
    ds_read_b64_tr_b16 a[76:77], v8 offset:19456
    ds_read_b64_tr_b16 a[78:79], v8 offset:19968
    ds_read_b64_tr_b16 a[80:81], v8 offset:20480
    ds_read_b64_tr_b16 a[82:83], v8 offset:20992
    ds_read_b64_tr_b16 a[84:85], v8 offset:21504
    ds_read_b64_tr_b16 a[86:87], v8 offset:22016
    ds_read_b64_tr_b16 a[88:89], v8 offset:22528
    ds_read_b64_tr_b16 a[90:91], v8 offset:23040
    ds_read_b64_tr_b16 a[92:93], v8 offset:23552
    ds_read_b64_tr_b16 a[94:95], v8 offset:24064
    ds_read_b64_tr_b16 a[96:97], v8 offset:24576
    ds_read_b64_tr_b16 a[98:99], v8 offset:25088
    ds_read_b64_tr_b16 a[100:101], v8 offset:25600
    ds_read_b64_tr_b16 a[102:103], v8 offset:26112
    ds_read_b64_tr_b16 a[104:105], v8 offset:26624
    ds_read_b64_tr_b16 a[106:107], v8 offset:27136
    ds_read_b64_tr_b16 a[108:109], v8 offset:27648
    ds_read_b64_tr_b16 a[110:111], v8 offset:28160
    ds_read_b64_tr_b16 a[112:113], v8 offset:28672
    ds_read_b64_tr_b16 a[114:115], v8 offset:29184
    ds_read_b64_tr_b16 a[116:117], v8 offset:29696
    ds_read_b64_tr_b16 a[118:119], v8 offset:30208
    ds_read_b64_tr_b16 a[120:121], v8 offset:30720
    ds_read_b64_tr_b16 a[122:123], v8 offset:31232
    ds_read_b64_tr_b16 a[124:125], v8 offset:31744
    ds_read_b64_tr_b16 a[126:127], v8 offset:32256
    s_mul_i32 s60, s19, 11
    s_cmp_eq_u32 s19, 3
    s_subb_u32 s60, s60, 0
    s_lshl_b32 s22, s60, 15
    s_add_u32 s58, s36, s22
    s_addc_u32 s59, s37, 0
    s_waitcnt lgkmcnt(0)
    s_add_u32 m0, s56, 0
    s_nop 0
    global_load_lds_dwordx4 v7, s[58:59]
    s_add_u32 s58, s58, 32768
    s_addc_u32 s59, s59, 0
    s_add_u32 m0, s56, 1024
    s_nop 0
    global_load_lds_dwordx4 v7, s[58:59]
    s_add_u32 s58, s58, 32768
    s_addc_u32 s59, s59, 0
    s_add_u32 m0, s56, 2048
    s_nop 0
    global_load_lds_dwordx4 v7, s[58:59]
    s_add_u32 s58, s58, 32768
    s_addc_u32 s59, s59, 0
    s_add_u32 m0, s56, 3072
    s_nop 0
    global_load_lds_dwordx4 v7, s[58:59]
    s_add_u32 s58, s58, 32768
    s_addc_u32 s59, s59, 0
    s_add_u32 m0, s56, 4096
    s_nop 0
    global_load_lds_dwordx4 v7, s[58:59]
    s_add_u32 s58, s58, 32768
    s_addc_u32 s59, s59, 0
    s_add_u32 m0, s56, 5120
    s_nop 0
    global_load_lds_dwordx4 v7, s[58:59]
    s_add_u32 s58, s58, 32768
    s_addc_u32 s59, s59, 0
    s_add_u32 m0, s56, 6144
    s_nop 0
    global_load_lds_dwordx4 v7, s[58:59]
    s_add_u32 s58, s58, 32768
    s_addc_u32 s59, s59, 0
    s_add_u32 m0, s56, 7168
    s_nop 0
    global_load_lds_dwordx4 v7, s[58:59]
    s_add_u32 s58, s58, 32768
    s_addc_u32 s59, s59, 0
    s_add_u32 m0, s56, 8192
    s_nop 0
    global_load_lds_dwordx4 v7, s[58:59]
    s_add_u32 s58, s58, 32768
    s_addc_u32 s59, s59, 0
    s_add_u32 m0, s56, 9216
    s_nop 0
    global_load_lds_dwordx4 v7, s[58:59]
    s_add_u32 s58, s58, 32768
    s_addc_u32 s59, s59, 0
    s_add_u32 m0, s56, 10240
    s_nop 0
    global_load_lds_dwordx4 v7, s[58:59]
    s_waitcnt vmcnt(0)
    ds_read_b64_tr_b16 a[128:129], v8 offset:0
    ds_read_b64_tr_b16 a[130:131], v8 offset:512
    ds_read_b64_tr_b16 a[132:133], v8 offset:1024
    ds_read_b64_tr_b16 a[134:135], v8 offset:1536
    ds_read_b64_tr_b16 a[136:137], v8 offset:2048
    ds_read_b64_tr_b16 a[138:139], v8 offset:2560
    ds_read_b64_tr_b16 a[140:141], v8 offset:3072
    ds_read_b64_tr_b16 a[142:143], v8 offset:3584
    ds_read_b64_tr_b16 a[144:145], v8 offset:4096
    ds_read_b64_tr_b16 a[146:147], v8 offset:4608
    ds_read_b64_tr_b16 a[148:149], v8 offset:5120
    ds_read_b64_tr_b16 a[150:151], v8 offset:5632
    ds_read_b64_tr_b16 a[152:153], v8 offset:6144
    ds_read_b64_tr_b16 a[154:155], v8 offset:6656
    ds_read_b64_tr_b16 a[156:157], v8 offset:7168
    ds_read_b64_tr_b16 a[158:159], v8 offset:7680
    ds_read_b64_tr_b16 a[160:161], v8 offset:8192
    ds_read_b64_tr_b16 a[162:163], v8 offset:8704
    ds_read_b64_tr_b16 a[164:165], v8 offset:9216
    ds_read_b64_tr_b16 a[166:167], v8 offset:9728
    ds_read_b64_tr_b16 a[168:169], v8 offset:10240
    ds_read_b64_tr_b16 a[170:171], v8 offset:10752
    s_waitcnt lgkmcnt(0)
    s_cmp_lg_u32 s19, 3
    s_cbranch_scc1 Lt3_nz
    v_accvgpr_write_b32 a128, 0
    v_accvgpr_write_b32 a129, 0
    v_accvgpr_write_b32 a130, 0
    v_accvgpr_write_b32 a131, 0
Lt3_nz:
    s_add_u32 s44, s20, 1
    s_cmp_ge_u32 s44, 6
    s_cselect_b32 s22, 6, 0
    s_sub_u32 s44, s44, s22
    v_and_b32 v10, 7, v3
    v_lshlrev_b32 v10, 2, v10
    s_lshl_b32 s22, s19, 5
    v_add_u32 v10, s22, v10
    s_mul_i32 s22, s19, 3072
    s_add_u32 s22, s22, 131072
    v_add_u32 v11, s22, v6
    v_lshlrev_b32 v12, 10, v4
    v_lshl_add_u32 v12, v5, 3, v12
    s_lshl_b32 s22, s18, 5
    v_add_u32 v12, s22, v12
    s_mul_i32 s22, s20, 1572864
    s_add_u32 s22, s22, 100663296
    s_add_u32 s62, s16, s22
    s_addc_u32 s63, s17, 0
    s_lshr_b32 s22, s18, 3
    s_lshl_b32 s22, s22, 17
    s_lshl_b32 s23, s19, 15
    s_add_u32 s22, s22, s23
    s_and_b32 s23, s18, 7
    s_lshl_b32 s23, s23, 7
    s_add_u32 s22, s22, s23
    v_lshrrev_b32 v1, 3, v3
    v_lshl_add_u32 v1, v1, 10, s22
    v_and_b32 v2, 7, v3
    v_lshl_add_u32 v116, v2, 4, v1
    v_add_u32 v117, 8192, v116
    v_add_u32 v118, 16384, v116
    v_add_u32 v119, 24576, v116
    s_lshl_b32 s22, s18, 5
    v_subrev_u32 v7, s22, v7
    s_mov_b32 s69, 0
    s_mov_b32 s26, 0
    s_lshl_b32 s22, s18, 17
    s_lshl_b32 s23, s19, 8
    s_add_u32 s22, s22, s23
    s_add_u32 s58, s12, s22
    s_addc_u32 s59, s13, 0
    s_lshl_b32 s22, s19, 11
    v_add_u32 v108, s22, v6
    v_xor_b32 v109, 2048, v108
    v_xor_b32 v110, 4096, v108
    v_xor_b32 v111, 6144, v108
    v_mov_b32 v127, 0xff800000
    v_lshl_add_u32 v1, v4, 1, v5
    v_and_b32 v1, 15, v1
    s_lshl_b32 s22, s18, 5
    s_lshl_b32 s23, s19, 3
    s_add_u32 s22, s22, s23
    v_lshl_add_u32 v14, v1, 10, s22
    s_lshl_b32 s22, s19, 8
    s_add_u32 s22, s22, 131072
    v_lshl_add_u32 v13, v1, 4, s22
    v_and_b32 v1, 1, v4
    v_lshlrev_b32 v1, 4, v1
    v_mov_b32 v2, 0x3f80
    v_lshlrev_b32 v1, v1, v2
    v_lshrrev_b32 v2, 1, v4
    v_cmp_eq_u32 vcc, 0, v2
    s_nop 1
    v_cndmask_b32 v28, 0, v1, vcc
    v_cmp_eq_u32 vcc, 1, v2
    s_nop 1
    v_cndmask_b32 v29, 0, v1, vcc
    v_cmp_eq_u32 vcc, 2, v2
    s_nop 1
    v_cndmask_b32 v30, 0, v1, vcc
    v_cmp_eq_u32 vcc, 3, v2
    s_nop 1
    v_cndmask_b32 v31, 0, v1, vcc
    v_add_u32 v1, 66076672, v6
    s_cmp_lg_u32 s19, 0
    s_cbranch_scc1 Lt3_w_b
    s_lshl_b32 s22, s18, 8
    s_add_u32 s22, s22, 66068480
    v_lshl_add_u32 v73, v3, 2, s22
    v_and_b32 v74, 1, v3
    v_mul_u32_u24 v74, 0x0101, v74
    v_lshlrev_b32 v74, 16, v74
    s_mov_b32 s21, 0
Lt3_w_p:
    global_load_dwordx4 v[64:67], v1, s[16:17] sc1
    global_load_dwordx4 v[68:71], v1, s[16:17] offset:352 sc1
    global_load_dword v72, v73, s[16:17] sc1
    s_add_u32 s21, s21, 1
    s_cmp_gt_u32 s21, 60000
    s_cbranch_scc1 Lt3_w_b
    s_waitcnt vmcnt(0)
    v_or_b32 v72, v72, v74
    v_and_b32 v64, v64, v65
    v_and_b32 v64, v64, v66
    v_and_b32 v64, v64, v67
    v_and_b32 v64, v64, v68
    v_and_b32 v64, v64, v69
    v_and_b32 v64, v64, v70
    v_and_b32 v64, v64, v71
    v_and_b32 v64, v64, v72
    v_cmp_ne_u32 vcc, 0x01010101, v64
    s_cbranch_vccz Lt3_w_b
    s_sleep 64
    s_branch Lt3_w_p
Lt3_w_b:
    s_waitcnt vmcnt(0)
    s_barrier
Lt3_tile:
    s_cmp_lt_u32 s44, 88
    s_cbranch_scc1 Lt3_np
    s_cmp_ge_u32 s26, 3
    s_cbranch_scc1 Lt3_np
    s_add_u32 s27, s44, 24
    s_cmp_ge_u32 s27, 128
    s_cbranch_scc1 Lt3_pb
    s_lshl_b32 s22, s26, 19
    s_add_u32 s52, s62, s22
    s_addc_u32 s53, s63, 0
    v_mov_b64 v[240:241], -1
    v_mov_b64 v[242:243], -1
    global_store_dwordx4 v116, v[240:243], s[52:53] sc1
    global_store_dwordx4 v117, v[240:243], s[52:53] sc1
    global_store_dwordx4 v118, v[240:243], s[52:53] sc1
    global_store_dwordx4 v119, v[240:243], s[52:53] sc1
    s_mul_i32 s22, s27, 180224
    s_lshl_b32 s23, s60, 10
    s_add_u32 s23, s23, s22
    s_add_u32 s23, s23, 134352896
    s_add_u32 s48, s16, s23
    s_addc_u32 s49, s17, 0
    s_lshl_b32 s22, s27, 14
    s_add_u32 s50, s30, s22
    s_addc_u32 s51, s31, 0
    global_load_dwordx4 v[48:51], v9, s[50:51] offset:0
    global_load_dwordx4 v[52:55], v9, s[50:51] offset:64
    global_load_dwordx4 v[56:59], v9, s[50:51] offset:128
    global_load_dwordx4 v[60:63], v9, s[50:51] offset:192
    global_load_dwordx4 v[64:67], v6, s[48:49] offset:-4096 sc1
    global_load_dwordx4 v[68:71], v6, s[48:49] offset:-3072 sc1
    global_load_dwordx4 v[72:75], v6, s[48:49] offset:-2048 sc1
    global_load_dwordx4 v[76:79], v6, s[48:49] offset:-1024 sc1
    global_load_dwordx4 v[80:83], v6, s[48:49] offset:0 sc1
    global_load_dwordx4 v[84:87], v6, s[48:49] offset:1024 sc1
    global_load_dwordx4 v[88:91], v6, s[48:49] offset:2048 sc1
    global_load_dwordx4 v[92:95], v6, s[48:49] offset:3072 sc1
    s_add_u32 s48, s48, 8192
    s_addc_u32 s49, s49, 0
    global_load_dwordx4 v[96:99], v6, s[48:49] offset:-4096 sc1
    global_load_dwordx4 v[100:103], v6, s[48:49] offset:-3072 sc1
    global_load_dwordx4 v[104:107], v6, s[48:49] offset:-2048 sc1
    s_lshr_b32 s22, s27, 1
    s_lshl_b32 s22, s22, 5
    s_add_u32 s22, s22, s18
    s_lshl_b32 s23, s22, 13
    s_add_u32 s64, s16, s23
    s_addc_u32 s65, s17, 0
    s_and_b32 s24, s27, 1
    s_lshl_b32 s23, s24, 10
    s_add_u32 s23, s23, 67108864
    s_add_u32 s46, s64, s23
    s_addc_u32 s47, s65, 0
    s_add_u32 s66, s64, 16777216
    s_addc_u32 s67, s65, 0
    s_lshl_b32 s24, s24, 4
    v_lshlrev_b32 v1, 2, v5
    v_sub_u32 v15, v4, v1
    v_add_u32 v15, s24, v15
    v_and_b32 v1, 0x4000, v11
    v_or_b32 v1, v13, v1
    global_load_dwordx4 v[128:131], v108, s[46:47] sc1
    global_load_dwordx4 v[144:147], v108, s[64:65] offset:0 sc1
    global_load_dwordx4 v[148:151], v108, s[64:65] offset:1024 sc1
    global_load_dwordx4 v[132:135], v109, s[46:47] sc1
    global_load_dwordx4 v[152:155], v109, s[64:65] offset:0 sc1
    global_load_dwordx4 v[156:159], v109, s[64:65] offset:1024 sc1
    global_load_dwordx4 v[136:139], v110, s[46:47] sc1
    global_load_dwordx4 v[160:163], v110, s[64:65] offset:0 sc1
    global_load_dwordx4 v[164:167], v110, s[64:65] offset:1024 sc1
    global_load_dwordx4 v[140:143], v111, s[46:47] sc1
    global_load_dwordx4 v[168:171], v111, s[64:65] offset:0 sc1
    global_load_dwordx4 v[172:175], v111, s[64:65] offset:1024 sc1
    global_load_dwordx4 v[176:179], v108, s[66:67] offset:0 sc1
    global_load_dwordx4 v[180:183], v108, s[66:67] offset:1024 sc1
    s_waitcnt vmcnt(14)
    global_load_dwordx4 v[200:203], v116, s[52:53] sc1
    global_load_dwordx4 v[204:207], v117, s[52:53] sc1
    global_load_dwordx4 v[208:211], v118, s[52:53] sc1
    global_load_dwordx4 v[212:215], v119, s[52:53] sc1
    v_mfma_f32_16x16x32_bf16 v[24:27], v[32:35], v[48:51], 0
    v_mfma_f32_16x16x32_bf16 v[24:27], v[36:39], v[52:55], v[24:27]
    v_mfma_f32_16x16x32_bf16 v[24:27], v[40:43], v[56:59], v[24:27]
    v_mfma_f32_16x16x32_bf16 v[24:27], v[44:47], v[60:63], v[24:27]
    v_mfma_f32_16x16x32_bf16 v[20:23], a[128:131], v[64:67], 0
    v_mfma_f32_16x16x32_bf16 v[20:23], a[132:135], v[68:71], v[20:23]
    v_mfma_f32_16x16x32_bf16 v[20:23], a[136:139], v[72:75], v[20:23]
    v_mfma_f32_16x16x32_bf16 v[20:23], a[140:143], v[76:79], v[20:23]
    v_mfma_f32_16x16x32_bf16 v[20:23], a[144:147], v[80:83], v[20:23]
    v_mfma_f32_16x16x32_bf16 v[20:23], a[148:151], v[84:87], v[20:23]
    v_mfma_f32_16x16x32_bf16 v[20:23], a[152:155], v[88:91], v[20:23]
    v_mfma_f32_16x16x32_bf16 v[20:23], a[156:159], v[92:95], v[20:23]
    v_mfma_f32_16x16x32_bf16 v[20:23], a[160:163], v[96:99], v[20:23]
    v_mfma_f32_16x16x32_bf16 v[20:23], a[164:167], v[100:103], v[20:23]
    v_mfma_f32_16x16x32_bf16 v[20:23], a[168:171], v[104:107], v[20:23]
    ds_write_b32 v11, v24 offset:2048
    s_nop 6
    ds_write_b128 v11, v[20:23] offset:1024
    s_waitcnt vmcnt(6)
    v_mfma_f32_16x16x32_bf16 v[216:219], v[144:147], v[128:131], 0
    v_mfma_f32_16x16x32_bf16 v[220:223], v[148:151], v[128:131], 0
    v_mfma_f32_16x16x32_bf16 v[216:219], v[152:155], v[132:135], v[216:219]
    v_mfma_f32_16x16x32_bf16 v[220:223], v[156:159], v[132:135], v[220:223]
    v_mfma_f32_16x16x32_bf16 v[216:219], v[160:163], v[136:139], v[216:219]
    v_mfma_f32_16x16x32_bf16 v[220:223], v[164:167], v[136:139], v[220:223]
    v_mfma_f32_16x16x32_bf16 v[216:219], v[168:171], v[140:143], v[216:219]
    v_mfma_f32_16x16x32_bf16 v[220:223], v[172:175], v[140:143], v[220:223]
    s_waitcnt lgkmcnt(0)
    s_barrier
    ds_read_b128 v[64:67], v1 offset:1024
    ds_read_b32 v80, v1 offset:2048
    ds_read_b128 v[68:71], v1 offset:4096
    ds_read_b32 v81, v1 offset:5120
    ds_read_b128 v[72:75], v1 offset:7168
    ds_read_b32 v82, v1 offset:8192
    ds_read_b128 v[76:79], v1 offset:10240
    ds_read_b32 v83, v1 offset:11264
    v_cmp_le_i32 vcc, 0, v15
    s_nop 1
    v_cndmask_b32 v216, v127, v216, vcc
    v_cmp_le_i32 vcc, 1, v15
    s_nop 1
    v_cndmask_b32 v217, v127, v217, vcc
    v_cmp_le_i32 vcc, 2, v15
    s_nop 1
    v_cndmask_b32 v218, v127, v218, vcc
    v_cmp_le_i32 vcc, 3, v15
    s_nop 1
    v_cndmask_b32 v219, v127, v219, vcc
    v_cmp_le_i32 vcc, 16, v15
    s_nop 1
    v_cndmask_b32 v220, v127, v220, vcc
    v_cmp_le_i32 vcc, 17, v15
    s_nop 1
    v_cndmask_b32 v221, v127, v221, vcc
    v_cmp_le_i32 vcc, 18, v15
    s_nop 1
    v_cndmask_b32 v222, v127, v222, vcc
    v_cmp_le_i32 vcc, 19, v15
    s_nop 1
    v_cndmask_b32 v223, v127, v223, vcc
    v_max3_f32 v228, v216, v217, v218
    v_max3_f32 v228, v228, v219, v220
    v_max3_f32 v228, v228, v221, v222
    v_max_f32 v228, v228, v223
    v_mov_b32 v230, v228
    s_nop 1
    v_permlane16_swap_b32 v228, v230
    v_max_f32 v228, v228, v230
    v_mov_b32 v230, v228
    s_nop 1
    v_permlane32_swap_b32 v228, v230
    v_max_f32 v228, v228, v230
    v_sub_f32 v216, v216, v228
    v_sub_f32 v217, v217, v228
    v_sub_f32 v218, v218, v228
    v_sub_f32 v219, v219, v228
    v_sub_f32 v220, v220, v228
    v_sub_f32 v221, v221, v228
    v_sub_f32 v222, v222, v228
    v_sub_f32 v223, v223, v228
    v_exp_f32 v216, v216
    v_exp_f32 v217, v217
    v_exp_f32 v218, v218
    v_exp_f32 v219, v219
    v_exp_f32 v220, v220
    v_exp_f32 v221, v221
    v_exp_f32 v222, v222
    v_exp_f32 v223, v223
    v_cvt_pk_bf16_f32 v240, v216, v217
    v_cvt_pk_bf16_f32 v241, v218, v219
    v_cvt_pk_bf16_f32 v242, v220, v221
    v_cvt_pk_bf16_f32 v243, v222, v223
    s_waitcnt vmcnt(4)
    s_nop 0
    v_mfma_f32_16x16x32_bf16 v[232:235], v[176:179], v[240:243], 0
    v_mfma_f32_16x16x32_bf16 v[236:239], v[180:183], v[240:243], 0
    v_add_f32 v231, v216, v217
    v_add_f32 v231, v231, v218
    v_add_f32 v231, v231, v219
    v_add_f32 v231, v231, v220
    v_add_f32 v231, v231, v221
    v_add_f32 v231, v231, v222
    v_add_f32 v231, v231, v223
    v_mov_b32 v230, v231
    s_nop 1
    v_permlane16_swap_b32 v231, v230
    v_add_f32 v231, v231, v230
    v_mov_b32 v230, v231
    s_nop 1
    v_permlane32_swap_b32 v231, v230
    v_add_f32 v231, v231, v230
    s_waitcnt lgkmcnt(0)
    v_add_f32 v16, v64, v68
    v_add_f32 v72, v72, v76
    v_add_f32 v16, v16, v72
    v_add_f32 v17, v65, v69
    v_add_f32 v73, v73, v77
    v_add_f32 v17, v17, v73
    v_add_f32 v18, v66, v70
    v_add_f32 v74, v74, v78
    v_add_f32 v18, v18, v74
    v_add_f32 v19, v67, v71
    v_add_f32 v75, v75, v79
    v_add_f32 v19, v19, v75
    v_add_f32 v20, v80, v81
    v_add_f32 v21, v82, v83
    v_add_f32 v20, v20, v21
    v_mul_f32 v20, 3216550459, v20
    v_exp_f32 v20, v20
    s_nop 0
    v_add_f32 v20, 1.0, v20
    v_rcp_f32 v20, v20
    s_nop 0
    v_sub_f32 v21, 1.0, v20
    v_mul_f32 v16, v16, v21
    v_mul_f32 v17, v17, v21
    v_mul_f32 v18, v18, v21
    v_mul_f32 v19, v19, v21
    v_xor_b32 v11, 0x4000, v11
    s_cmp_lg_u32 s26, 0
    s_cbranch_scc1 Lt3_pk1
    v_accvgpr_write_b32 a172, v128
    v_accvgpr_write_b32 a173, v129
    v_accvgpr_write_b32 a174, v130
    v_accvgpr_write_b32 a175, v131
    v_accvgpr_write_b32 a176, v132
    v_accvgpr_write_b32 a177, v133
    v_accvgpr_write_b32 a178, v134
    v_accvgpr_write_b32 a179, v135
    v_accvgpr_write_b32 a180, v136
    v_accvgpr_write_b32 a181, v137
    v_accvgpr_write_b32 a182, v138
    v_accvgpr_write_b32 a183, v139
    v_accvgpr_write_b32 a184, v140
    v_accvgpr_write_b32 a185, v141
    v_accvgpr_write_b32 a186, v142
    v_accvgpr_write_b32 a187, v143
    v_accvgpr_write_b32 a188, v232
    v_accvgpr_write_b32 a189, v233
    v_accvgpr_write_b32 a190, v234
    v_accvgpr_write_b32 a191, v235
    v_accvgpr_write_b32 a192, v236
    v_accvgpr_write_b32 a193, v237
    v_accvgpr_write_b32 a194, v238
    v_accvgpr_write_b32 a195, v239
    v_accvgpr_write_b32 a196, v228
    v_accvgpr_write_b32 a197, v231
    v_accvgpr_write_b32 a198, v20
    v_accvgpr_write_b32 a199, v16
    v_accvgpr_write_b32 a200, v17
    v_accvgpr_write_b32 a201, v18
    v_accvgpr_write_b32 a202, v19
    s_branch Lt3_pe
Lt3_pk1:
    s_cmp_lg_u32 s26, 1
    s_cbranch_scc1 Lt3_pk2
    v_accvgpr_write_b32 a203, v128
    v_accvgpr_write_b32 a204, v129
    v_accvgpr_write_b32 a205, v130
    v_accvgpr_write_b32 a206, v131
    v_accvgpr_write_b32 a207, v132
    v_accvgpr_write_b32 a208, v133
    v_accvgpr_write_b32 a209, v134
    v_accvgpr_write_b32 a210, v135
    v_accvgpr_write_b32 a211, v136
    v_accvgpr_write_b32 a212, v137
    v_accvgpr_write_b32 a213, v138
    v_accvgpr_write_b32 a214, v139
    v_accvgpr_write_b32 a215, v140
    v_accvgpr_write_b32 a216, v141
    v_accvgpr_write_b32 a217, v142
    v_accvgpr_write_b32 a218, v143
    v_accvgpr_write_b32 a219, v232
    v_accvgpr_write_b32 a220, v233
    v_accvgpr_write_b32 a221, v234
    v_accvgpr_write_b32 a222, v235
    v_accvgpr_write_b32 a223, v236
    v_accvgpr_write_b32 a224, v237
    v_accvgpr_write_b32 a225, v238
    v_accvgpr_write_b32 a226, v239
    v_accvgpr_write_b32 a227, v228
    v_accvgpr_write_b32 a228, v231
    v_accvgpr_write_b32 a229, v20
    v_accvgpr_write_b32 a230, v16
    v_accvgpr_write_b32 a231, v17
    v_accvgpr_write_b32 a232, v18
    v_accvgpr_write_b32 a233, v19
    s_branch Lt3_pe
Lt3_pk2:
    v_accvgpr_write_b32 a234, v128
    v_accvgpr_write_b32 a235, v129
    v_accvgpr_write_b32 a236, v130
    v_accvgpr_write_b32 a237, v131
    v_accvgpr_write_b32 a238, v132
    v_accvgpr_write_b32 a239, v133
    v_accvgpr_write_b32 a240, v134
    v_accvgpr_write_b32 a241, v135
    v_accvgpr_write_b32 a242, v136
    v_accvgpr_write_b32 a243, v137
    v_accvgpr_write_b32 a244, v138
    v_accvgpr_write_b32 a245, v139
    v_accvgpr_write_b32 a246, v140
    v_accvgpr_write_b32 a247, v141
    v_accvgpr_write_b32 a248, v142
    v_accvgpr_write_b32 a249, v143
    v_accvgpr_write_b32 a250, v232
    v_accvgpr_write_b32 a251, v233
    v_accvgpr_write_b32 a252, v234
    v_accvgpr_write_b32 a253, v235
    v_accvgpr_write_b32 a254, v236
    v_accvgpr_write_b32 a255, v237
    v_mov_b32 v112, v238
    v_mov_b32 v113, v239
    v_mov_b32 v114, v228
    v_mov_b32 v115, v231
    v_mov_b32 v120, v20
    v_mov_b32 v121, v16
    v_mov_b32 v122, v17
    v_mov_b32 v123, v18
    v_mov_b32 v124, v19
Lt3_pb:
    s_lshl_b32 s22, s20, 6
    s_add_u32 s22, s22, s18
    s_add_u32 s22, s22, 66084864
    v_mov_b32 v1, s22
    s_lshl_b32 s22, s3, 1
    s_add_u32 s22, s22, 1
    v_mov_b32 v2, s22
    s_cmp_eq_u32 s19, 0
    s_cselect_b64 exec, 1, 0
    global_store_byte v1, v2, s[16:17] sc1
    s_mov_b64 exec, -1
Lt3_pe:
    s_add_u32 s26, s26, 1
Lt3_np:
    s_mul_i32 s22, s44, 180224
    s_lshl_b32 s23, s60, 10
    s_add_u32 s23, s23, s22
    s_add_u32 s23, s23, 134352896
    s_add_u32 s48, s16, s23
    s_addc_u32 s49, s17, 0
    s_lshl_b32 s22, s44, 14
    s_add_u32 s50, s30, s22
    s_addc_u32 s51, s31, 0
    global_load_dwordx4 v[48:51], v9, s[50:51] offset:0
    global_load_dwordx4 v[52:55], v9, s[50:51] offset:64
    global_load_dwordx4 v[56:59], v9, s[50:51] offset:128
    global_load_dwordx4 v[60:63], v9, s[50:51] offset:192
    global_load_dwordx4 v[64:67], v6, s[48:49] offset:-4096 sc1
    global_load_dwordx4 v[68:71], v6, s[48:49] offset:-3072 sc1
    global_load_dwordx4 v[72:75], v6, s[48:49] offset:-2048 sc1
    global_load_dwordx4 v[76:79], v6, s[48:49] offset:-1024 sc1
    global_load_dwordx4 v[80:83], v6, s[48:49] offset:0 sc1
    global_load_dwordx4 v[84:87], v6, s[48:49] offset:1024 sc1
    global_load_dwordx4 v[88:91], v6, s[48:49] offset:2048 sc1
    global_load_dwordx4 v[92:95], v6, s[48:49] offset:3072 sc1
    s_add_u32 s48, s48, 8192
    s_addc_u32 s49, s49, 0
    global_load_dwordx4 v[96:99], v6, s[48:49] offset:-4096 sc1
    global_load_dwordx4 v[100:103], v6, s[48:49] offset:-3072 sc1
    global_load_dwordx4 v[104:107], v6, s[48:49] offset:-2048 sc1
    s_lshr_b32 s22, s44, 1
    s_lshl_b32 s22, s22, 7
    s_add_u32 s22, s22, 66060288
    s_add_u32 s52, s16, s22
    s_addc_u32 s53, s17, 0
    global_load_dword v2, v10, s[52:53] sc1
    s_cmp_ge_u32 s69, 32
    s_cbranch_scc1 Lt3_nd
    s_lshl_b32 s23, s69, 10
    s_add_u32 m0, s56, s23
    s_and_b32 s23, s69, 2
    s_xor_b32 s23, s23, s19
    s_lshl_b32 s23, s23, 15
    s_lshr_b32 s22, s69, 2
    s_lshl_b32 s22, s22, 5
    s_add_u32 s22, s22, s23
    v_add_u32 v1, s22, v7
    global_load_lds_dwordx4 v1, s[58:59]
    s_add_u32 m0, m0, 1024
    v_xor_b32 v1, 0x8000, v1
    global_load_lds_dwordx4 v1, s[58:59]
    s_add_u32 s69, s69, 2
Lt3_nd:
    s_mul_i32 s22, s44, 180224
    s_add_u32 s22, s22, 134221824
    s_lshl_b32 s23, s19, 15
    s_add_u32 s23, s23, s22
    s_add_u32 s46, s16, s23
    s_addc_u32 s47, s17, 0
    s_lshl_b32 s22, s44, 14
    s_add_u32 s54, s40, s22
    s_addc_u32 s55, s41, 0
    s_mov_b32 s21, 0
Lt3_p:
    s_waitcnt vmcnt(0)
    v_cmp_ne_u32 vcc, 1, v2
    s_cbranch_vccz Lt3_go
    s_add_u32 s21, s21, 1
    s_cmp_gt_u32 s21, 60000
    s_cbranch_scc1 Lt3_go
    s_sleep 4
    global_load_dword v2, v10, s[52:53] sc1
    s_branch Lt3_p
Lt3_go:
    global_load_dwordx4 v[128:131], v6, s[46:47] offset:-4096 sc1
    global_load_dwordx4 v[132:135], v6, s[46:47] offset:-3072 sc1
    global_load_dwordx4 v[136:139], v6, s[46:47] offset:-2048 sc1
    global_load_dwordx4 v[140:143], v6, s[46:47] offset:-1024 sc1
    global_load_dwordx4 v[144:147], v6, s[46:47] offset:0 sc1
    global_load_dwordx4 v[148:151], v6, s[46:47] offset:1024 sc1
    global_load_dwordx4 v[152:155], v6, s[46:47] offset:2048 sc1
    global_load_dwordx4 v[156:159], v6, s[46:47] offset:3072 sc1
    s_add_u32 s46, s46, 8192
    s_addc_u32 s47, s47, 0
    global_load_dwordx4 v[160:163], v6, s[46:47] offset:-4096 sc1
    global_load_dwordx4 v[164:167], v6, s[46:47] offset:-3072 sc1
    global_load_dwordx4 v[168:171], v6, s[46:47] offset:-2048 sc1
    global_load_dwordx4 v[172:175], v6, s[46:47] offset:-1024 sc1
    global_load_dwordx4 v[176:179], v6, s[46:47] offset:0 sc1
    global_load_dwordx4 v[180:183], v6, s[46:47] offset:1024 sc1
    global_load_dwordx4 v[184:187], v6, s[46:47] offset:2048 sc1
    global_load_dwordx4 v[188:191], v6, s[46:47] offset:3072 sc1
    s_add_u32 s46, s46, 8192
    s_addc_u32 s47, s47, 0
    global_load_dwordx4 v[192:195], v6, s[46:47] offset:-4096 sc1
    global_load_dwordx4 v[196:199], v6, s[46:47] offset:-3072 sc1
    global_load_dwordx4 v[200:203], v6, s[46:47] offset:-2048 sc1
    global_load_dwordx4 v[204:207], v6, s[46:47] offset:-1024 sc1
    global_load_dwordx4 v[208:211], v6, s[46:47] offset:0 sc1
    global_load_dwordx4 v[212:215], v6, s[46:47] offset:1024 sc1
    global_load_dwordx4 v[216:219], v6, s[46:47] offset:2048 sc1
    global_load_dwordx4 v[220:223], v6, s[46:47] offset:3072 sc1
    s_add_u32 s46, s46, 8192
    s_addc_u32 s47, s47, 0
    global_load_dwordx4 v[224:227], v6, s[46:47] offset:-4096 sc1
    global_load_dwordx4 v[228:231], v6, s[46:47] offset:-3072 sc1
    global_load_dwordx4 v[232:235], v6, s[46:47] offset:-2048 sc1
    global_load_dwordx4 v[236:239], v6, s[46:47] offset:-1024 sc1
    global_load_dwordx4 v[240:243], v6, s[46:47] offset:0 sc1
    global_load_dwordx4 v[244:247], v6, s[46:47] offset:1024 sc1
    global_load_dwordx4 v[248:251], v6, s[46:47] offset:2048 sc1
    global_load_dwordx4 v[252:255], v6, s[46:47] offset:3072 sc1
    v_mfma_f32_16x16x32_bf16 v[24:27], v[32:35], v[48:51], 0
    v_mfma_f32_16x16x32_bf16 v[24:27], v[36:39], v[52:55], v[24:27]
    v_mfma_f32_16x16x32_bf16 v[24:27], v[40:43], v[56:59], v[24:27]
    v_mfma_f32_16x16x32_bf16 v[24:27], v[44:47], v[60:63], v[24:27]
    v_mfma_f32_16x16x32_bf16 v[20:23], a[128:131], v[64:67], 0
    v_mfma_f32_16x16x32_bf16 v[20:23], a[132:135], v[68:71], v[20:23]
    v_mfma_f32_16x16x32_bf16 v[20:23], a[136:139], v[72:75], v[20:23]
    v_mfma_f32_16x16x32_bf16 v[20:23], a[140:143], v[76:79], v[20:23]
    v_mfma_f32_16x16x32_bf16 v[20:23], a[144:147], v[80:83], v[20:23]
    v_mfma_f32_16x16x32_bf16 v[20:23], a[148:151], v[84:87], v[20:23]
    v_mfma_f32_16x16x32_bf16 v[20:23], a[152:155], v[88:91], v[20:23]
    v_mfma_f32_16x16x32_bf16 v[20:23], a[156:159], v[92:95], v[20:23]
    v_mfma_f32_16x16x32_bf16 v[20:23], a[160:163], v[96:99], v[20:23]
    v_mfma_f32_16x16x32_bf16 v[20:23], a[164:167], v[100:103], v[20:23]
    v_mfma_f32_16x16x32_bf16 v[20:23], a[168:171], v[104:107], v[20:23]
    s_add_u32 s25, s44, 6
    s_cmp_ge_u32 s25, 88
    s_cbranch_scc1 Lt3_o2
    s_mul_i32 s22, s25, 180224
    s_lshl_b32 s23, s60, 10
    s_add_u32 s23, s23, s22
    s_add_u32 s23, s23, 134352896
    s_add_u32 s48, s16, s23
    s_addc_u32 s49, s17, 0
    s_lshl_b32 s22, s25, 14
    s_add_u32 s50, s30, s22
    s_addc_u32 s51, s31, 0
    global_load_dwordx4 v[48:51], v9, s[50:51] offset:0
    global_load_dwordx4 v[52:55], v9, s[50:51] offset:64
    global_load_dwordx4 v[56:59], v9, s[50:51] offset:128
    global_load_dwordx4 v[60:63], v9, s[50:51] offset:192
    global_load_dwordx4 v[64:67], v6, s[48:49] offset:-4096 sc1
    global_load_dwordx4 v[68:71], v6, s[48:49] offset:-3072 sc1
    global_load_dwordx4 v[72:75], v6, s[48:49] offset:-2048 sc1
    global_load_dwordx4 v[76:79], v6, s[48:49] offset:-1024 sc1
    global_load_dwordx4 v[80:83], v6, s[48:49] offset:0 sc1
    global_load_dwordx4 v[84:87], v6, s[48:49] offset:1024 sc1
    global_load_dwordx4 v[88:91], v6, s[48:49] offset:2048 sc1
    global_load_dwordx4 v[92:95], v6, s[48:49] offset:3072 sc1
    s_add_u32 s48, s48, 8192
    s_addc_u32 s49, s49, 0
    global_load_dwordx4 v[96:99], v6, s[48:49] offset:-4096 sc1
    global_load_dwordx4 v[100:103], v6, s[48:49] offset:-3072 sc1
    global_load_dwordx4 v[104:107], v6, s[48:49] offset:-2048 sc1
    s_lshr_b32 s22, s25, 1
    s_lshl_b32 s22, s22, 7
    s_add_u32 s22, s22, 66060288
    s_add_u32 s52, s16, s22
    s_addc_u32 s53, s17, 0
    global_load_dword v2, v10, s[52:53] sc1
    s_lshl_b32 s23, s69, 10
    s_add_u32 m0, s56, s23
    s_and_b32 s23, s69, 2
    s_xor_b32 s23, s23, s19
    s_lshl_b32 s23, s23, 15
    s_lshr_b32 s22, s69, 2
    s_lshl_b32 s22, s22, 5
    s_add_u32 s22, s22, s23
    v_add_u32 v1, s22, v7
    global_load_lds_dwordx4 v1, s[58:59]
    s_add_u32 m0, m0, 1024
    v_xor_b32 v1, 0x8000, v1
    global_load_lds_dwordx4 v1, s[58:59]
    s_add_u32 s69, s69, 2
    s_waitcnt vmcnt(49)
    v_mfma_f32_16x16x32_bf16 v[16:19], a[0:3], v[128:131], 0
    s_waitcnt vmcnt(48)
    v_mfma_f32_16x16x32_bf16 v[16:19], a[4:7], v[132:135], v[16:19]
    s_waitcnt vmcnt(47)
    v_mfma_f32_16x16x32_bf16 v[16:19], a[8:11], v[136:139], v[16:19]
    s_waitcnt vmcnt(46)
    v_mfma_f32_16x16x32_bf16 v[16:19], a[12:15], v[140:143], v[16:19]
    s_waitcnt vmcnt(45)
    v_mfma_f32_16x16x32_bf16 v[16:19], a[16:19], v[144:147], v[16:19]
    s_waitcnt vmcnt(44)
    v_mfma_f32_16x16x32_bf16 v[16:19], a[20:23], v[148:151], v[16:19]
    s_waitcnt vmcnt(43)
    v_mfma_f32_16x16x32_bf16 v[16:19], a[24:27], v[152:155], v[16:19]
    s_waitcnt vmcnt(42)
    v_mfma_f32_16x16x32_bf16 v[16:19], a[28:31], v[156:159], v[16:19]
    s_waitcnt vmcnt(41)
    v_mfma_f32_16x16x32_bf16 v[16:19], a[32:35], v[160:163], v[16:19]
    s_waitcnt vmcnt(40)
    v_mfma_f32_16x16x32_bf16 v[16:19], a[36:39], v[164:167], v[16:19]
    s_waitcnt vmcnt(39)
    v_mfma_f32_16x16x32_bf16 v[16:19], a[40:43], v[168:171], v[16:19]
    s_waitcnt vmcnt(38)
    v_mfma_f32_16x16x32_bf16 v[16:19], a[44:47], v[172:175], v[16:19]
    s_waitcnt vmcnt(37)
    v_mfma_f32_16x16x32_bf16 v[16:19], a[48:51], v[176:179], v[16:19]
    s_waitcnt vmcnt(36)
    v_mfma_f32_16x16x32_bf16 v[16:19], a[52:55], v[180:183], v[16:19]
    s_waitcnt vmcnt(35)
    v_mfma_f32_16x16x32_bf16 v[16:19], a[56:59], v[184:187], v[16:19]
    s_waitcnt vmcnt(34)
    v_mfma_f32_16x16x32_bf16 v[16:19], a[60:63], v[188:191], v[16:19]
    s_waitcnt vmcnt(33)
    v_mfma_f32_16x16x32_bf16 v[16:19], a[64:67], v[192:195], v[16:19]
    s_waitcnt vmcnt(32)
    v_mfma_f32_16x16x32_bf16 v[16:19], a[68:71], v[196:199], v[16:19]
    s_waitcnt vmcnt(31)
    v_mfma_f32_16x16x32_bf16 v[16:19], a[72:75], v[200:203], v[16:19]
    s_waitcnt vmcnt(30)
    v_mfma_f32_16x16x32_bf16 v[16:19], a[76:79], v[204:207], v[16:19]
    s_waitcnt vmcnt(29)
    v_mfma_f32_16x16x32_bf16 v[16:19], a[80:83], v[208:211], v[16:19]
    s_waitcnt vmcnt(28)
    v_mfma_f32_16x16x32_bf16 v[16:19], a[84:87], v[212:215], v[16:19]
    s_waitcnt vmcnt(27)
    v_mfma_f32_16x16x32_bf16 v[16:19], a[88:91], v[216:219], v[16:19]
    s_waitcnt vmcnt(26)
    v_mfma_f32_16x16x32_bf16 v[16:19], a[92:95], v[220:223], v[16:19]
    s_waitcnt vmcnt(25)
    v_mfma_f32_16x16x32_bf16 v[16:19], a[96:99], v[224:227], v[16:19]
    s_waitcnt vmcnt(24)
    v_mfma_f32_16x16x32_bf16 v[16:19], a[100:103], v[228:231], v[16:19]
    s_waitcnt vmcnt(23)
    v_mfma_f32_16x16x32_bf16 v[16:19], a[104:107], v[232:235], v[16:19]
    s_waitcnt vmcnt(22)
    v_mfma_f32_16x16x32_bf16 v[16:19], a[108:111], v[236:239], v[16:19]
    s_waitcnt vmcnt(21)
    v_mfma_f32_16x16x32_bf16 v[16:19], a[112:115], v[240:243], v[16:19]
    s_waitcnt vmcnt(20)
    v_mfma_f32_16x16x32_bf16 v[16:19], a[116:119], v[244:247], v[16:19]
    s_waitcnt vmcnt(19)
    v_mfma_f32_16x16x32_bf16 v[16:19], a[120:123], v[248:251], v[16:19]
    s_waitcnt vmcnt(18)
    v_mfma_f32_16x16x32_bf16 v[16:19], a[124:127], v[252:255], v[16:19]
    s_branch Lt3_o3
Lt3_o2:
    s_waitcnt vmcnt(31)
    s_nop 3
    v_mfma_f32_16x16x32_bf16 v[16:19], a[0:3], v[128:131], 0
    s_waitcnt vmcnt(30)
    v_mfma_f32_16x16x32_bf16 v[16:19], a[4:7], v[132:135], v[16:19]
    s_waitcnt vmcnt(29)
    v_mfma_f32_16x16x32_bf16 v[16:19], a[8:11], v[136:139], v[16:19]
    s_waitcnt vmcnt(28)
    v_mfma_f32_16x16x32_bf16 v[16:19], a[12:15], v[140:143], v[16:19]
    s_waitcnt vmcnt(27)
    v_mfma_f32_16x16x32_bf16 v[16:19], a[16:19], v[144:147], v[16:19]
    s_waitcnt vmcnt(26)
    v_mfma_f32_16x16x32_bf16 v[16:19], a[20:23], v[148:151], v[16:19]
    s_waitcnt vmcnt(25)
    v_mfma_f32_16x16x32_bf16 v[16:19], a[24:27], v[152:155], v[16:19]
    s_waitcnt vmcnt(24)
    v_mfma_f32_16x16x32_bf16 v[16:19], a[28:31], v[156:159], v[16:19]
    s_waitcnt vmcnt(23)
    v_mfma_f32_16x16x32_bf16 v[16:19], a[32:35], v[160:163], v[16:19]
    s_waitcnt vmcnt(22)
    v_mfma_f32_16x16x32_bf16 v[16:19], a[36:39], v[164:167], v[16:19]
    s_waitcnt vmcnt(21)
    v_mfma_f32_16x16x32_bf16 v[16:19], a[40:43], v[168:171], v[16:19]
    s_waitcnt vmcnt(20)
    v_mfma_f32_16x16x32_bf16 v[16:19], a[44:47], v[172:175], v[16:19]
    s_waitcnt vmcnt(19)
    v_mfma_f32_16x16x32_bf16 v[16:19], a[48:51], v[176:179], v[16:19]
    s_waitcnt vmcnt(18)
    v_mfma_f32_16x16x32_bf16 v[16:19], a[52:55], v[180:183], v[16:19]
    s_waitcnt vmcnt(17)
    v_mfma_f32_16x16x32_bf16 v[16:19], a[56:59], v[184:187], v[16:19]
    s_waitcnt vmcnt(16)
    v_mfma_f32_16x16x32_bf16 v[16:19], a[60:63], v[188:191], v[16:19]
    s_waitcnt vmcnt(15)
    v_mfma_f32_16x16x32_bf16 v[16:19], a[64:67], v[192:195], v[16:19]
    s_waitcnt vmcnt(14)
    v_mfma_f32_16x16x32_bf16 v[16:19], a[68:71], v[196:199], v[16:19]
    s_waitcnt vmcnt(13)
    v_mfma_f32_16x16x32_bf16 v[16:19], a[72:75], v[200:203], v[16:19]
    s_waitcnt vmcnt(12)
    v_mfma_f32_16x16x32_bf16 v[16:19], a[76:79], v[204:207], v[16:19]
    s_waitcnt vmcnt(11)
    v_mfma_f32_16x16x32_bf16 v[16:19], a[80:83], v[208:211], v[16:19]
    s_waitcnt vmcnt(10)
    v_mfma_f32_16x16x32_bf16 v[16:19], a[84:87], v[212:215], v[16:19]
    s_waitcnt vmcnt(9)
    v_mfma_f32_16x16x32_bf16 v[16:19], a[88:91], v[216:219], v[16:19]
    s_waitcnt vmcnt(8)
    v_mfma_f32_16x16x32_bf16 v[16:19], a[92:95], v[220:223], v[16:19]
    s_waitcnt vmcnt(7)
    v_mfma_f32_16x16x32_bf16 v[16:19], a[96:99], v[224:227], v[16:19]
    s_waitcnt vmcnt(6)
    v_mfma_f32_16x16x32_bf16 v[16:19], a[100:103], v[228:231], v[16:19]
    s_waitcnt vmcnt(5)
    v_mfma_f32_16x16x32_bf16 v[16:19], a[104:107], v[232:235], v[16:19]
    s_waitcnt vmcnt(4)
    v_mfma_f32_16x16x32_bf16 v[16:19], a[108:111], v[236:239], v[16:19]
    s_waitcnt vmcnt(3)
    v_mfma_f32_16x16x32_bf16 v[16:19], a[112:115], v[240:243], v[16:19]
    s_waitcnt vmcnt(2)
    v_mfma_f32_16x16x32_bf16 v[16:19], a[116:119], v[244:247], v[16:19]
    s_waitcnt vmcnt(1)
    v_mfma_f32_16x16x32_bf16 v[16:19], a[120:123], v[248:251], v[16:19]
    s_waitcnt vmcnt(0)
    v_mfma_f32_16x16x32_bf16 v[16:19], a[124:127], v[252:255], v[16:19]
Lt3_o3:
    ds_write_b128 v11, v[20:23] offset:1024
    ds_write_b128 v11, v[24:27] offset:2048
    s_nop 5
    ds_write_b128 v11, v[16:19]
    s_waitcnt lgkmcnt(0)
    s_barrier
    s_cmp_lg_u32 s19, 0
    s_cbranch_scc1 Lt3_nx
    ds_read_b128 v[140:143], v11 offset:3072
    ds_read_b128 v[144:147], v11 offset:4096
    ds_read_b128 v[148:151], v11 offset:5120
    ds_read_b128 v[152:155], v11 offset:6144
    ds_read_b128 v[156:159], v11 offset:7168
    ds_read_b128 v[160:163], v11 offset:8192
    ds_read_b128 v[164:167], v11 offset:9216
    ds_read_b128 v[168:171], v11 offset:10240
    ds_read_b128 v[172:175], v11 offset:11264
    s_waitcnt lgkmcnt(0)
    v_add_f32 v16, v16, v140
    v_add_f32 v17, v17, v141
    v_add_f32 v18, v18, v142
    v_add_f32 v19, v19, v143
    v_add_f32 v20, v20, v144
    v_add_f32 v21, v21, v145
    v_add_f32 v22, v22, v146
    v_add_f32 v23, v23, v147
    v_add_f32 v24, v24, v148
    v_add_f32 v16, v16, v152
    v_add_f32 v17, v17, v153
    v_add_f32 v18, v18, v154
    v_add_f32 v19, v19, v155
    v_add_f32 v20, v20, v156
    v_add_f32 v21, v21, v157
    v_add_f32 v22, v22, v158
    v_add_f32 v23, v23, v159
    v_add_f32 v24, v24, v160
    v_add_f32 v16, v16, v164
    v_add_f32 v17, v17, v165
    v_add_f32 v18, v18, v166
    v_add_f32 v19, v19, v167
    v_add_f32 v20, v20, v168
    v_add_f32 v21, v21, v169
    v_add_f32 v22, v22, v170
    v_add_f32 v23, v23, v171
    v_add_f32 v24, v24, v172
    v_mul_f32 v24, 3216550459, v24
    v_exp_f32 v24, v24
    s_nop 0
    v_add_f32 v24, 1.0, v24
    v_rcp_f32 v24, v24
    s_nop 0
    v_sub_f32 v25, 1.0, v24
    v_mul_f32 v16, v16, v24
    v_fmac_f32 v16, v20, v25
    v_mul_f32 v17, v17, v24
    v_fmac_f32 v17, v21, v25
    v_mul_f32 v18, v18, v24
    v_fmac_f32 v18, v22, v25
    v_mul_f32 v19, v19, v24
    v_fmac_f32 v19, v23, v25
    v_cvt_pk_bf16_f32 v16, v16, v17
    v_cvt_pk_bf16_f32 v17, v18, v19
    global_store_dwordx2 v12, v[16:17], s[54:55]
Lt3_nx:
    v_xor_b32 v11, 0x4000, v11
    s_add_u32 s44, s44, 6
    s_cmp_lt_u32 s44, 88
    s_cbranch_scc1 Lt3_nd
    s_cmp_lt_u32 s44, 112
    s_cbranch_scc1 Lt3_tile
    s_lshl_b32 s22, s20, 6
    s_add_u32 s22, s22, 66084864
    v_and_b32 v1, 7, v3
    v_lshl_add_u32 v1, v1, 2, s22
    global_load_dword v2, v1, s[16:17] sc1
    ds_read_b64_tr_b16 a[0:1], v8 offset:0
    ds_read_b64_tr_b16 a[2:3], v8 offset:512
    ds_read_b64_tr_b16 a[4:5], v8 offset:1024
    ds_read_b64_tr_b16 a[6:7], v8 offset:1536
    ds_read_b64_tr_b16 a[8:9], v8 offset:2048
    ds_read_b64_tr_b16 a[10:11], v8 offset:2560
    ds_read_b64_tr_b16 a[12:13], v8 offset:3072
    ds_read_b64_tr_b16 a[14:15], v8 offset:3584
    ds_read_b64_tr_b16 a[16:17], v8 offset:4096
    ds_read_b64_tr_b16 a[18:19], v8 offset:4608
    ds_read_b64_tr_b16 a[20:21], v8 offset:5120
    ds_read_b64_tr_b16 a[22:23], v8 offset:5632
    ds_read_b64_tr_b16 a[24:25], v8 offset:6144
    ds_read_b64_tr_b16 a[26:27], v8 offset:6656
    ds_read_b64_tr_b16 a[28:29], v8 offset:7168
    ds_read_b64_tr_b16 a[30:31], v8 offset:7680
    ds_read_b64_tr_b16 a[32:33], v8 offset:8192
    ds_read_b64_tr_b16 a[34:35], v8 offset:8704
    ds_read_b64_tr_b16 a[36:37], v8 offset:9216
    ds_read_b64_tr_b16 a[38:39], v8 offset:9728
    ds_read_b64_tr_b16 a[40:41], v8 offset:10240
    ds_read_b64_tr_b16 a[42:43], v8 offset:10752
    ds_read_b64_tr_b16 a[44:45], v8 offset:11264
    ds_read_b64_tr_b16 a[46:47], v8 offset:11776
    ds_read_b64_tr_b16 a[48:49], v8 offset:12288
    ds_read_b64_tr_b16 a[50:51], v8 offset:12800
    ds_read_b64_tr_b16 a[52:53], v8 offset:13312
    ds_read_b64_tr_b16 a[54:55], v8 offset:13824
    ds_read_b64_tr_b16 a[56:57], v8 offset:14336
    ds_read_b64_tr_b16 a[58:59], v8 offset:14848
    ds_read_b64_tr_b16 a[60:61], v8 offset:15360
    ds_read_b64_tr_b16 a[62:63], v8 offset:15872
    ds_read_b64_tr_b16 a[64:65], v8 offset:16384
    ds_read_b64_tr_b16 a[66:67], v8 offset:16896
    ds_read_b64_tr_b16 a[68:69], v8 offset:17408
    ds_read_b64_tr_b16 a[70:71], v8 offset:17920
    ds_read_b64_tr_b16 a[72:73], v8 offset:18432
    ds_read_b64_tr_b16 a[74:75], v8 offset:18944
    ds_read_b64_tr_b16 a[76:77], v8 offset:19456
    ds_read_b64_tr_b16 a[78:79], v8 offset:19968
    ds_read_b64_tr_b16 a[80:81], v8 offset:20480
    ds_read_b64_tr_b16 a[82:83], v8 offset:20992
    ds_read_b64_tr_b16 a[84:85], v8 offset:21504
    ds_read_b64_tr_b16 a[86:87], v8 offset:22016
    ds_read_b64_tr_b16 a[88:89], v8 offset:22528
    ds_read_b64_tr_b16 a[90:91], v8 offset:23040
    ds_read_b64_tr_b16 a[92:93], v8 offset:23552
    ds_read_b64_tr_b16 a[94:95], v8 offset:24064
    ds_read_b64_tr_b16 a[96:97], v8 offset:24576
    ds_read_b64_tr_b16 a[98:99], v8 offset:25088
    ds_read_b64_tr_b16 a[100:101], v8 offset:25600
    ds_read_b64_tr_b16 a[102:103], v8 offset:26112
    ds_read_b64_tr_b16 a[104:105], v8 offset:26624
    ds_read_b64_tr_b16 a[106:107], v8 offset:27136
    ds_read_b64_tr_b16 a[108:109], v8 offset:27648
    ds_read_b64_tr_b16 a[110:111], v8 offset:28160
    ds_read_b64_tr_b16 a[112:113], v8 offset:28672
    ds_read_b64_tr_b16 a[114:115], v8 offset:29184
    ds_read_b64_tr_b16 a[116:117], v8 offset:29696
    ds_read_b64_tr_b16 a[118:119], v8 offset:30208
    ds_read_b64_tr_b16 a[120:121], v8 offset:30720
    ds_read_b64_tr_b16 a[122:123], v8 offset:31232
    ds_read_b64_tr_b16 a[124:125], v8 offset:31744
    ds_read_b64_tr_b16 a[126:127], v8 offset:32256
    s_lshl_b32 s22, s19, 10
    v_add_u32 v48, s22, v6
    v_add_u32 v52, 143360, v48
    v_xor_b32 v49, 1024, v48
    v_xor_b32 v53, 1024, v52
    v_xor_b32 v50, 2048, v48
    v_xor_b32 v54, 2048, v52
    v_xor_b32 v51, 3072, v48
    v_xor_b32 v55, 3072, v52
    s_lshl_b32 s22, s19, 17
    s_lshl_b32 s23, s18, 10
    s_add_u32 s22, s22, s23
    v_lshl_add_u32 v56, v5, 15, s22
    v_lshl_add_u32 v56, v4, 3, v56
    v_lshl_add_u32 v57, v4, 5, s56
    v_lshl_add_u32 v57, v5, 3, v57
    v_mov_b32 v252, 0x3f803f80
    v_mov_b32 v253, 0x3f803f80
    v_mov_b32 v245, 0
    v_mov_b32 v246, 0
    s_mov_b32 s26, 0
    s_waitcnt vmcnt(0)
    v_and_b32 v128, 0x01010101, v2
    v_cmp_ne_u32 vcc, 0x01010101, v128
    s_cbranch_vccz Lt4_x_b
    s_mov_b32 s21, 0
Lt4_x_p:
    global_load_dword v2, v1, s[16:17] sc1
    s_add_u32 s21, s21, 1
    s_cmp_gt_u32 s21, 60000
    s_cbranch_scc1 Lt4_x_b
    s_waitcnt vmcnt(0)
    v_and_b32 v128, 0x01010101, v2
    v_cmp_ne_u32 vcc, 0x01010101, v128
    s_cbranch_vccz Lt4_x_b
    s_sleep 8
    s_branch Lt4_x_p
Lt4_x_b:
    s_waitcnt vmcnt(0)
    s_lshl_b32 s22, s3, 1
    s_add_u32 s22, s22, 1
    s_mul_i32 s22, s22, 0x01010101
    v_cmp_ne_u32 vcc, s22, v2
    s_waitcnt lgkmcnt(0)
    s_mov_b32 s68, vcc_lo
Lt4_tile:
    s_lshl_b32 s22, s44, 14
    s_add_u32 s54, s40, s22
    s_addc_u32 s55, s41, 0
    s_lshr_b32 s22, s44, 1
    s_lshl_b32 s22, s22, 5
    s_add_u32 s22, s22, s18
    s_lshl_b32 s23, s22, 12
    s_add_u32 s23, s23, 50331648
    s_add_u32 s52, s16, s23
    s_addc_u32 s53, s17, 0
    global_load_dwordx4 v[184:187], v48, s[52:53] sc1
    global_load_dwordx4 v[188:191], v49, s[52:53] sc1
    global_load_dwordx4 v[192:195], v50, s[52:53] sc1
    global_load_dwordx4 v[196:199], v51, s[52:53] sc1
    s_cmp_lg_u32 s26, 0
    s_cbranch_scc1 Lt4_pk1
    v_accvgpr_read_b32 v128, a172
    v_accvgpr_read_b32 v129, a173
    v_accvgpr_read_b32 v130, a174
    v_accvgpr_read_b32 v131, a175
    v_accvgpr_read_b32 v132, a176
    v_accvgpr_read_b32 v133, a177
    v_accvgpr_read_b32 v134, a178
    v_accvgpr_read_b32 v135, a179
    v_accvgpr_read_b32 v136, a180
    v_accvgpr_read_b32 v137, a181
    v_accvgpr_read_b32 v138, a182
    v_accvgpr_read_b32 v139, a183
    v_accvgpr_read_b32 v140, a184
    v_accvgpr_read_b32 v141, a185
    v_accvgpr_read_b32 v142, a186
    v_accvgpr_read_b32 v143, a187
    v_accvgpr_read_b32 v232, a188
    v_accvgpr_read_b32 v233, a189
    v_accvgpr_read_b32 v234, a190
    v_accvgpr_read_b32 v235, a191
    v_accvgpr_read_b32 v236, a192
    v_accvgpr_read_b32 v237, a193
    v_accvgpr_read_b32 v238, a194
    v_accvgpr_read_b32 v239, a195
    v_accvgpr_read_b32 v228, a196
    v_accvgpr_read_b32 v231, a197
    v_accvgpr_read_b32 v20, a198
    v_accvgpr_read_b32 v16, a199
    v_accvgpr_read_b32 v17, a200
    v_accvgpr_read_b32 v18, a201
    v_accvgpr_read_b32 v19, a202
    s_branch Lt4_pe
Lt4_pk1:
    s_cmp_lg_u32 s26, 1
    s_cbranch_scc1 Lt4_pk2
    v_accvgpr_read_b32 v128, a203
    v_accvgpr_read_b32 v129, a204
    v_accvgpr_read_b32 v130, a205
    v_accvgpr_read_b32 v131, a206
    v_accvgpr_read_b32 v132, a207
    v_accvgpr_read_b32 v133, a208
    v_accvgpr_read_b32 v134, a209
    v_accvgpr_read_b32 v135, a210
    v_accvgpr_read_b32 v136, a211
    v_accvgpr_read_b32 v137, a212
    v_accvgpr_read_b32 v138, a213
    v_accvgpr_read_b32 v139, a214
    v_accvgpr_read_b32 v140, a215
    v_accvgpr_read_b32 v141, a216
    v_accvgpr_read_b32 v142, a217
    v_accvgpr_read_b32 v143, a218
    v_accvgpr_read_b32 v232, a219
    v_accvgpr_read_b32 v233, a220
    v_accvgpr_read_b32 v234, a221
    v_accvgpr_read_b32 v235, a222
    v_accvgpr_read_b32 v236, a223
    v_accvgpr_read_b32 v237, a224
    v_accvgpr_read_b32 v238, a225
    v_accvgpr_read_b32 v239, a226
    v_accvgpr_read_b32 v228, a227
    v_accvgpr_read_b32 v231, a228
    v_accvgpr_read_b32 v20, a229
    v_accvgpr_read_b32 v16, a230
    v_accvgpr_read_b32 v17, a231
    v_accvgpr_read_b32 v18, a232
    v_accvgpr_read_b32 v19, a233
    s_branch Lt4_pe
Lt4_pk2:
    v_accvgpr_read_b32 v128, a234
    v_accvgpr_read_b32 v129, a235
    v_accvgpr_read_b32 v130, a236
    v_accvgpr_read_b32 v131, a237
    v_accvgpr_read_b32 v132, a238
    v_accvgpr_read_b32 v133, a239
    v_accvgpr_read_b32 v134, a240
    v_accvgpr_read_b32 v135, a241
    v_accvgpr_read_b32 v136, a242
    v_accvgpr_read_b32 v137, a243
    v_accvgpr_read_b32 v138, a244
    v_accvgpr_read_b32 v139, a245
    v_accvgpr_read_b32 v140, a246
    v_accvgpr_read_b32 v141, a247
    v_accvgpr_read_b32 v142, a248
    v_accvgpr_read_b32 v143, a249
    v_accvgpr_read_b32 v232, a250
    v_accvgpr_read_b32 v233, a251
    v_accvgpr_read_b32 v234, a252
    v_accvgpr_read_b32 v235, a253
    v_accvgpr_read_b32 v236, a254
    v_accvgpr_read_b32 v237, a255
    v_mov_b32 v238, v112
    v_mov_b32 v239, v113
    v_mov_b32 v228, v114
    v_mov_b32 v231, v115
    v_mov_b32 v20, v120
    v_mov_b32 v16, v121
    v_mov_b32 v17, v122
    v_mov_b32 v18, v123
    v_mov_b32 v19, v124
Lt4_pe:
    s_mov_b32 s21, 0
    s_branch Lt4_p
Lt4_r:
    s_add_u32 s21, s21, 1
    s_cmp_gt_u32 s21, 60000
    s_cbranch_scc1 Lt4_go
    s_sleep 1
    global_load_dwordx4 v[184:187], v48, s[52:53] sc1
    global_load_dwordx4 v[188:191], v49, s[52:53] sc1
    global_load_dwordx4 v[192:195], v50, s[52:53] sc1
    global_load_dwordx4 v[196:199], v51, s[52:53] sc1
Lt4_p:
    s_waitcnt vmcnt(3)
    ds_write2st64_b32 v57, v184, v185 offset0:0 offset1:2
    s_waitcnt vmcnt(2)
    ds_write2st64_b32 v57, v188, v189 offset0:4 offset1:6
    s_waitcnt vmcnt(1)
    ds_write2st64_b32 v57, v192, v193 offset0:8 offset1:10
    s_waitcnt vmcnt(0)
    ds_write2st64_b32 v57, v196, v197 offset0:12 offset1:14
    ds_read_b64_tr_b16 v[200:201], v8 offset:0
    ds_read_b64_tr_b16 v[202:203], v8 offset:512
    ds_read_b64_tr_b16 v[204:205], v8 offset:1024
    ds_read_b64_tr_b16 v[206:207], v8 offset:1536
    ds_read_b64_tr_b16 v[208:209], v8 offset:2048
    ds_read_b64_tr_b16 v[210:211], v8 offset:2560
    ds_read_b64_tr_b16 v[212:213], v8 offset:3072
    ds_read_b64_tr_b16 v[214:215], v8 offset:3584
    v_max3_u32 v230, v184, v185, v186
    v_max3_u32 v230, v230, v187, v188
    v_max3_u32 v230, v230, v189, v192
    v_max3_u32 v230, v230, v193, v196
    v_max_u32 v230, v230, v197
    v_cmp_eq_u32 vcc, -1, v230
    s_cbranch_vccnz Lt4_r
Lt4_go:
    s_waitcnt lgkmcnt(6)
    v_mfma_f32_16x16x32_bf16 v[224:227], v[200:203], v[128:131], 0
    s_waitcnt lgkmcnt(4)
    v_mfma_f32_16x16x32_bf16 v[224:227], v[204:207], v[132:135], v[224:227]
    s_waitcnt lgkmcnt(2)
    v_mfma_f32_16x16x32_bf16 v[224:227], v[208:211], v[136:139], v[224:227]
    s_waitcnt lgkmcnt(0)
    v_mfma_f32_16x16x32_bf16 v[224:227], v[212:215], v[140:143], v[224:227]
    s_nop 7
    v_max3_f32 v229, v228, v224, v225
    v_max3_f32 v230, v228, v224, v225
    s_nop 1
    v_permlane16_swap_b32 v229, v230
    v_max_f32 v226, v229, v230
    v_max_f32 v229, v229, v230
    s_nop 1
    v_permlane32_swap_b32 v229, v226
    v_max_f32 v229, v229, v226
    v_sub_f32 v228, v228, v229
    v_sub_f32 v224, v224, v229
    v_sub_f32 v225, v225, v229
    v_exp_f32 v228, v228
    v_exp_f32 v224, v224
    v_exp_f32 v225, v225
    v_mul_f32 v248, v231, v228
    v_cvt_pk_bf16_f32 v244, v224, v225
    v_cvt_pk_bf16_f32 v247, v224, v225
    v_mul_f32 v232, v232, v228
    v_mul_f32 v233, v233, v228
    v_mfma_f32_16x16x16_bf16 v[248:251], v[252:253], v[244:245], v[248:251]
    v_mul_f32 v234, v234, v228
    v_mul_f32 v235, v235, v228
    v_mul_f32 v236, v236, v228
    v_mul_f32 v237, v237, v228
    v_mfma_f32_16x16x16_bf16 v[232:235], v[186:187], v[244:245], v[232:235]
    v_mul_f32 v238, v238, v228
    v_mul_f32 v239, v239, v228
    s_nop 1
    v_mfma_f32_16x16x16_bf16 v[236:239], v[186:187], v[246:247], v[236:239]
    v_rcp_f32 v248, v248
    s_nop 1
    v_mul_f32 v232, v232, v248
    v_mul_f32 v233, v233, v248
    v_mul_f32 v234, v234, v248
    v_mul_f32 v235, v235, v248
    v_cvt_pk_bf16_f32 v144, v232, v233
    v_cvt_pk_bf16_f32 v145, v234, v235
    v_mul_f32 v236, v236, v248
    v_mul_f32 v237, v237, v248
    v_mul_f32 v238, v238, v248
    v_mul_f32 v239, v239, v248
    v_cvt_pk_bf16_f32 v146, v236, v237
    v_cvt_pk_bf16_f32 v147, v238, v239
    ds_write_b128 v52, v[144:147]
    s_nop 0
    v_mfma_f32_16x16x32_bf16 v[64:67], a[0:3], v[144:147], 0
    v_mfma_f32_16x16x32_bf16 v[68:71], a[16:19], v[144:147], 0
    s_waitcnt lgkmcnt(0)
    s_barrier
    ds_read_b128 v[148:151], v53
    ds_read_b128 v[152:155], v54
    ds_read_b128 v[156:159], v55
    v_mfma_f32_16x16x32_bf16 v[72:75], a[32:35], v[144:147], 0
    v_mfma_f32_16x16x32_bf16 v[76:79], a[48:51], v[144:147], 0
    v_mfma_f32_16x16x32_bf16 v[80:83], a[64:67], v[144:147], 0
    v_mfma_f32_16x16x32_bf16 v[84:87], a[80:83], v[144:147], 0
    v_mfma_f32_16x16x32_bf16 v[88:91], a[96:99], v[144:147], 0
    v_mfma_f32_16x16x32_bf16 v[92:95], a[112:115], v[144:147], 0
    s_cmp_lg_u32 s68, 0
    s_cbranch_scc1 Lt4_s
    s_waitcnt lgkmcnt(2)
    v_mfma_f32_16x16x32_bf16 v[64:67], a[4:7], v[148:151], v[64:67]
    v_mfma_f32_16x16x32_bf16 v[68:71], a[20:23], v[148:151], v[68:71]
    s_waitcnt lgkmcnt(1)
    v_mfma_f32_16x16x32_bf16 v[64:67], a[8:11], v[152:155], v[64:67]
    v_mfma_f32_16x16x32_bf16 v[68:71], a[24:27], v[152:155], v[68:71]
    s_waitcnt lgkmcnt(0)
    v_mfma_f32_16x16x32_bf16 v[64:67], a[12:15], v[156:159], v[64:67]
    v_mfma_f32_16x16x32_bf16 v[68:71], a[28:31], v[156:159], v[68:71]
    v_mfma_f32_16x16x32_bf16 v[72:75], a[36:39], v[148:151], v[72:75]
    v_mfma_f32_16x16x32_bf16 v[76:79], a[52:55], v[148:151], v[76:79]
    v_cvt_pk_bf16_f32 v96, v64, v65
    v_mfma_f32_16x16x32_bf16 v[72:75], a[40:43], v[152:155], v[72:75]
    v_cvt_pk_bf16_f32 v97, v66, v67
    global_store_dwordx2 v56, v[96:97], s[62:63] offset:0
    v_mfma_f32_16x16x32_bf16 v[76:79], a[56:59], v[152:155], v[76:79]
    v_cvt_pk_bf16_f32 v98, v68, v69
    v_mfma_f32_16x16x32_bf16 v[72:75], a[44:47], v[156:159], v[72:75]
    v_cvt_pk_bf16_f32 v99, v70, v71
    global_store_dwordx2 v56, v[98:99], s[62:63] offset:128
    v_mfma_f32_16x16x32_bf16 v[76:79], a[60:63], v[156:159], v[76:79]
    v_mfma_f32_16x16x32_bf16 v[80:83], a[68:71], v[148:151], v[80:83]
    v_mfma_f32_16x16x32_bf16 v[84:87], a[84:87], v[148:151], v[84:87]
    v_cvt_pk_bf16_f32 v100, v72, v73
    v_mfma_f32_16x16x32_bf16 v[80:83], a[72:75], v[152:155], v[80:83]
    v_cvt_pk_bf16_f32 v101, v74, v75
    global_store_dwordx2 v56, v[100:101], s[62:63] offset:256
    v_mfma_f32_16x16x32_bf16 v[84:87], a[88:91], v[152:155], v[84:87]
    v_cvt_pk_bf16_f32 v102, v76, v77
    v_mfma_f32_16x16x32_bf16 v[80:83], a[76:79], v[156:159], v[80:83]
    v_cvt_pk_bf16_f32 v103, v78, v79
    global_store_dwordx2 v56, v[102:103], s[62:63] offset:384
    v_mfma_f32_16x16x32_bf16 v[84:87], a[92:95], v[156:159], v[84:87]
    v_mfma_f32_16x16x32_bf16 v[88:91], a[100:103], v[148:151], v[88:91]
    v_mfma_f32_16x16x32_bf16 v[92:95], a[116:119], v[148:151], v[92:95]
    v_cvt_pk_bf16_f32 v96, v80, v81
    v_mfma_f32_16x16x32_bf16 v[88:91], a[104:107], v[152:155], v[88:91]
    v_cvt_pk_bf16_f32 v97, v82, v83
    global_store_dwordx2 v56, v[96:97], s[62:63] offset:512
    v_mfma_f32_16x16x32_bf16 v[92:95], a[120:123], v[152:155], v[92:95]
    v_cvt_pk_bf16_f32 v98, v84, v85
    v_mfma_f32_16x16x32_bf16 v[88:91], a[108:111], v[156:159], v[88:91]
    v_cvt_pk_bf16_f32 v99, v86, v87
    global_store_dwordx2 v56, v[98:99], s[62:63] offset:640
    v_mfma_f32_16x16x32_bf16 v[92:95], a[124:127], v[156:159], v[92:95]
    s_nop 3
    v_cvt_pk_bf16_f32 v100, v88, v89
    v_cvt_pk_bf16_f32 v101, v90, v91
    global_store_dwordx2 v56, v[100:101], s[62:63] offset:768
    s_nop 0
    v_cvt_pk_bf16_f32 v102, v92, v93
    v_cvt_pk_bf16_f32 v103, v94, v95
    global_store_dwordx2 v56, v[102:103], s[62:63] offset:896
    s_branch Lt4_e
Lt4_s:
    s_waitcnt lgkmcnt(2)
    v_mfma_f32_16x16x32_bf16 v[64:67], a[4:7], v[148:151], v[64:67]
    v_mfma_f32_16x16x32_bf16 v[68:71], a[20:23], v[148:151], v[68:71]
    s_waitcnt lgkmcnt(1)
    v_mfma_f32_16x16x32_bf16 v[64:67], a[8:11], v[152:155], v[64:67]
    v_mfma_f32_16x16x32_bf16 v[68:71], a[24:27], v[152:155], v[68:71]
    s_waitcnt lgkmcnt(0)
    v_mfma_f32_16x16x32_bf16 v[64:67], a[12:15], v[156:159], v[64:67]
    v_mfma_f32_16x16x32_bf16 v[68:71], a[28:31], v[156:159], v[68:71]
    v_mfma_f32_16x16x32_bf16 v[72:75], a[36:39], v[148:151], v[72:75]
    v_mfma_f32_16x16x32_bf16 v[76:79], a[52:55], v[148:151], v[76:79]
    v_cvt_pk_bf16_f32 v96, v64, v65
    v_mfma_f32_16x16x32_bf16 v[72:75], a[40:43], v[152:155], v[72:75]
    v_cvt_pk_bf16_f32 v97, v66, v67
    global_store_dwordx2 v56, v[96:97], s[62:63] offset:0 sc1
    v_mfma_f32_16x16x32_bf16 v[76:79], a[56:59], v[152:155], v[76:79]
    v_cvt_pk_bf16_f32 v98, v68, v69
    v_mfma_f32_16x16x32_bf16 v[72:75], a[44:47], v[156:159], v[72:75]
    v_cvt_pk_bf16_f32 v99, v70, v71
    global_store_dwordx2 v56, v[98:99], s[62:63] offset:128 sc1
    v_mfma_f32_16x16x32_bf16 v[76:79], a[60:63], v[156:159], v[76:79]
    v_mfma_f32_16x16x32_bf16 v[80:83], a[68:71], v[148:151], v[80:83]
    v_mfma_f32_16x16x32_bf16 v[84:87], a[84:87], v[148:151], v[84:87]
    v_cvt_pk_bf16_f32 v100, v72, v73
    v_mfma_f32_16x16x32_bf16 v[80:83], a[72:75], v[152:155], v[80:83]
    v_cvt_pk_bf16_f32 v101, v74, v75
    global_store_dwordx2 v56, v[100:101], s[62:63] offset:256 sc1
    v_mfma_f32_16x16x32_bf16 v[84:87], a[88:91], v[152:155], v[84:87]
    v_cvt_pk_bf16_f32 v102, v76, v77
    v_mfma_f32_16x16x32_bf16 v[80:83], a[76:79], v[156:159], v[80:83]
    v_cvt_pk_bf16_f32 v103, v78, v79
    global_store_dwordx2 v56, v[102:103], s[62:63] offset:384 sc1
    v_mfma_f32_16x16x32_bf16 v[84:87], a[92:95], v[156:159], v[84:87]
    v_mfma_f32_16x16x32_bf16 v[88:91], a[100:103], v[148:151], v[88:91]
    v_mfma_f32_16x16x32_bf16 v[92:95], a[116:119], v[148:151], v[92:95]
    v_cvt_pk_bf16_f32 v96, v80, v81
    v_mfma_f32_16x16x32_bf16 v[88:91], a[104:107], v[152:155], v[88:91]
    v_cvt_pk_bf16_f32 v97, v82, v83
    global_store_dwordx2 v56, v[96:97], s[62:63] offset:512 sc1
    v_mfma_f32_16x16x32_bf16 v[92:95], a[120:123], v[152:155], v[92:95]
    v_cvt_pk_bf16_f32 v98, v84, v85
    v_mfma_f32_16x16x32_bf16 v[88:91], a[108:111], v[156:159], v[88:91]
    v_cvt_pk_bf16_f32 v99, v86, v87
    global_store_dwordx2 v56, v[98:99], s[62:63] offset:640 sc1
    v_mfma_f32_16x16x32_bf16 v[92:95], a[124:127], v[156:159], v[92:95]
    s_nop 3
    v_cvt_pk_bf16_f32 v100, v88, v89
    v_cvt_pk_bf16_f32 v101, v90, v91
    global_store_dwordx2 v56, v[100:101], s[62:63] offset:768 sc1
    s_nop 0
    v_cvt_pk_bf16_f32 v102, v92, v93
    v_cvt_pk_bf16_f32 v103, v94, v95
    global_store_dwordx2 v56, v[102:103], s[62:63] offset:896 sc1
Lt4_e:
    s_mov_b32 s21, 0
Lt4_i:
    global_load_dwordx4 v[160:163], v116, s[62:63] sc1
    global_load_dwordx4 v[164:167], v117, s[62:63] sc1
    global_load_dwordx4 v[168:171], v118, s[62:63] sc1
    global_load_dwordx4 v[172:175], v119, s[62:63] sc1
    s_add_u32 s21, s21, 1
    s_cmp_gt_u32 s21, 60000
    s_cbranch_scc1 Lt4_f
    s_waitcnt vmcnt(3)
    v_mfma_f32_16x16x32_bf16 v[24:27], v[28:31], v[160:163], 0
    v_max3_u32 v230, v160, v160, v161
    v_max3_u32 v230, v230, v162, v163
    s_waitcnt vmcnt(2)
    v_mfma_f32_16x16x32_bf16 v[24:27], v[28:31], v[164:167], v[24:27]
    v_max3_u32 v230, v230, v164, v165
    v_max3_u32 v230, v230, v166, v167
    s_waitcnt vmcnt(1)
    v_mfma_f32_16x16x32_bf16 v[24:27], v[28:31], v[168:171], v[24:27]
    v_max3_u32 v230, v230, v168, v169
    v_max3_u32 v230, v230, v170, v171
    s_waitcnt vmcnt(0)
    v_mfma_f32_16x16x32_bf16 v[24:27], v[28:31], v[172:175], v[24:27]
    v_max3_u32 v230, v230, v172, v173
    v_max3_u32 v230, v230, v174, v175
    v_cmp_eq_u32 vcc, -1, v230
    s_cbranch_vccnz Lt4_i
Lt4_f:
    s_nop 3
    v_add_f32_dpp v24, v24, v24 row_ror:8 row_mask:0xf bank_mask:0xf
    v_add_f32_dpp v25, v25, v25 row_ror:8 row_mask:0xf bank_mask:0xf
    v_add_f32_dpp v26, v26, v26 row_ror:8 row_mask:0xf bank_mask:0xf
    v_add_f32_dpp v27, v27, v27 row_ror:8 row_mask:0xf bank_mask:0xf
    v_fma_f32 v24, v24, v20, v16
    v_fma_f32 v25, v25, v20, v17
    v_fma_f32 v26, v26, v20, v18
    v_fma_f32 v27, v27, v20, v19
    s_mov_b64 exec, 0x00ff00ff
    v_cvt_pk_bf16_f32 v24, v24, v25
    v_cvt_pk_bf16_f32 v25, v26, v27
    global_store_dwordx2 v14, v[24:25], s[54:55]
    s_mov_b64 exec, -1
    s_waitcnt vmcnt(1)
    s_add_u32 s26, s26, 1
    s_add_u32 s62, s62, 524288
    s_addc_u32 s63, s63, 0
    s_add_u32 s44, s44, 6
    s_cmp_ge_u32 s44, 128
    s_cbranch_scc1 Lt4_wb1
    s_lshl_b32 s22, s18, 2
    s_add_u32 s22, s22, s19
    s_cmp_lg_u32 s22, 0
    s_cbranch_scc1 Lt4_wb1
    buffer_wbl2 sc1
Lt4_wb1:
    s_cmp_lt_u32 s44, 128
    s_cbranch_scc1 Lt4_tile
L_done:
    s_endpgm
.section .rodata,"a"
.p2align 6
.amdhsa_kernel gated_mix__memory_aug_recurrent_mem_tr__glu_gated_bilinear__prompt_kernel
  .amdhsa_next_free_vgpr 512
  .amdhsa_next_free_sgpr 102
  .amdhsa_accum_offset 256
  .amdhsa_group_segment_fixed_size 0
  .amdhsa_kernarg_size 120
  .amdhsa_user_sgpr_count 2
  .amdhsa_user_sgpr_kernarg_segment_ptr 1
  .amdhsa_system_sgpr_workgroup_id_x 1
.end_amdhsa_kernel
```
